```python
import torch

def _softmax(x, axis=-1):
    return torch.softmax(x, dim=axis)
def _gelu(x):
    return torch.nn.functional.gelu(x, approximate="tanh")
def _silu(x):
    return torch.nn.functional.silu(x)
def _sigmoid(x):
    return torch.sigmoid(x)
def _layernorm(x, axis=-1, eps=1e-5):
    m = x.mean(dim=axis, keepdim=True)
    v = x.var(dim=axis, keepdim=True, unbiased=False)
    return (x - m) / torch.sqrt(v + eps)
def _scatter_add(tgt, idx, src, axis=0):
    return tgt.clone().index_add_(axis, idx, src)
def _segment_sum(src, seg, n):
    out = torch.zeros((n,) + src.shape[1:], dtype=src.dtype)
    return out.index_add_(0, seg, src)
def _pad(x, pw):
    flat = tuple(v for pair in reversed(pw) for v in pair)
    return torch.nn.functional.pad(x, flat)

kernel_name = 'sequential_preLN__ssm_conv_s4d__mixer_token_mlp__prompt'

def setup_inputs():

    _w = (lambda a: (lambda t: t.to(torch.bfloat16) if t.is_floating_point() else t)(torch.as_tensor(a)))
    def _A_setup():
        Bsz, L, D, N = 1, 2048, 576, 128
        return {
            "u": _w((lambda *s: torch.randn(*s, dtype=torch.bfloat16) * 0.05)(Bsz, L, D)),
            "log_A_real": _w((lambda *s: torch.randn(*s, dtype=torch.bfloat16) * 6.4)(D, N) * 0.5),
            "A_imag": _w((lambda *s: torch.randn(*s, dtype=torch.bfloat16) * 0.05)(D, N) * 3.14),
            "C_real": _w((lambda *s: torch.randn(*s, dtype=torch.bfloat16) * 0.05)(D, N) / N ** 0.5),
            "C_imag": _w((lambda *s: torch.randn(*s, dtype=torch.bfloat16) * 0.05)(D, N) / N ** 0.5),
            "log_dt": _w((lambda *s: torch.randn(*s, dtype=torch.bfloat16) * 0.05)(D) * 0.5 - 4.0),
            "D_skip": _w((lambda *s: torch.randn(*s, dtype=torch.bfloat16) * 0.05)(D)),
        }
    _A_in = _A_setup()

    def _B_setup():
        B, S, D, F = 1, 2048, 576, 4608
        return {
            "x": _w((lambda *s: torch.randn(*s, dtype=torch.bfloat16) * 0.05)(B, S, D)),
            "w1": _w((lambda *s: torch.randn(*s, dtype=torch.bfloat16) * 0.4)(S, F) * (S ** -0.5)),
            "b1": _w((lambda *s: torch.randn(*s, dtype=torch.bfloat16) * 0.1)(F) * 0.02),
            "w2": _w((lambda *s: torch.randn(*s, dtype=torch.bfloat16) * 0.1)(F, S) * (F ** -0.5)),
            "b2": _w((lambda *s: torch.randn(*s, dtype=torch.bfloat16) * 0.1)(S) * 0.02),
        }
    _B_in = _B_setup()

    return {
        "A_u": _A_in["u"],
        "A_log_A_real": _A_in["log_A_real"],
        "A_A_imag": _A_in["A_imag"],
        "A_C_real": _A_in["C_real"],
        "A_C_imag": _A_in["C_imag"],
        "A_log_dt": _A_in["log_dt"],
        "A_D_skip": _A_in["D_skip"],
        "B_x": _B_in["x"],
        "B_w1": _B_in["w1"],
        "B_b1": _B_in["b1"],
        "B_w2": _B_in["w2"],
        "B_b2": _B_in["b2"],
    }

def reference(A_u, A_log_A_real, A_A_imag, A_C_real, A_C_imag, A_log_dt, A_D_skip, B_x, B_w1, B_b1, B_w2, B_b2):
    def _A_ref(u, log_A_real, A_imag, C_real, C_imag, log_dt, D_skip):
        L = u.shape[1]
        dt = torch.exp(log_dt)
        A = -torch.exp(log_A_real) + 1j * A_imag
        C = (C_real + 1j * C_imag) * dt[:, None]
        pos = (lambda x, dt: x.to(dt))(torch.arange(L), log_dt.dtype)
        P = torch.exp((A * dt[:, None])[:, :, None] * pos[None, None, :])
        K = 2.0 * torch.einsum("dn,dnl->dl", C, P).real
        L2 = 2 * L
        u_t = (lambda x, *d: x.permute(*d))(u, 0, 2, 1)
        Kf = (lambda x, *a, **k: torch.fft.rfft(x.float(), *a, **k))(K, L2)
        Uf = (lambda x, *a, **k: torch.fft.rfft(x.float(), *a, **k))(u_t, L2)
        y = (lambda x, *a, **k: torch.fft.irfft(x, *a, **k).to(torch.bfloat16))(Uf * Kf[None, :, :], L2)[:, :, :L]
        y = (lambda x, *d: x.permute(*d))(y, 0, 2, 1)
        return y + u * D_skip[None, None, :]

    def _B_ref(x, w1, b1, w2, b2):
        B, S, D = x.shape
        h = _layernorm(x, axis=-1)
        u = torch.einsum("bsd,sf->bdf", h, w1) + b1
        u = _gelu(u)
        y = torch.einsum("bdf,fs->bds", u, w2) + b2
        return (lambda x, *d: x.permute(*d))(y, 0, 2, 1)

    x = A_u
    h = x + _A_ref(_layernorm(x, axis=-1), A_log_A_real, A_A_imag, A_C_real, A_C_imag, A_log_dt, A_D_skip)
    h2 = h + _B_ref(_layernorm(h, axis=-1), B_w1, B_b1, B_w2, B_b2)
    return h2
```

```asm
; @launch kernel=k1_kernel grid=(256,1,1) block=(768,1,1) lds=153888
; @launch kernel=k3_kernel grid=(384,1,1) block=(192,1,1) lds=1088
; @launch kernel=k4_kernel grid=(256,1,1) block=(512,1,1) lds=114688
; @launch kernel=k5_kernel grid=(256,1,1) block=(512,1,1) lds=114688
.amdgcn_target "amdgcn-amd-amdhsa--gfx950"
.text
.globl k1_kernel
.p2align 8
.type k1_kernel,@function
k1_kernel:
    s_cmp_ge_u32 s2, 256
    s_cbranch_scc1 K1_END
    s_load_dwordx2 s[4:5], s[0:1], 0
    s_load_dwordx2 s[6:7], s[0:1], 112
    s_load_dwordx8 s[16:23], s[0:1], 8
    s_load_dwordx4 s[52:55], s[0:1], 40
    s_load_dwordx2 s[56:57], s[0:1], 104
    s_load_dwordx2 s[84:85], s[0:1], 64
    v_lshrrev_b32 v2, 6, v0
    s_nop 0
    v_readfirstlane_b32 s59, v2
    v_and_b32 v1, 63, v0
    s_cmp_ge_u32 s2, 64
    s_cbranch_scc1 K1_CH
    s_cmp_lt_u32 s59, 8
    s_cbranch_scc1 K1_LN_A
    s_sub_u32 s26, s59, 8
    s_lshl_b32 s26, s26, 13
    s_getpc_b64 s[40:41]
CPF_A:
    s_add_u32 s40, s40, k1_kernel-CPF_A
    s_addc_u32 s41, s41, -1
    v_lshlrev_b32 v90, 7, v1
    v_add_u32 v90, s26, v90
    v_min_u32 v91, K5_END-k1_kernel-4, v90
    global_load_dword v92, v91, s[40:41]
    v_add_u32 v91, 32768, v90
    v_min_u32 v91, K5_END-k1_kernel-4, v91
    global_load_dword v93, v91, s[40:41]
    s_branch K1_LN_B
K1_LN_A:
    s_setprio 3
    v_lshrrev_b32 v2, 4, v1
    v_and_b32 v3, 15, v1
    s_lshl_b32 s3, s2, 5
    s_lshl_b32 s26, s59, 2
    s_add_u32 s3, s3, s26
    v_add_u32 v4, s3, v2
    s_movk_i32 s26, 1152
    v_mul_lo_u32 v5, v4, s26
    v_lshl_add_u32 v5, v3, 3, v5
    s_waitcnt lgkmcnt(0)
    s_mov_b32 s8, s4
    s_and_b32 s9, s5, 0xffff
    s_mov_b32 s10, 0x240000
    s_mov_b32 s11, 0x00020000
    buffer_load_dwordx2 v[10:11], v5, s[8:11], 0 offen offset:0
    buffer_load_dwordx2 v[12:13], v5, s[8:11], 0 offen offset:128
    buffer_load_dwordx2 v[14:15], v5, s[8:11], 0 offen offset:256
    buffer_load_dwordx2 v[16:17], v5, s[8:11], 0 offen offset:384
    buffer_load_dwordx2 v[18:19], v5, s[8:11], 0 offen offset:512
    buffer_load_dwordx2 v[20:21], v5, s[8:11], 0 offen offset:640
    buffer_load_dwordx2 v[22:23], v5, s[8:11], 0 offen offset:768
    buffer_load_dwordx2 v[24:25], v5, s[8:11], 0 offen offset:896
    buffer_load_dwordx2 v[26:27], v5, s[8:11], 0 offen offset:1024
    s_mov_b32 s12, s6
    s_and_b32 s13, s7, 0xffff
    s_mov_b32 s14, 0xb50000
    s_mov_b32 s15, 0x00020000
    s_mov_b32 s48, s56
    s_and_b32 s49, s57, 0xffff
    s_mov_b32 s50, 0x100
    s_mov_b32 s51, 0x00020000
    v_mov_b32 v6, 0
    ds_write_b32 v6, v6
    v_lshlrev_b32 v7, 2, v4
    v_lshrrev_b32 v9, 9, v7
    v_and_b32 v7, 511, v7
    v_lshl_add_u32 v7, v9, 10, v7
    v_add_u32 v7, 512, v7
    v_mov_b32 v8, 1
    v_lshrrev_b32 v28, 8, v4
    v_lshlrev_b32 v28, 10, v28
    v_and_b32 v29, 255, v4
    v_lshl_add_u32 v28, v29, 1, v28
    v_add_u32 v28, 512, v28
    s_waitcnt lgkmcnt(0)
K1_LN_B:
    s_barrier
    s_cmp_ge_u32 s59, 8
    s_cbranch_scc1 K1_PF
    s_waitcnt vmcnt(0)
    s_mov_b32 exec_lo, 0x80008000
    s_mov_b32 exec_hi, 0x80008000
    s_mov_b32 s26, 3145728
    buffer_store_short_d16_hi v11, v28, s[12:15], s26 offen sc1
    s_mov_b32 s26, 3170304
    buffer_store_short_d16_hi v17, v28, s[12:15], s26 offen sc1
    s_mov_b32 s26, 3194880
    buffer_store_short_d16_hi v23, v28, s[12:15], s26 offen sc1
    s_mov_b32 exec_lo, 0x00010001
    s_mov_b32 exec_hi, 0x00010001
    s_mov_b32 s26, 3162112
    buffer_store_short v14, v28, s[12:15], s26 offen sc1
    s_mov_b32 s26, 3186688
    buffer_store_short v20, v28, s[12:15], s26 offen sc1
    s_mov_b32 s26, 3211264
    buffer_store_short v26, v28, s[12:15], s26 offen sc1
    s_mov_b64 exec, -1
    v_lshlrev_b32 v30, 16, v10
    v_and_b32 v31, 0xffff0000, v10
    v_lshlrev_b32 v32, 16, v11
    v_and_b32 v33, 0xffff0000, v11
    v_lshlrev_b32 v34, 16, v12
    v_and_b32 v35, 0xffff0000, v12
    v_lshlrev_b32 v36, 16, v13
    v_and_b32 v37, 0xffff0000, v13
    v_lshlrev_b32 v38, 16, v14
    v_and_b32 v39, 0xffff0000, v14
    v_lshlrev_b32 v40, 16, v15
    v_and_b32 v41, 0xffff0000, v15
    v_lshlrev_b32 v42, 16, v16
    v_and_b32 v43, 0xffff0000, v16
    v_lshlrev_b32 v44, 16, v17
    v_and_b32 v45, 0xffff0000, v17
    v_lshlrev_b32 v46, 16, v18
    v_and_b32 v47, 0xffff0000, v18
    v_lshlrev_b32 v48, 16, v19
    v_and_b32 v49, 0xffff0000, v19
    v_lshlrev_b32 v50, 16, v20
    v_and_b32 v51, 0xffff0000, v20
    v_lshlrev_b32 v52, 16, v21
    v_and_b32 v53, 0xffff0000, v21
    v_lshlrev_b32 v54, 16, v22
    v_and_b32 v55, 0xffff0000, v22
    v_lshlrev_b32 v56, 16, v23
    v_and_b32 v57, 0xffff0000, v23
    v_lshlrev_b32 v58, 16, v24
    v_and_b32 v59, 0xffff0000, v24
    v_lshlrev_b32 v60, 16, v25
    v_and_b32 v61, 0xffff0000, v25
    v_lshlrev_b32 v62, 16, v26
    v_and_b32 v63, 0xffff0000, v26
    v_lshlrev_b32 v64, 16, v27
    v_and_b32 v65, 0xffff0000, v27
    v_pk_add_f32 v[66:67], v[30:31], v[32:33]
    v_pk_add_f32 v[68:69], v[34:35], v[36:37]
    v_pk_add_f32 v[66:67], v[66:67], v[38:39]
    v_pk_add_f32 v[68:69], v[68:69], v[40:41]
    v_pk_add_f32 v[66:67], v[66:67], v[42:43]
    v_pk_add_f32 v[68:69], v[68:69], v[44:45]
    v_pk_add_f32 v[66:67], v[66:67], v[46:47]
    v_pk_add_f32 v[68:69], v[68:69], v[48:49]
    v_pk_add_f32 v[66:67], v[66:67], v[50:51]
    v_pk_add_f32 v[68:69], v[68:69], v[52:53]
    v_pk_add_f32 v[66:67], v[66:67], v[54:55]
    v_pk_add_f32 v[68:69], v[68:69], v[56:57]
    v_pk_add_f32 v[66:67], v[66:67], v[58:59]
    v_pk_add_f32 v[68:69], v[68:69], v[60:61]
    v_pk_add_f32 v[66:67], v[66:67], v[62:63]
    v_pk_add_f32 v[68:69], v[68:69], v[64:65]
    v_pk_add_f32 v[66:67], v[66:67], v[68:69]
    v_add_f32 v66, v66, v67
    s_nop 1
    v_add_f32_dpp v66, v66, v66 quad_perm:[1,0,3,2] row_mask:0xf bank_mask:0xf
    s_nop 1
    v_add_f32_dpp v66, v66, v66 quad_perm:[2,3,0,1] row_mask:0xf bank_mask:0xf
    s_nop 1
    v_add_f32_dpp v66, v66, v66 row_half_mirror row_mask:0xf bank_mask:0xf
    s_nop 1
    v_add_f32_dpp v66, v66, v66 row_mirror row_mask:0xf bank_mask:0xf
    s_mov_b32 s26, 0x3ae38e39
    v_mul_f32 v70, s26, v66
    v_pk_add_f32 v[72:73], v[30:31], v[70:71] op_sel:[0,0] op_sel_hi:[1,0] neg_lo:[0,1] neg_hi:[0,1]
    v_pk_mul_f32 v[66:67], v[72:73], v[72:73]
    v_pk_add_f32 v[74:75], v[32:33], v[70:71] op_sel:[0,0] op_sel_hi:[1,0] neg_lo:[0,1] neg_hi:[0,1]
    v_pk_mul_f32 v[68:69], v[74:75], v[74:75]
    v_pk_add_f32 v[76:77], v[34:35], v[70:71] op_sel:[0,0] op_sel_hi:[1,0] neg_lo:[0,1] neg_hi:[0,1]
    v_pk_fma_f32 v[66:67], v[76:77], v[76:77], v[66:67]
    v_pk_add_f32 v[78:79], v[36:37], v[70:71] op_sel:[0,0] op_sel_hi:[1,0] neg_lo:[0,1] neg_hi:[0,1]
    v_pk_fma_f32 v[68:69], v[78:79], v[78:79], v[68:69]
    v_pk_add_f32 v[72:73], v[38:39], v[70:71] op_sel:[0,0] op_sel_hi:[1,0] neg_lo:[0,1] neg_hi:[0,1]
    v_pk_fma_f32 v[66:67], v[72:73], v[72:73], v[66:67]
    v_pk_add_f32 v[74:75], v[40:41], v[70:71] op_sel:[0,0] op_sel_hi:[1,0] neg_lo:[0,1] neg_hi:[0,1]
    v_pk_fma_f32 v[68:69], v[74:75], v[74:75], v[68:69]
    v_pk_add_f32 v[76:77], v[42:43], v[70:71] op_sel:[0,0] op_sel_hi:[1,0] neg_lo:[0,1] neg_hi:[0,1]
    v_pk_fma_f32 v[66:67], v[76:77], v[76:77], v[66:67]
    v_pk_add_f32 v[78:79], v[44:45], v[70:71] op_sel:[0,0] op_sel_hi:[1,0] neg_lo:[0,1] neg_hi:[0,1]
    v_pk_fma_f32 v[68:69], v[78:79], v[78:79], v[68:69]
    v_pk_add_f32 v[72:73], v[46:47], v[70:71] op_sel:[0,0] op_sel_hi:[1,0] neg_lo:[0,1] neg_hi:[0,1]
    v_pk_fma_f32 v[66:67], v[72:73], v[72:73], v[66:67]
    v_pk_add_f32 v[74:75], v[48:49], v[70:71] op_sel:[0,0] op_sel_hi:[1,0] neg_lo:[0,1] neg_hi:[0,1]
    v_pk_fma_f32 v[68:69], v[74:75], v[74:75], v[68:69]
    v_pk_add_f32 v[76:77], v[50:51], v[70:71] op_sel:[0,0] op_sel_hi:[1,0] neg_lo:[0,1] neg_hi:[0,1]
    v_pk_fma_f32 v[66:67], v[76:77], v[76:77], v[66:67]
    v_pk_add_f32 v[78:79], v[52:53], v[70:71] op_sel:[0,0] op_sel_hi:[1,0] neg_lo:[0,1] neg_hi:[0,1]
    v_pk_fma_f32 v[68:69], v[78:79], v[78:79], v[68:69]
    v_pk_add_f32 v[72:73], v[54:55], v[70:71] op_sel:[0,0] op_sel_hi:[1,0] neg_lo:[0,1] neg_hi:[0,1]
    v_pk_fma_f32 v[66:67], v[72:73], v[72:73], v[66:67]
    v_pk_add_f32 v[74:75], v[56:57], v[70:71] op_sel:[0,0] op_sel_hi:[1,0] neg_lo:[0,1] neg_hi:[0,1]
    v_pk_fma_f32 v[68:69], v[74:75], v[74:75], v[68:69]
    v_pk_add_f32 v[76:77], v[58:59], v[70:71] op_sel:[0,0] op_sel_hi:[1,0] neg_lo:[0,1] neg_hi:[0,1]
    v_pk_fma_f32 v[66:67], v[76:77], v[76:77], v[66:67]
    v_pk_add_f32 v[78:79], v[60:61], v[70:71] op_sel:[0,0] op_sel_hi:[1,0] neg_lo:[0,1] neg_hi:[0,1]
    v_pk_fma_f32 v[68:69], v[78:79], v[78:79], v[68:69]
    v_pk_add_f32 v[72:73], v[62:63], v[70:71] op_sel:[0,0] op_sel_hi:[1,0] neg_lo:[0,1] neg_hi:[0,1]
    v_pk_fma_f32 v[66:67], v[72:73], v[72:73], v[66:67]
    v_pk_add_f32 v[74:75], v[64:65], v[70:71] op_sel:[0,0] op_sel_hi:[1,0] neg_lo:[0,1] neg_hi:[0,1]
    v_pk_fma_f32 v[68:69], v[74:75], v[74:75], v[68:69]
    v_pk_add_f32 v[66:67], v[66:67], v[68:69]
    v_add_f32 v66, v66, v67
    s_nop 1
    v_add_f32_dpp v66, v66, v66 quad_perm:[1,0,3,2] row_mask:0xf bank_mask:0xf
    s_nop 1
    v_add_f32_dpp v66, v66, v66 quad_perm:[2,3,0,1] row_mask:0xf bank_mask:0xf
    s_nop 1
    v_add_f32_dpp v66, v66, v66 row_half_mirror row_mask:0xf bank_mask:0xf
    s_nop 1
    v_add_f32_dpp v66, v66, v66 row_mirror row_mask:0xf bank_mask:0xf
    v_mul_f32 v66, s26, v66
    v_cvt_pk_bf16_f32 v70, v70, v70
    v_and_b32 v70, 0xffff0000, v70
    v_cvt_pk_bf16_f32 v66, v66, v66
    v_and_b32 v66, 0xffff0000, v66
    v_add_f32 v66, 0x3727c5ac, v66
    v_cvt_pk_bf16_f32 v66, v66, v66
    v_and_b32 v66, 0xffff0000, v66
    v_sqrt_f32 v66, v66
    s_nop 0
    v_cvt_pk_bf16_f32 v66, v66, v66
    v_and_b32 v66, 0xffff0000, v66
    v_lshrrev_b32 v70, 16, v70
    v_or_b32 v66, v66, v70
    s_mov_b32 exec_lo, 0x00010001
    s_mov_b32 exec_hi, 0x00010001
    s_mov_b32 s26, 0
    buffer_store_dword v66, v7, s[12:15], s26 offen sc1
    s_waitcnt vmcnt(0)
    s_mov_b64 exec, 1
    ds_add_rtn_u32 v9, v6, v8
    s_waitcnt lgkmcnt(0)
    v_readfirstlane_b32 s26, v9
    s_nop 0
    s_cmp_lg_u32 s26, 7
    s_cbranch_scc1 K1_LN_D
    buffer_atomic_add v8, v6, s[48:51], 0 offen sc0 sc1
    s_waitcnt vmcnt(0)
    v_readfirstlane_b32 s26, v8
    s_nop 0
    s_cmp_lg_u32 s26, 63
    s_cbranch_scc1 K1_LN_D
    v_mov_b32 v8, 1
    buffer_store_dword v8, v6, s[48:51], 0 offen offset:128 sc1
K1_LN_D:
    s_mov_b64 exec, -1
    s_setprio 0
    s_branch K1_PF
K1_CH:
    s_sub_u32 s3, s2, 64
    s_and_b32 s26, s3, 7
    s_mul_i32 s26, s26, 24
    s_lshr_b32 s3, s3, 3
    s_add_u32 s3, s3, s26
    s_lshr_b32 s39, s59, 2
    s_and_b32 s27, s59, 3
    s_add_u32 s27, s27, s39
    s_and_b32 s27, s27, 3
    s_mul_i32 s33, s3, 3
    s_add_u32 s33, s33, s39
    s_mul_i32 s34, s39, 51296
    s_movk_i32 s26, 1152
    s_cmp_lg_u32 s27, 3
    s_cbranch_scc1 K1_CI
    v_and_b32 v2, 15, v1
    v_lshl_add_u32 v2, v2, 2, s34
    v_mov_b32 v5, 0
    ds_write_b32 v2, v5 offset:51232
K1_CI:
    s_add_u32 s35, s3, s39
    s_mul_i32 s28, s35, 171
    s_lshr_b32 s28, s28, 9
    s_mul_i32 s28, s28, 3
    s_sub_u32 s35, s35, s28
    s_lshl_b32 s28, s35, 8
    v_lshl_add_u32 v0, s27, 6, v1
    v_add_u32 v151, s28, v0
    v_mul_lo_u32 v150, v151, s26
    v_lshlrev_b32 v151, 1, v151
    v_lshrrev_b32 v3, 4, v1
    v_and_b32 v4, 15, v1
    v_and_b32 v6, 127, v0
    s_lshl_b32 s28, s33, 8
    v_lshlrev_b32 v5, 1, v6
    v_add_u32 v5, s28, v5
    v_lshl_add_u32 v9, v1, 2, s28
    s_lshl_b32 s44, s33, 1
    v_mov_b32 v7, s44
    s_mul_i32 s36, s3, 6
    s_and_b32 s37, s36, 2
    s_lshl_b32 s37, s37, 3
    s_and_b32 s36, s36, -4
    s_mul_i32 s28, s3, 6
    s_and_b32 s28, s28, 127
    s_mov_b32 s32, 3
    s_cmp_lg_u32 s28, 126
    s_cbranch_scc1 K1_XM1
    s_add_u32 s36, s36, 4
    s_mov_b32 s37, 0
    s_mov_b32 s32, 0
K1_XM1:
    s_cmp_lg_u32 s28, 124
    s_cbranch_scc1 K1_XM2
    s_sub_u32 s36, s36, 4
    s_mov_b32 s37, 32
    s_mov_b32 s32, 2
K1_XM2:
    s_add_u32 s38, s36, 884736
    s_add_u32 s58, s36, 1769472
    s_waitcnt lgkmcnt(0)
    s_mov_b32 s40, s52
    s_and_b32 s41, s53, 0xffff
    s_mov_b32 s42, 0x480
    s_mov_b32 s43, 0x00020000
    buffer_load_ushort v14, v7, s[40:43], 0 offen
    s_mov_b32 s8, s16
    s_and_b32 s9, s17, 0xffff
    s_mov_b32 s10, 0x24000
    s_mov_b32 s11, 0x00020000
    buffer_load_ushort v10, v5, s[8:11], 0 offen
    s_mov_b32 s28, s18
    s_and_b32 s29, s19, 0xffff
    s_mov_b32 s30, 0x24000
    s_mov_b32 s31, 0x00020000
    buffer_load_ushort v11, v5, s[28:31], 0 offen
    s_mov_b32 s44, s20
    s_and_b32 s45, s21, 0xffff
    s_mov_b32 s46, 0x24000
    s_mov_b32 s47, 0x00020000
    buffer_load_dword v24, v9, s[44:47], 0 offen
    buffer_load_ushort v12, v5, s[44:47], 0 offen
    s_mov_b32 s48, s22
    s_and_b32 s49, s23, 0xffff
    s_mov_b32 s50, 0x24000
    s_mov_b32 s51, 0x00020000
    buffer_load_dword v25, v9, s[48:51], 0 offen
    buffer_load_ushort v13, v5, s[48:51], 0 offen
    s_mov_b32 s40, s54
    s_and_b32 s41, s55, 0xffff
    s_mov_b32 s42, 0x480
    s_mov_b32 s43, 0x00020000
    buffer_load_ushort v160, v7, s[40:43], 0 offen
    s_mov_b32 s8, s4
    s_and_b32 s9, s5, 0xffff
    s_mov_b32 s10, 0x240000
    s_mov_b32 s11, 0x00020000
    s_barrier
    s_mov_b32 s12, s6
    s_and_b32 s13, s7, 0xffff
    s_mov_b32 s14, 0xb50000
    s_mov_b32 s15, 0x00020000
    s_mov_b32 s48, s56
    s_and_b32 s49, s57, 0xffff
    s_mov_b32 s50, 0x100
    s_mov_b32 s51, 0x00020000
    s_mov_b32 s44, 0x3fb8aa3b
    s_mov_b32 s45, 0x32a57060
    s_mov_b32 s46, 0x3f317218
    s_mov_b32 s47, 0x3e22f983
    s_mov_b32 s26, 0xbfb8aa3b
    v_lshrrev_b32 v8, 3, v6
    v_mul_u32_u24 v8, 544, v8
    v_bfe_u32 v9, v6, 2, 1
    v_lshl_add_u32 v8, v9, 8, v8
    v_and_b32 v9, 3, v6
    v_lshl_add_u32 v8, v9, 2, v8
    v_add_u32 v8, s34, v8
    s_lshr_b32 s28, s27, 1
    s_mul_i32 s28, s28, 17408
    v_add_u32 v8, s28, v8
    v_add_u32 v2, 8704, v8
    v_lshrrev_b32 v9, 1, v3
    v_mul_u32_u24 v9, 544, v9
    v_and_b32 v5, 1, v3
    v_lshl_add_u32 v9, v5, 8, v9
    v_lshl_add_u32 v9, v4, 4, v9
    v_add_u32 v9, s34, v9
    s_cmp_eq_u32 s27, 1
    s_cbranch_scc1 K1_KG_T1
    s_cmp_eq_u32 s27, 2
    s_cbranch_scc1 K1_KG_T2
    v_and_b32 v100, 1, v3
    v_lshlrev_b32 v100, 2, v100
    v_lshrrev_b32 v101, 1, v3
    v_lshl_add_u32 v100, v101, 7, v100
    v_lshl_add_u32 v100, v4, 3, v100
    v_add_u32 v101, 1, v100
    v_add_u32 v102, 2, v100
    v_add_u32 v103, 3, v100
    s_branch K1_KG_SC
K1_KG_T1:
    v_lshlrev_b32 v104, 6, v3
    v_lshl_add_u32 v104, v4, 2, v104
    v_add_u32 v104, 256, v104
    v_lshlrev_b32 v105, 6, v3
    v_lshl_add_u32 v105, v4, 1, v105
    v_add_u32 v105, 256, v105
    v_cmp_gt_u32 vcc, 2, v3
    v_add_u32 v106, 0, v104
    v_add_u32 v107, 0, v105
    v_cndmask_b32 v100, v107, v106, vcc
    v_add_u32 v106, 1, v104
    v_add_u32 v107, 1, v105
    v_cndmask_b32 v101, v107, v106, vcc
    v_add_u32 v106, 2, v104
    v_add_u32 v107, 32, v105
    v_cndmask_b32 v102, v107, v106, vcc
    v_add_u32 v106, 3, v104
    v_add_u32 v107, 33, v105
    v_cndmask_b32 v103, v107, v106, vcc
    s_branch K1_KG_SC
K1_KG_T2:
    v_lshlrev_b32 v100, 6, v3
    v_add_u32 v100, v4, v100
    v_add_u32 v100, 512, v100
    v_add_u32 v101, 16, v100
    v_add_u32 v102, 32, v100
    v_add_u32 v103, 48, v100
K1_KG_SC:
    v_lshl_add_u32 v140, v100, 2, s34
    v_lshl_add_u32 v141, v101, 2, s34
    v_lshl_add_u32 v142, v102, 2, s34
    v_lshl_add_u32 v143, v103, 2, s34
    s_min_u32 s28, s39, 1
    s_add_u32 s28, s28, s39
    s_and_b32 s88, s59, 3
    s_xor_b32 s88, s28, s88
    s_cmp_eq_u32 s88, 1
    s_cbranch_scc1 K1_FA1
    s_cmp_lg_u32 s88, 0
    s_cbranch_scc1 K1_FA2
    v_lshlrev_b32 v116, 3, v1
    v_sub_u32 v117, 643, v116
    v_add_u32 v118, 412, v117
    v_cmp_gt_u32 vcc, 6, v1
    s_nop 1
    v_cndmask_b32 v116, v117, v118, vcc
    v_cvt_f32_i32 v122, v116
    s_sub_u32 s28, s34, 68096
    v_add_f32 v119, 0xbf800000, v122
    v_cvt_pk_bf16_f32 v118, v122, v119
    v_mad_u32_u16 v100, v118, 4, s28
    v_mad_u32_u16 v101, v118, 4, s28 op_sel:[1,0,0,0]
    v_add_f32 v120, 0xc0000000, v122
    v_add_f32 v121, 0xc0400000, v122
    v_cvt_pk_bf16_f32 v120, v120, v121
    v_mad_u32_u16 v102, v120, 4, s28
    v_mad_u32_u16 v103, v120, 4, s28 op_sel:[1,0,0,0]
    v_add_f32 v118, 0xc0800000, v122
    v_add_f32 v119, 0xc0a00000, v122
    v_cvt_pk_bf16_f32 v118, v118, v119
    v_mad_u32_u16 v104, v118, 4, s28
    v_mad_u32_u16 v105, v118, 4, s28 op_sel:[1,0,0,0]
    v_add_f32 v120, 0xc0c00000, v122
    v_add_f32 v121, 0xc0e00000, v122
    v_cvt_pk_bf16_f32 v120, v120, v121
    v_mad_u32_u16 v106, v120, 4, s28
    v_mad_u32_u16 v107, v120, 4, s28 op_sel:[1,0,0,0]
    v_add_f32 v118, 0xc1000000, v122
    v_add_f32 v119, 0xc1100000, v122
    v_cvt_pk_bf16_f32 v118, v118, v119
    v_mad_u32_u16 v108, v118, 4, s28
    v_mad_u32_u16 v109, v118, 4, s28 op_sel:[1,0,0,0]
    v_add_f32 v120, 0xc1200000, v122
    v_add_f32 v121, 0xc1300000, v122
    v_cvt_pk_bf16_f32 v120, v120, v121
    v_mad_u32_u16 v110, v120, 4, s28
    v_mad_u32_u16 v111, v120, 4, s28 op_sel:[1,0,0,0]
    v_lshl_add_u32 v5, v1, 4, s34
    s_branch K1_FA2
K1_FA1:
    v_lshlrev_b32 v116, 5, v1
    v_sub_u32 v100, 524, v116
    v_subrev_u32 v117, 17, v1
    v_mul_u32_u24 v118, 43, v117
    v_lshrrev_b32 v118, 8, v118
    v_mul_u32_u24 v118, 772, v118
    v_lshlrev_b32 v117, 7, v117
    v_sub_u32 v118, v118, v117
    v_add_u32 v118, 2304, v118
    v_cmp_lt_u32 vcc, 16, v1
    s_nop 1
    v_cndmask_b32 v100, v100, v118, vcc
    v_cndmask_b32 v119, -4, -16, vcc
    v_subrev_u32 v117, 43, v1
    v_lshlrev_b32 v117, 6, v117
    v_sub_u32 v118, 2560, v117
    v_add_u32 v117, 644, v118
    v_cmp_lt_u32 vcc, 52, v1
    s_nop 1
    v_cndmask_b32 v118, v118, v117, vcc
    v_cmp_lt_u32 vcc, 42, v1
    s_nop 1
    v_cndmask_b32 v100, v100, v118, vcc
    v_cndmask_b32 v119, v119, -8, vcc
    v_add_u32 v100, s34, v100
    v_mad_i32_i24 v101, v119, 1, v100
    v_mad_i32_i24 v102, v119, 2, v100
    v_mad_i32_i24 v103, v119, 3, v100
    v_mad_i32_i24 v104, v119, 4, v100
    v_mad_i32_i24 v105, v119, 5, v100
    v_mad_i32_i24 v106, v119, 6, v100
    v_mad_i32_i24 v107, v119, 7, v100
    v_mad_i32_i24 v108, v119, 8, v100
    v_mad_i32_i24 v109, v119, 9, v100
    v_mad_i32_i24 v110, v119, 10, v100
    v_mad_i32_i24 v111, v119, 11, v100
    v_lshl_add_u32 v5, v1, 4, s34
    v_add_u32 v5, 1024, v5
K1_FA2:
    v_lshlrev_b32 v23, 5, v4
    v_lshl_add_u32 v23, v3, 3, v23
    s_lshl_b32 s28, s27, 10
    s_add_u32 s28, s28, s34
    v_add_u32 v23, s28, v23
    v_and_b32 v15, 1, v1
    v_lshlrev_b32 v15, 4, v15
    v_add_u32 v15, 8448, v15
    v_bfe_u32 v116, v1, 1, 2
    v_add_u32 v117, 5264, v15
    v_cmp_le_u32 vcc, 1, v116
    s_nop 1
    v_cndmask_b32 v15, v15, v117, vcc
    v_add_u32 v117, 3152, v15
    v_cmp_le_u32 vcc, 2, v116
    s_nop 1
    v_cndmask_b32 v15, v15, v117, vcc
    v_subrev_u32 v116, 32, v1
    v_lshlrev_b32 v116, 4, v116
    v_add_u32 v116, 43552, v116
    v_cmp_gt_u32 vcc, 32, v1
    s_nop 1
    v_cndmask_b32 v15, v116, v15, vcc
    v_add_u32 v15, s34, v15
    v_lshlrev_b32 v20, 5, v4
    v_lshl_add_u32 v20, v3, 4, v20
    s_add_u32 s29, s34, 43584
    v_add_u32 v20, s29, v20
    v_and_b32 v21, 3, v4
    v_mul_u32_u24 v21, 2112, v21
    v_lshl_add_u32 v21, v3, 4, v21
    v_lshrrev_b32 v116, 2, v4
    v_lshlrev_b32 v116, 3, v116
    v_sub_u32 v21, v21, v116
    s_add_u32 s29, s34, 216
    v_add_u32 v21, s29, v21
    v_and_b32 v22, 7, v4
    v_lshlrev_b32 v22, 6, v22
    v_lshrrev_b32 v116, 3, v4
    v_lshl_add_u32 v22, v116, 10, v22
    v_lshl_add_u32 v22, v3, 4, v22
    v_add_u32 v158, 51296, v151
    v_add_u32 v159, 102592, v151
    s_cmp_lg_u32 s32, 0
    s_cbranch_scc1 K1_XM3
    v_mov_b32 v116, v151
    v_mov_b32 v151, v158
    v_mov_b32 v158, v159
    v_mov_b32 v159, v116
K1_XM3:
    s_waitcnt vmcnt(1)
    s_cmp_lg_u32 s39, 0
    s_cbranch_scc1 K1_GP_1
    buffer_load_dwordx2 v[152:153], v150, s[8:11], s36 offen
    buffer_load_dwordx2 v[154:155], v150, s[8:11], s38 offen
    buffer_load_dwordx2 v[156:157], v150, s[8:11], s58 offen
K1_GP_1:
    v_lshlrev_b32 v14, 16, v14
    v_mul_f32 v17, s44, v14
    v_fma_f32 v18, v14, s44, -v17
    v_fma_f32 v18, v14, s45, v18
    v_exp_f32 v16, v17
    v_mul_f32 v18, s46, v18
    v_fma_f32 v16, v16, v18, v16
    v_lshlrev_b32 v10, 16, v10
    v_mul_f32 v28, s44, v10
    v_fma_f32 v29, v10, s44, -v28
    v_fma_f32 v29, v10, s45, v29
    v_exp_f32 v19, v28
    v_mul_f32 v29, s46, v29
    v_fma_f32 v19, v19, v29, v19
    v_cvt_pk_bf16_f32 v16, v16, v16
    v_and_b32 v16, 0xffff0000, v16
    v_cvt_pk_bf16_f32 v19, v19, v19
    v_and_b32 v19, 0xffff0000, v19
    v_add_f32 v17, v16, v16
    v_mul_f32 v19, v19, v16
    v_mul_f32 v32, s26, v19
    v_lshlrev_b32 v11, 16, v11
    v_mul_f32 v11, v11, v16
    v_mul_f32 v33, s47, v11
    v_and_b32 v24, 0x7fff7fff, v24
    v_and_b32 v25, 0x7fff7fff, v25
    v_lshlrev_b32 v28, 16, v24
    v_lshlrev_b32 v29, 16, v25
    v_max_u32 v24, v24, v25
    v_max_u32 v28, v28, v29
    v_and_b32 v24, 0xffff0000, v24
    v_max_u32 v36, v24, v28
    s_nop 1
    v_max_u32_dpp v36, v36, v36 quad_perm:[1,0,3,2] row_mask:0xf bank_mask:0xf
    s_nop 1
    v_max_u32_dpp v36, v36, v36 quad_perm:[2,3,0,1] row_mask:0xf bank_mask:0xf
    s_nop 1
    v_max_u32_dpp v36, v36, v36 row_half_mirror row_mask:0xf bank_mask:0xf
    s_nop 1
    v_max_u32_dpp v36, v36, v36 row_mirror row_mask:0xf bank_mask:0xf
    s_nop 0
    v_readlane_b32 s24, v36, 0
    v_readlane_b32 s25, v36, 16
    v_readlane_b32 s30, v36, 32
    v_readlane_b32 s31, v36, 48
    s_max_u32 s24, s24, s25
    s_max_u32 s30, s30, s31
    s_max_u32 s24, s24, s30
    v_mul_f32 v36, s24, v17
    v_frexp_exp_i32_f32 v26, v36
    v_sub_u32 v31, 0, v26
    s_cmp_ge_u32 s27, 2
    s_cbranch_scc1 K1_H1
    v_mul_f32 v72, 0x41000000, v32
    v_mul_f32 v73, 0x41000000, v33
    v_fract_f32 v73, v73
    v_exp_f32 v72, v72
    v_cos_f32 v74, v73
    v_sin_f32 v75, v73
    v_mul_f32 v40, v72, v74
    v_mul_f32 v41, v72, v75
    v_mul_f32 v76, 1.0, v32
    v_mul_f32 v77, 1.0, v33
    v_fract_f32 v77, v77
    v_exp_f32 v76, v76
    v_cos_f32 v78, v77
    v_sin_f32 v79, v77
    v_mul_f32 v42, v76, v78
    v_mul_f32 v43, -v76, v79
    v_mul_f32 v64, 0x43000000, v32
    v_mul_f32 v65, 0x43000000, v33
    v_fract_f32 v65, v65
    v_exp_f32 v64, v64
    v_cos_f32 v66, v65
    v_sin_f32 v67, v65
    v_mul_f32 v44, v64, v66
    v_mul_f32 v45, -v64, v67
    v_lshlrev_b32 v12, 16, v12
    v_lshlrev_b32 v13, 16, v13
    v_mul_f32 v12, v12, v17
    v_mul_f32 v13, v13, v17
    v_ldexp_f32 v46, v12, v31
    v_ldexp_f32 v47, v13, v31
    v_mov_b32 v52, 1.0
    v_mov_b32 v53, 0
    v_cvt_pk_f16_f32 v80, v46, v47
    v_cvt_pk_f16_f32 v81, v52, v53
    v_cvt_pk_f16_f32 v82, v42, v43
    ds_write2_b32 v2, v81, v82 offset0:0 offset1:4
    v_cvt_pk_f16_f32 v83, v44, v45
    s_cmp_lg_u32 s39, 1
    s_cbranch_scc1 K1_GP_2
    buffer_load_dwordx2 v[152:153], v150, s[8:11], s36 offen
    buffer_load_dwordx2 v[154:155], v150, s[8:11], s38 offen
    buffer_load_dwordx2 v[156:157], v150, s[8:11], s58 offen
K1_GP_2:
    v_pk_mul_f32 v[50:51], v[46:47], v[40:41] op_sel:[0,0] op_sel_hi:[0,1]
    v_pk_fma_f32 v[48:49], v[46:47], v[40:41], v[50:51] op_sel:[1,1,0] op_sel_hi:[1,0,1] neg_lo:[1,0,0]
    v_pk_mul_f32 v[60:61], v[42:43], v[44:45] op_sel:[0,0] op_sel_hi:[0,1]
    v_pk_fma_f32 v[58:59], v[42:43], v[44:45], v[60:61] op_sel:[1,1,0] op_sel_hi:[1,0,1] neg_lo:[1,0,0]
    v_pk_mul_f32 v[62:63], v[42:43], v[42:43] op_sel:[0,0] op_sel_hi:[0,1]
    v_pk_fma_f32 v[54:55], v[42:43], v[42:43], v[62:63] op_sel:[1,1,0] op_sel_hi:[1,0,1] neg_lo:[1,0,0]
    v_cvt_pk_f16_f32 v84, v48, v49
    ds_write2_b32 v8, v80, v84 offset0:0 offset1:4
    v_cvt_pk_f16_f32 v85, v58, v59
    ds_write2_b32 v2, v83, v85 offset0:32 offset1:36
    v_cvt_pk_f16_f32 v86, v54, v55
    v_pk_mul_f32 v[50:51], v[48:49], v[40:41] op_sel:[0,0] op_sel_hi:[0,1]
    v_pk_fma_f32 v[46:47], v[48:49], v[40:41], v[50:51] op_sel:[1,1,0] op_sel_hi:[1,0,1] neg_lo:[1,0,0]
    v_pk_mul_f32 v[60:61], v[54:55], v[44:45] op_sel:[0,0] op_sel_hi:[0,1]
    v_pk_fma_f32 v[58:59], v[54:55], v[44:45], v[60:61] op_sel:[1,1,0] op_sel_hi:[1,0,1] neg_lo:[1,0,0]
    v_pk_mul_f32 v[62:63], v[54:55], v[42:43] op_sel:[0,0] op_sel_hi:[0,1]
    v_pk_fma_f32 v[56:57], v[54:55], v[42:43], v[62:63] op_sel:[1,1,0] op_sel_hi:[1,0,1] neg_lo:[1,0,0]
    v_cvt_pk_f16_f32 v87, v46, v47
    v_cvt_pk_f16_f32 v88, v58, v59
    v_cvt_pk_f16_f32 v89, v56, v57
    ds_write2_b32 v2, v86, v89 offset0:8 offset1:12
    v_pk_mul_f32 v[50:51], v[46:47], v[40:41] op_sel:[0,0] op_sel_hi:[0,1]
    v_pk_fma_f32 v[48:49], v[46:47], v[40:41], v[50:51] op_sel:[1,1,0] op_sel_hi:[1,0,1] neg_lo:[1,0,0]
    v_pk_mul_f32 v[60:61], v[56:57], v[44:45] op_sel:[0,0] op_sel_hi:[0,1]
    v_pk_fma_f32 v[58:59], v[56:57], v[44:45], v[60:61] op_sel:[1,1,0] op_sel_hi:[1,0,1] neg_lo:[1,0,0]
    v_pk_mul_f32 v[62:63], v[56:57], v[42:43] op_sel:[0,0] op_sel_hi:[0,1]
    v_pk_fma_f32 v[54:55], v[56:57], v[42:43], v[62:63] op_sel:[1,1,0] op_sel_hi:[1,0,1] neg_lo:[1,0,0]
    v_cvt_pk_f16_f32 v90, v48, v49
    ds_write2_b32 v8, v87, v90 offset0:8 offset1:12
    v_cvt_pk_f16_f32 v91, v58, v59
    ds_write2_b32 v2, v88, v91 offset0:40 offset1:44
    v_cvt_pk_f16_f32 v92, v54, v55
    v_pk_mul_f32 v[50:51], v[48:49], v[40:41] op_sel:[0,0] op_sel_hi:[0,1]
    v_pk_fma_f32 v[46:47], v[48:49], v[40:41], v[50:51] op_sel:[1,1,0] op_sel_hi:[1,0,1] neg_lo:[1,0,0]
    v_pk_mul_f32 v[60:61], v[54:55], v[44:45] op_sel:[0,0] op_sel_hi:[0,1]
    v_pk_fma_f32 v[58:59], v[54:55], v[44:45], v[60:61] op_sel:[1,1,0] op_sel_hi:[1,0,1] neg_lo:[1,0,0]
    v_pk_mul_f32 v[62:63], v[54:55], v[42:43] op_sel:[0,0] op_sel_hi:[0,1]
    v_pk_fma_f32 v[56:57], v[54:55], v[42:43], v[62:63] op_sel:[1,1,0] op_sel_hi:[1,0,1] neg_lo:[1,0,0]
    v_cvt_pk_f16_f32 v93, v46, v47
    v_cvt_pk_f16_f32 v94, v58, v59
    v_cvt_pk_f16_f32 v95, v56, v57
    ds_write2_b32 v2, v92, v95 offset0:16 offset1:20
    v_pk_mul_f32 v[50:51], v[46:47], v[40:41] op_sel:[0,0] op_sel_hi:[0,1]
    v_pk_fma_f32 v[48:49], v[46:47], v[40:41], v[50:51] op_sel:[1,1,0] op_sel_hi:[1,0,1] neg_lo:[1,0,0]
    v_pk_mul_f32 v[60:61], v[56:57], v[44:45] op_sel:[0,0] op_sel_hi:[0,1]
    v_pk_fma_f32 v[58:59], v[56:57], v[44:45], v[60:61] op_sel:[1,1,0] op_sel_hi:[1,0,1] neg_lo:[1,0,0]
    v_pk_mul_f32 v[62:63], v[56:57], v[42:43] op_sel:[0,0] op_sel_hi:[0,1]
    v_pk_fma_f32 v[54:55], v[56:57], v[42:43], v[62:63] op_sel:[1,1,0] op_sel_hi:[1,0,1] neg_lo:[1,0,0]
    v_cvt_pk_f16_f32 v80, v48, v49
    ds_write2_b32 v8, v93, v80 offset0:16 offset1:20
    v_cvt_pk_f16_f32 v81, v58, v59
    ds_write2_b32 v2, v94, v81 offset0:48 offset1:52
    v_cvt_pk_f16_f32 v82, v54, v55
    s_cmp_lg_u32 s39, 2
    s_cbranch_scc1 K1_GP_3
    buffer_load_dwordx2 v[152:153], v150, s[8:11], s36 offen
    buffer_load_dwordx2 v[154:155], v150, s[8:11], s38 offen
    buffer_load_dwordx2 v[156:157], v150, s[8:11], s58 offen
K1_GP_3:
    v_pk_mul_f32 v[50:51], v[48:49], v[40:41] op_sel:[0,0] op_sel_hi:[0,1]
    v_pk_fma_f32 v[46:47], v[48:49], v[40:41], v[50:51] op_sel:[1,1,0] op_sel_hi:[1,0,1] neg_lo:[1,0,0]
    v_pk_mul_f32 v[60:61], v[54:55], v[44:45] op_sel:[0,0] op_sel_hi:[0,1]
    v_pk_fma_f32 v[58:59], v[54:55], v[44:45], v[60:61] op_sel:[1,1,0] op_sel_hi:[1,0,1] neg_lo:[1,0,0]
    v_pk_mul_f32 v[62:63], v[54:55], v[42:43] op_sel:[0,0] op_sel_hi:[0,1]
    v_pk_fma_f32 v[56:57], v[54:55], v[42:43], v[62:63] op_sel:[1,1,0] op_sel_hi:[1,0,1] neg_lo:[1,0,0]
    v_cvt_pk_f16_f32 v83, v46, v47
    v_cvt_pk_f16_f32 v84, v58, v59
    v_cvt_pk_f16_f32 v85, v56, v57
    ds_write2_b32 v2, v82, v85 offset0:24 offset1:28
    v_pk_mul_f32 v[50:51], v[46:47], v[40:41] op_sel:[0,0] op_sel_hi:[0,1]
    v_pk_fma_f32 v[48:49], v[46:47], v[40:41], v[50:51] op_sel:[1,1,0] op_sel_hi:[1,0,1] neg_lo:[1,0,0]
    v_pk_mul_f32 v[60:61], v[56:57], v[44:45] op_sel:[0,0] op_sel_hi:[0,1]
    v_pk_fma_f32 v[58:59], v[56:57], v[44:45], v[60:61] op_sel:[1,1,0] op_sel_hi:[1,0,1] neg_lo:[1,0,0]
    v_cvt_pk_f16_f32 v86, v48, v49
    ds_write2_b32 v8, v83, v86 offset0:24 offset1:28
    v_cvt_pk_f16_f32 v87, v58, v59
    ds_write2_b32 v2, v84, v87 offset0:56 offset1:60
    v_pk_mul_f32 v[50:51], v[48:49], v[40:41] op_sel:[0,0] op_sel_hi:[0,1]
    v_pk_fma_f32 v[46:47], v[48:49], v[40:41], v[50:51] op_sel:[1,1,0] op_sel_hi:[1,0,1] neg_lo:[1,0,0]
    v_cvt_pk_f16_f32 v88, v46, v47
    v_pk_mul_f32 v[50:51], v[46:47], v[40:41] op_sel:[0,0] op_sel_hi:[0,1]
    v_pk_fma_f32 v[48:49], v[46:47], v[40:41], v[50:51] op_sel:[1,1,0] op_sel_hi:[1,0,1] neg_lo:[1,0,0]
    v_cvt_pk_f16_f32 v89, v48, v49
    ds_write2_b32 v8, v88, v89 offset0:32 offset1:36
    v_pk_mul_f32 v[50:51], v[48:49], v[40:41] op_sel:[0,0] op_sel_hi:[0,1]
    v_pk_fma_f32 v[46:47], v[48:49], v[40:41], v[50:51] op_sel:[1,1,0] op_sel_hi:[1,0,1] neg_lo:[1,0,0]
    v_cvt_pk_f16_f32 v90, v46, v47
    v_pk_mul_f32 v[50:51], v[46:47], v[40:41] op_sel:[0,0] op_sel_hi:[0,1]
    v_pk_fma_f32 v[48:49], v[46:47], v[40:41], v[50:51] op_sel:[1,1,0] op_sel_hi:[1,0,1] neg_lo:[1,0,0]
    v_cvt_pk_f16_f32 v91, v48, v49
    ds_write2_b32 v8, v90, v91 offset0:40 offset1:44
    v_pk_mul_f32 v[50:51], v[48:49], v[40:41] op_sel:[0,0] op_sel_hi:[0,1]
    v_pk_fma_f32 v[46:47], v[48:49], v[40:41], v[50:51] op_sel:[1,1,0] op_sel_hi:[1,0,1] neg_lo:[1,0,0]
    v_cvt_pk_f16_f32 v92, v46, v47
    v_pk_mul_f32 v[50:51], v[46:47], v[40:41] op_sel:[0,0] op_sel_hi:[0,1]
    v_pk_fma_f32 v[48:49], v[46:47], v[40:41], v[50:51] op_sel:[1,1,0] op_sel_hi:[1,0,1] neg_lo:[1,0,0]
    v_cvt_pk_f16_f32 v93, v48, v49
    ds_write2_b32 v8, v92, v93 offset0:48 offset1:52
    v_pk_mul_f32 v[50:51], v[48:49], v[40:41] op_sel:[0,0] op_sel_hi:[0,1]
    v_pk_fma_f32 v[46:47], v[48:49], v[40:41], v[50:51] op_sel:[1,1,0] op_sel_hi:[1,0,1] neg_lo:[1,0,0]
    v_cvt_pk_f16_f32 v94, v46, v47
    v_pk_mul_f32 v[50:51], v[46:47], v[40:41] op_sel:[0,0] op_sel_hi:[0,1]
    v_pk_fma_f32 v[48:49], v[46:47], v[40:41], v[50:51] op_sel:[1,1,0] op_sel_hi:[1,0,1] neg_lo:[1,0,0]
    v_cvt_pk_f16_f32 v95, v48, v49
    ds_write2_b32 v8, v94, v95 offset0:56 offset1:60
    s_branch K1_HJ
K1_H1:
    v_mul_f32 v72, 2.0, v32
    v_mul_f32 v73, 2.0, v33
    v_fract_f32 v73, v73
    v_exp_f32 v72, v72
    v_cos_f32 v74, v73
    v_sin_f32 v75, v73
    v_mul_f32 v40, v72, v74
    v_mul_f32 v41, -v72, v75
    v_mul_f32 v76, 0x43000000, v32
    v_mul_f32 v77, 0x43000000, v33
    v_fract_f32 v77, v77
    v_exp_f32 v76, v76
    v_cos_f32 v78, v77
    v_sin_f32 v79, v77
    v_mul_f32 v42, v76, v78
    v_mul_f32 v43, -v76, v79
    v_pk_mul_f32 v[60:61], v[40:41], v[40:41] op_sel:[0,0] op_sel_hi:[0,1]
    v_pk_fma_f32 v[44:45], v[40:41], v[40:41], v[60:61] op_sel:[1,1,0] op_sel_hi:[1,0,1] neg_lo:[1,0,0]
    v_pk_mul_f32 v[62:63], v[42:43], v[42:43] op_sel:[0,0] op_sel_hi:[0,1]
    v_pk_fma_f32 v[48:49], v[42:43], v[42:43], v[62:63] op_sel:[1,1,0] op_sel_hi:[1,0,1] neg_lo:[1,0,0]
    v_pk_mul_f32 v[60:61], v[44:45], v[40:41] op_sel:[0,0] op_sel_hi:[0,1]
    v_pk_fma_f32 v[46:47], v[44:45], v[40:41], v[60:61] op_sel:[1,1,0] op_sel_hi:[1,0,1] neg_lo:[1,0,0]
    v_pk_mul_f32 v[62:63], v[48:49], v[42:43] op_sel:[0,0] op_sel_hi:[0,1]
    v_pk_fma_f32 v[50:51], v[48:49], v[42:43], v[62:63] op_sel:[1,1,0] op_sel_hi:[1,0,1] neg_lo:[1,0,0]
    v_pk_mul_f32 v[60:61], v[48:49], v[48:49] op_sel:[0,0] op_sel_hi:[0,1]
    v_pk_fma_f32 v[52:53], v[48:49], v[48:49], v[60:61] op_sel:[1,1,0] op_sel_hi:[1,0,1] neg_lo:[1,0,0]
    v_pk_mul_f32 v[62:63], v[52:53], v[52:53] op_sel:[0,0] op_sel_hi:[0,1]
    v_pk_fma_f32 v[54:55], v[52:53], v[52:53], v[62:63] op_sel:[1,1,0] op_sel_hi:[1,0,1] neg_lo:[1,0,0]
    s_cmp_lg_u32 s39, 1
    s_cbranch_scc1 K1_GP_4
    buffer_load_dwordx2 v[152:153], v150, s[8:11], s36 offen
    buffer_load_dwordx2 v[154:155], v150, s[8:11], s38 offen
    buffer_load_dwordx2 v[156:157], v150, s[8:11], s58 offen
K1_GP_4:
    v_cvt_pk_f16_f32 v80, v54, v55
    v_cvt_pk_f16_f32 v81, v48, v49
    v_pk_mul_f32 v[60:61], v[48:49], v[40:41] op_sel:[0,0] op_sel_hi:[0,1]
    v_pk_fma_f32 v[66:67], v[48:49], v[40:41], v[60:61] op_sel:[1,1,0] op_sel_hi:[1,0,1] neg_lo:[1,0,0]
    v_pk_mul_f32 v[58:59], v[54:55], v[42:43] op_sel:[0,0] op_sel_hi:[0,1]
    v_pk_fma_f32 v[56:57], v[54:55], v[42:43], v[58:59] op_sel:[1,1,0] op_sel_hi:[1,0,1] neg_lo:[1,0,0]
    v_cvt_pk_f16_f32 v82, v56, v57
    ds_write2_b32 v2, v80, v82 offset0:0 offset1:4
    v_cvt_pk_f16_f32 v83, v66, v67
    ds_write2_b32 v8, v81, v83 offset0:0 offset1:4
    v_pk_mul_f32 v[60:61], v[48:49], v[44:45] op_sel:[0,0] op_sel_hi:[0,1]
    v_pk_fma_f32 v[66:67], v[48:49], v[44:45], v[60:61] op_sel:[1,1,0] op_sel_hi:[1,0,1] neg_lo:[1,0,0]
    v_pk_mul_f32 v[58:59], v[56:57], v[42:43] op_sel:[0,0] op_sel_hi:[0,1]
    v_pk_fma_f32 v[54:55], v[56:57], v[42:43], v[58:59] op_sel:[1,1,0] op_sel_hi:[1,0,1] neg_lo:[1,0,0]
    v_cvt_pk_f16_f32 v84, v54, v55
    v_cvt_pk_f16_f32 v85, v66, v67
    v_pk_mul_f32 v[60:61], v[48:49], v[46:47] op_sel:[0,0] op_sel_hi:[0,1]
    v_pk_fma_f32 v[66:67], v[48:49], v[46:47], v[60:61] op_sel:[1,1,0] op_sel_hi:[1,0,1] neg_lo:[1,0,0]
    v_pk_mul_f32 v[58:59], v[54:55], v[42:43] op_sel:[0,0] op_sel_hi:[0,1]
    v_pk_fma_f32 v[56:57], v[54:55], v[42:43], v[58:59] op_sel:[1,1,0] op_sel_hi:[1,0,1] neg_lo:[1,0,0]
    v_cvt_pk_f16_f32 v86, v56, v57
    ds_write2_b32 v2, v84, v86 offset0:8 offset1:12
    v_cvt_pk_f16_f32 v87, v66, v67
    ds_write2_b32 v8, v85, v87 offset0:8 offset1:12
    v_cvt_pk_f16_f32 v88, v50, v51
    v_pk_mul_f32 v[60:61], v[50:51], v[40:41] op_sel:[0,0] op_sel_hi:[0,1]
    v_pk_fma_f32 v[66:67], v[50:51], v[40:41], v[60:61] op_sel:[1,1,0] op_sel_hi:[1,0,1] neg_lo:[1,0,0]
    v_pk_mul_f32 v[58:59], v[56:57], v[42:43] op_sel:[0,0] op_sel_hi:[0,1]
    v_pk_fma_f32 v[54:55], v[56:57], v[42:43], v[58:59] op_sel:[1,1,0] op_sel_hi:[1,0,1] neg_lo:[1,0,0]
    v_cvt_pk_f16_f32 v89, v54, v55
    v_cvt_pk_f16_f32 v90, v66, v67
    ds_write2_b32 v8, v88, v90 offset0:16 offset1:20
    v_pk_mul_f32 v[60:61], v[50:51], v[44:45] op_sel:[0,0] op_sel_hi:[0,1]
    v_pk_fma_f32 v[66:67], v[50:51], v[44:45], v[60:61] op_sel:[1,1,0] op_sel_hi:[1,0,1] neg_lo:[1,0,0]
    v_pk_mul_f32 v[58:59], v[54:55], v[42:43] op_sel:[0,0] op_sel_hi:[0,1]
    v_pk_fma_f32 v[56:57], v[54:55], v[42:43], v[58:59] op_sel:[1,1,0] op_sel_hi:[1,0,1] neg_lo:[1,0,0]
    v_cvt_pk_f16_f32 v91, v56, v57
    ds_write2_b32 v2, v89, v91 offset0:16 offset1:20
    v_cvt_pk_f16_f32 v92, v66, v67
    v_pk_mul_f32 v[60:61], v[50:51], v[46:47] op_sel:[0,0] op_sel_hi:[0,1]
    v_pk_fma_f32 v[66:67], v[50:51], v[46:47], v[60:61] op_sel:[1,1,0] op_sel_hi:[1,0,1] neg_lo:[1,0,0]
    v_pk_mul_f32 v[58:59], v[56:57], v[42:43] op_sel:[0,0] op_sel_hi:[0,1]
    v_pk_fma_f32 v[54:55], v[56:57], v[42:43], v[58:59] op_sel:[1,1,0] op_sel_hi:[1,0,1] neg_lo:[1,0,0]
    v_cvt_pk_f16_f32 v93, v54, v55
    v_cvt_pk_f16_f32 v94, v66, v67
    ds_write2_b32 v8, v92, v94 offset0:24 offset1:28
    s_cmp_lg_u32 s39, 2
    s_cbranch_scc1 K1_GP_5
    buffer_load_dwordx2 v[152:153], v150, s[8:11], s36 offen
    buffer_load_dwordx2 v[154:155], v150, s[8:11], s38 offen
    buffer_load_dwordx2 v[156:157], v150, s[8:11], s58 offen
K1_GP_5:
    v_pk_mul_f32 v[60:61], v[52:53], v[44:45] op_sel:[0,0] op_sel_hi:[0,1]
    v_pk_fma_f32 v[66:67], v[52:53], v[44:45], v[60:61] op_sel:[1,1,0] op_sel_hi:[1,0,1] neg_lo:[1,0,0]
    v_pk_mul_f32 v[62:63], v[52:53], v[42:43] op_sel:[0,0] op_sel_hi:[0,1]
    v_pk_fma_f32 v[64:65], v[52:53], v[42:43], v[62:63] op_sel:[1,1,0] op_sel_hi:[1,0,1] neg_lo:[1,0,0]
    v_cvt_pk_f16_f32 v95, v52, v53
    v_pk_mul_f32 v[58:59], v[54:55], v[42:43] op_sel:[0,0] op_sel_hi:[0,1]
    v_pk_fma_f32 v[56:57], v[54:55], v[42:43], v[58:59] op_sel:[1,1,0] op_sel_hi:[1,0,1] neg_lo:[1,0,0]
    v_cvt_pk_f16_f32 v80, v56, v57
    ds_write2_b32 v2, v93, v80 offset0:24 offset1:28
    v_cvt_pk_f16_f32 v81, v66, v67
    ds_write2_b32 v8, v95, v81 offset0:32 offset1:36
    v_pk_mul_f32 v[60:61], v[64:65], v[44:45] op_sel:[0,0] op_sel_hi:[0,1]
    v_pk_fma_f32 v[66:67], v[64:65], v[44:45], v[60:61] op_sel:[1,1,0] op_sel_hi:[1,0,1] neg_lo:[1,0,0]
    v_pk_mul_f32 v[62:63], v[64:65], v[42:43] op_sel:[0,0] op_sel_hi:[0,1]
    v_pk_fma_f32 v[68:69], v[64:65], v[42:43], v[62:63] op_sel:[1,1,0] op_sel_hi:[1,0,1] neg_lo:[1,0,0]
    v_cvt_pk_f16_f32 v82, v64, v65
    v_pk_mul_f32 v[58:59], v[56:57], v[42:43] op_sel:[0,0] op_sel_hi:[0,1]
    v_pk_fma_f32 v[54:55], v[56:57], v[42:43], v[58:59] op_sel:[1,1,0] op_sel_hi:[1,0,1] neg_lo:[1,0,0]
    v_cvt_pk_f16_f32 v83, v54, v55
    v_cvt_pk_f16_f32 v84, v66, v67
    ds_write2_b32 v8, v82, v84 offset0:40 offset1:44
    v_pk_mul_f32 v[60:61], v[68:69], v[44:45] op_sel:[0,0] op_sel_hi:[0,1]
    v_pk_fma_f32 v[66:67], v[68:69], v[44:45], v[60:61] op_sel:[1,1,0] op_sel_hi:[1,0,1] neg_lo:[1,0,0]
    v_pk_mul_f32 v[62:63], v[68:69], v[42:43] op_sel:[0,0] op_sel_hi:[0,1]
    v_pk_fma_f32 v[64:65], v[68:69], v[42:43], v[62:63] op_sel:[1,1,0] op_sel_hi:[1,0,1] neg_lo:[1,0,0]
    v_cvt_pk_f16_f32 v85, v68, v69
    v_cvt_pk_f16_f32 v86, v66, v67
    ds_write2_b32 v8, v85, v86 offset0:48 offset1:52
    v_pk_mul_f32 v[60:61], v[64:65], v[44:45] op_sel:[0,0] op_sel_hi:[0,1]
    v_pk_fma_f32 v[66:67], v[64:65], v[44:45], v[60:61] op_sel:[1,1,0] op_sel_hi:[1,0,1] neg_lo:[1,0,0]
    v_cvt_pk_f16_f32 v87, v64, v65
    v_cvt_pk_f16_f32 v88, v66, v67
    ds_write2_b32 v8, v87, v88 offset0:56 offset1:60
    ds_write_b32 v2, v83 offset:128
K1_HJ:
    s_waitcnt lgkmcnt(0)
    s_barrier
    s_cmp_eq_u32 s27, 3
    s_cbranch_scc1 K1_KG_Z
    s_mul_i32 s28, s27, 8704
    s_add_u32 s28, s28, 8704
    v_add_u32 v7, s28, v9
    ds_read_b128 v[36:39], v7 offset:0
    ds_read_b128 v[68:71], v9 offset:0
    ds_read_b128 v[40:43], v7 offset:1088
    ds_read_b128 v[72:75], v9 offset:1088
    ds_read_b128 v[44:47], v7 offset:2176
    ds_read_b128 v[76:79], v9 offset:2176
    ds_read_b128 v[48:51], v7 offset:3264
    ds_read_b128 v[80:83], v9 offset:3264
    ds_read_b128 v[52:55], v7 offset:4352
    ds_read_b128 v[84:87], v9 offset:4352
    ds_read_b128 v[56:59], v7 offset:5440
    ds_read_b128 v[88:91], v9 offset:5440
    ds_read_b128 v[60:63], v7 offset:6528
    ds_read_b128 v[92:95], v9 offset:6528
    ds_read_b128 v[64:67], v7 offset:7616
    ds_read_b128 v[96:99], v9 offset:7616
    s_waitcnt lgkmcnt(14)
    v_mfma_f32_16x16x32_f16 v[128:131], v[36:39], v[68:71], 0
    s_waitcnt lgkmcnt(12)
    v_mfma_f32_16x16x32_f16 v[132:135], v[40:43], v[72:75], 0
    s_waitcnt lgkmcnt(10)
    v_mfma_f32_16x16x32_f16 v[128:131], v[44:47], v[76:79], v[128:131]
    s_waitcnt lgkmcnt(8)
    v_mfma_f32_16x16x32_f16 v[132:135], v[48:51], v[80:83], v[132:135]
    s_waitcnt lgkmcnt(6)
    v_mfma_f32_16x16x32_f16 v[128:131], v[52:55], v[84:87], v[128:131]
    s_waitcnt lgkmcnt(4)
    v_mfma_f32_16x16x32_f16 v[132:135], v[56:59], v[88:91], v[132:135]
    s_waitcnt lgkmcnt(2)
    v_mfma_f32_16x16x32_f16 v[128:131], v[60:63], v[92:95], v[128:131]
    s_waitcnt lgkmcnt(0)
    v_mfma_f32_16x16x32_f16 v[132:135], v[64:67], v[96:99], v[132:135]
    s_nop 7
    v_add_f32 v128, v128, v132
    v_ldexp_f32 v128, v128, v26
    ds_write_b32 v140, v128 offset:48160
    v_add_f32 v129, v129, v133
    v_ldexp_f32 v129, v129, v26
    ds_write_b32 v141, v129 offset:48160
    v_add_f32 v130, v130, v134
    v_ldexp_f32 v130, v130, v26
    ds_write_b32 v142, v130 offset:48160
    v_add_f32 v131, v131, v135
    v_ldexp_f32 v131, v131, v26
    ds_write_b32 v143, v131 offset:48160
    s_branch K1_KG_X
K1_KG_Z:
K1_KG_X:
    v_mov_b32 v112, 0
    v_mov_b32 v113, 0
    v_mov_b32 v114, 0
    v_mov_b32 v115, 0
    v_mov_b32 v116, 0
    v_mov_b32 v117, 0
    v_mov_b32 v118, 0
    v_mov_b32 v119, 0
    v_mov_b32 v120, 0
    v_mov_b32 v121, 0
    v_mov_b32 v122, 0
    v_mov_b32 v123, 0
    s_waitcnt vmcnt(0)
    v_lshrrev_b64 v[152:153], s37, v[152:153]
    ds_write_b16 v151, v152 offset:44064
    ds_write_b16_d16_hi v158, v152 offset:44064
    ds_write_b16 v159, v153 offset:44064
    v_lshrrev_b64 v[154:155], s37, v[154:155]
    ds_write_b16 v151, v154 offset:45600
    ds_write_b16_d16_hi v158, v154 offset:45600
    ds_write_b16 v159, v155 offset:45600
    s_cmp_ge_u32 s35, 2
    s_cbranch_scc1 K1_XS_8
    v_lshrrev_b64 v[156:157], s37, v[156:157]
    ds_write_b16 v151, v156 offset:47136
    ds_write_b16_d16_hi v158, v156 offset:47136
    ds_write_b16 v159, v157 offset:47136
K1_XS_8:
    s_waitcnt lgkmcnt(0)
    s_barrier
    v_mov_b32 v7, 0
    buffer_load_dword v9, v7, s[48:51], 0 offen offset:0 sc1
    s_cmp_ge_u32 s88, 2
    s_cbranch_scc1 K1_FG
    s_cmp_eq_u32 s88, 1
    s_cbranch_scc1 K1_FG1
    s_mov_b32 exec_lo, 0xffff8008
    s_mov_b32 exec_hi, 0xffffffff
    ds_read_b32 v112, v100 offset:48160
    ds_read_b32 v113, v101 offset:48160
    ds_read_b32 v114, v102 offset:48160
    ds_read_b32 v115, v103 offset:48160
    s_mov_b32 exec_lo, 0xffff800c
    s_mov_b32 exec_hi, 0xffffffff
    ds_read_b32 v116, v104 offset:48160
    s_mov_b32 exec_lo, 0xffff8004
    s_mov_b32 exec_hi, 0xffffffff
    ds_read_b32 v117, v105 offset:48160
    s_mov_b32 exec_lo, 0xffffc004
    s_mov_b32 exec_hi, 0xffffffff
    ds_read_b32 v118, v106 offset:48160
    ds_read_b32 v119, v107 offset:48160
    ds_read_b32 v120, v108 offset:48160
    ds_read_b32 v121, v109 offset:48160
    ds_read_b32 v122, v110 offset:48160
    ds_read_b32 v123, v111 offset:48160
    s_mov_b64 exec, -1
    s_branch K1_FG
K1_FG1:
    s_mov_b32 exec_lo, 0x1c79ffff
    s_mov_b32 exec_hi, 0x1fc7f9c7
    ds_read_b32 v112, v100 offset:48160
    s_mov_b32 exec_lo, 0x9e79ffff
    s_mov_b32 exec_hi, 0x1fe7f9e7
    ds_read_b32 v113, v101 offset:48160
    ds_read_b32 v114, v102 offset:48160
    ds_read_b32 v115, v103 offset:48160
    s_mov_b32 exec_lo, 0x9e78ffff
    s_mov_b32 exec_hi, 0x1fe7f9e7
    ds_read_b32 v116, v104 offset:48160
    ds_read_b32 v117, v105 offset:48160
    ds_read_b32 v118, v106 offset:48160
    ds_read_b32 v119, v107 offset:48160
    s_mov_b32 exec_lo, 0x8e3cffff
    s_mov_b32 exec_hi, 0xfe3f8e3
    ds_read_b32 v120, v108 offset:48160
    s_mov_b32 exec_lo, 0xcf3cffff
    s_mov_b32 exec_hi, 0xfe3f8f3
    ds_read_b32 v121, v109 offset:48160
    ds_read_b32 v122, v110 offset:48160
    ds_read_b32 v123, v111 offset:48160
    s_mov_b64 exec, -1
K1_FG:
    ds_read_b64 v[10:11], v23 offset:44064
    ds_read_b64 v[12:13], v23 offset:44576
    v_mov_b32 v84, 0
    v_mov_b32 v85, 0
    v_mov_b32 v86, 0
    v_mov_b32 v87, 0
    ds_write_b128 v15, v[84:87]
    s_lshl_b32 s38, s27, 12
    s_add_u32 s38, s38, 512
    s_cmp_ge_u32 s88, 2
    s_cbranch_scc1 K1_FC
    s_waitcnt lgkmcnt(3)
    v_cvt_pk_bf16_f32 v40, v112, v113
    v_cvt_pk_bf16_f32 v41, v114, v115
    v_cvt_pk_bf16_f32 v42, v116, v117
    v_cvt_pk_bf16_f32 v43, v118, v119
    v_cvt_pk_bf16_f32 v44, v120, v121
    v_cvt_pk_bf16_f32 v45, v122, v123
    v_mov_b32 v48, v41
    v_mov_b32 v49, v42
    v_mov_b32 v50, v43
    v_mov_b32 v51, v44
    v_alignbit_b32 v52, v41, v40, 16
    v_alignbit_b32 v53, v42, v41, 16
    v_alignbit_b32 v54, v43, v42, 16
    v_alignbit_b32 v55, v44, v43, 16
    v_alignbit_b32 v56, v42, v41, 16
    v_alignbit_b32 v57, v43, v42, 16
    v_alignbit_b32 v58, v44, v43, 16
    v_alignbit_b32 v59, v45, v44, 16
    ds_write_b128 v5, v[56:59] offset:0
    ds_write_b128 v5, v[48:51] offset:2112
    ds_write_b128 v5, v[52:55] offset:4224
    ds_write_b128 v5, v[40:43] offset:6336
K1_FC:
    v_lshl_add_u32 v162, v0, 3, s34
    v_lshrrev_b32 v166, 1, v3
    v_and_b32 v167, 1, v3
    v_mul_u32_u24 v163, 5256, v166
    v_lshl_add_u32 v163, v167, 7, v163
    v_and_b32 v164, 15, v1
    v_lshl_add_u32 v163, v164, 3, v163
    s_add_u32 s28, s34, 8464
    v_add_u32 v163, s28, v163
    v_and_b32 v164, 3, v4
    v_mul_u32_u24 v164, 2112, v164
    v_lshrrev_b32 v165, 2, v4
    v_lshlrev_b32 v165, 3, v165
    v_sub_u32 v164, v164, v165
    v_lshl_add_u32 v164, v167, 3, v164
    v_mul_u32_u24 v165, 96, v166
    v_add_u32 v164, v164, v165
    s_add_u32 s28, s34, 24
    v_add_u32 v164, s28, v164
    v_lshl_add_u32 v165, v166, 6, v164
    s_waitcnt vmcnt(0)
    v_readfirstlane_b32 s36, v9
    s_nop 0
    s_cmp_lt_u32 s36, 64
    s_cbranch_scc1 K1_NG1
    s_cmp_lg_u32 s32, s39
    s_cbranch_scc1 K1_XL_9
    s_lshl_b32 s28, s27, 10
    s_add_u32 s29, s28, s34
    v_subrev_u32 v60, s29, v23
    s_lshr_b32 s29, s33, 6
    s_lshl_b32 s29, s29, 13
    s_lshl_b32 s28, s28, 1
    s_add_u32 s29, s29, s28
    s_add_u32 s29, s29, 3146240
    s_waitcnt lgkmcnt(0)
    buffer_load_dwordx2 v[10:11], v60, s[12:15], s29 offen sc1
    buffer_load_dwordx2 v[12:13], v60, s[12:15], s29 offen offset:1024 sc1
K1_XL_9:
    buffer_load_dwordx4 v[24:27], v22, s[12:15], s38 offen sc1
    buffer_load_dwordx4 v[28:31], v22, s[12:15], s38 offen offset:2048 sc1
    s_branch K1_NG2
K1_NG1:
    buffer_load_dword v9, v7, s[48:51], 0 offen offset:0 sc1
K1_NG2:
    s_mov_b32 s8, s84
    s_and_b32 s9, s85, 0xffff
    s_mov_b32 s10, 0x1200000
    s_mov_b32 s11, 0x00020000
    s_and_b32 s80, s2, 7
    s_sub_u32 s90, s2, 64
    s_lshr_b32 s90, s90, 3
    s_mul_i32 s81, s90, 12
    s_add_u32 s81, s81, s59
    s_mul_i32 s82, s80, 576
    s_lshl_b32 s83, s81, 1
    s_add_u32 s82, s82, s83
    s_lshr_b32 s83, s82, 9
    s_and_b32 s82, s82, 511
    s_lshl_b32 s82, s82, 2
    v_lshrrev_b32 v2, 4, v1
    v_and_b32 v6, 15, v1
    v_lshlrev_b32 v6, 4, v6
    v_mul_u32_u24 v166, 9216, v2
    v_add_u32 v166, v166, v6
    v_mul_u32_u24 v2, 4608, v2
    v_add_u32 v2, v2, v6
    s_mul_i32 s86, s82, 9216
    s_lshl_b32 s87, s83, 10
    s_add_u32 s86, s86, s87
    s_add_u32 s86, s86, 256
    s_mul_i32 s89, s82, 4608
    s_lshl_b32 s87, s83, 9
    s_add_u32 s89, s89, s87
    s_add_u32 s89, s89, 22085632
    s_add_u32 s26, s86, 36864
    s_lshr_b32 s82, s80, 1
    s_lshl_b32 s82, s82, 4
    s_mov_b32 s83, 0x33214320
    s_cmp_ge_u32 s82, 32
    s_cselect_b32 s83, 0x43104210, s83
    s_and_b32 s82, s82, 16
    s_lshr_b32 s83, s83, s82
    v_bfe_u32 v167, v1, 1, 2
    v_lshlrev_b32 v167, 2, v167
    v_lshrrev_b32 v167, v167, s83
    v_and_b32 v167, 15, v167
    s_mul_i32 s82, s80, 4617
    s_lshr_b32 s82, s82, 10
    v_add_u32 v167, s82, v167
    v_lshrrev_b32 v6, 3, v1
    v_mul_u32_u24 v6, 9216, v6
    v_lshl_add_u32 v6, v167, 8, v6
    v_and_b32 v167, 1, v1
    v_lshl_add_u32 v6, v167, 7, v6
    s_mul_i32 s81, s59, 24
    s_add_u32 s81, s81, s90
    s_mul_i32 s82, s81, 73728
    s_add_u32 s82, s82, 14155776
    s_mov_b32 s87, 0
    s_cmp_ge_u32 s36, 64
    s_cbranch_scc1 K1_GO2
K1_POLL:
    s_waitcnt vmcnt(0)
    v_readfirstlane_b32 s36, v9
    s_nop 0
    s_cmp_ge_u32 s36, 64
    s_cbranch_scc1 K1_GO
    s_sleep 1
    buffer_load_dword v9, v7, s[48:51], 0 offen offset:0 sc1
    s_branch K1_POLL
K1_GO:
    s_cmp_lg_u32 s32, s39
    s_cbranch_scc1 K1_XL_10
    s_lshl_b32 s28, s27, 10
    s_add_u32 s29, s28, s34
    v_subrev_u32 v60, s29, v23
    s_lshr_b32 s29, s33, 6
    s_lshl_b32 s29, s29, 13
    s_lshl_b32 s28, s28, 1
    s_add_u32 s29, s29, s28
    s_add_u32 s29, s29, 3146240
    s_waitcnt lgkmcnt(0)
    buffer_load_dwordx2 v[10:11], v60, s[12:15], s29 offen sc1
    buffer_load_dwordx2 v[12:13], v60, s[12:15], s29 offen offset:1024 sc1
K1_XL_10:
    buffer_load_dwordx4 v[24:27], v22, s[12:15], s38 offen sc1
    buffer_load_dwordx4 v[28:31], v22, s[12:15], s38 offen offset:2048 sc1
K1_GO2:
    s_waitcnt lgkmcnt(0)
    s_waitcnt vmcnt(1)
    v_lshlrev_b32 v32, 16, v10
    v_and_b32 v33, 0xffff0000, v10
    v_lshlrev_b32 v34, 16, v11
    v_and_b32 v35, 0xffff0000, v11
    v_and_b32 v40, 0xffff0000, v24
    v_lshlrev_b32 v36, 16, v24
    v_rcp_f32 v40, v40
    v_sub_f32 v32, v32, v36
    v_and_b32 v41, 0xffff0000, v25
    v_lshlrev_b32 v37, 16, v25
    v_rcp_f32 v41, v41
    v_sub_f32 v33, v33, v37
    v_and_b32 v42, 0xffff0000, v26
    v_lshlrev_b32 v38, 16, v26
    v_rcp_f32 v42, v42
    v_sub_f32 v34, v34, v38
    v_and_b32 v43, 0xffff0000, v27
    v_lshlrev_b32 v39, 16, v27
    v_rcp_f32 v43, v43
    v_sub_f32 v35, v35, v39
    v_cvt_pk_bf16_f32 v36, v32, v33
    v_cvt_pk_bf16_f32 v37, v34, v35
    v_lshlrev_b32 v32, 16, v36
    v_and_b32 v33, 0xffff0000, v36
    v_lshlrev_b32 v34, 16, v37
    v_and_b32 v35, 0xffff0000, v37
    v_mul_f32 v32, v32, v40
    v_mul_f32 v33, v33, v41
    v_mul_f32 v34, v34, v42
    v_mul_f32 v35, v35, v43
    v_cvt_pk_bf16_f32 v16, v32, v33
    v_cvt_pk_bf16_f32 v17, v34, v35
    ds_write_b64 v23, v[16:17] offset:44064
    s_waitcnt vmcnt(0)
    v_lshlrev_b32 v32, 16, v12
    v_and_b32 v33, 0xffff0000, v12
    v_lshlrev_b32 v34, 16, v13
    v_and_b32 v35, 0xffff0000, v13
    v_and_b32 v40, 0xffff0000, v28
    v_lshlrev_b32 v36, 16, v28
    v_rcp_f32 v40, v40
    v_sub_f32 v32, v32, v36
    v_and_b32 v41, 0xffff0000, v29
    v_lshlrev_b32 v37, 16, v29
    v_rcp_f32 v41, v41
    v_sub_f32 v33, v33, v37
    v_and_b32 v42, 0xffff0000, v30
    v_lshlrev_b32 v38, 16, v30
    v_rcp_f32 v42, v42
    v_sub_f32 v34, v34, v38
    v_and_b32 v43, 0xffff0000, v31
    v_lshlrev_b32 v39, 16, v31
    v_rcp_f32 v43, v43
    v_sub_f32 v35, v35, v39
    v_cvt_pk_bf16_f32 v36, v32, v33
    v_cvt_pk_bf16_f32 v37, v34, v35
    v_lshlrev_b32 v32, 16, v36
    v_and_b32 v33, 0xffff0000, v36
    v_lshlrev_b32 v34, 16, v37
    v_and_b32 v35, 0xffff0000, v37
    v_mul_f32 v32, v32, v40
    v_mul_f32 v33, v33, v41
    v_mul_f32 v34, v34, v42
    v_mul_f32 v35, v35, v43
    v_cvt_pk_bf16_f32 v18, v32, v33
    v_cvt_pk_bf16_f32 v19, v34, v35
    ds_write_b64 v23, v[18:19] offset:44576
    v_lshl_add_u32 v5, v1, 4, s34
    v_mov_b32 v32, s34
    v_mov_b32 v33, 1
    s_waitcnt lgkmcnt(0)
    s_mov_b64 exec, 1
    ds_add_rtn_u32 v34, v32, v33 offset:51240
    s_mov_b64 exec, -1
    v_lshlrev_b32 v14, 16, v160
    v_lshlrev_b32 v60, 16, v16
    v_and_b32 v61, 0xffff0000, v16
    v_lshlrev_b32 v64, 16, v10
    v_and_b32 v65, 0xffff0000, v10
    v_lshlrev_b32 v62, 16, v17
    v_and_b32 v63, 0xffff0000, v17
    v_lshlrev_b32 v66, 16, v11
    v_and_b32 v67, 0xffff0000, v11
    v_fma_f32 v10, v60, v14, v64
    v_fma_f32 v11, v61, v14, v65
    v_fma_f32 v16, v62, v14, v66
    v_fma_f32 v17, v63, v14, v67
    v_lshlrev_b32 v60, 16, v18
    v_and_b32 v61, 0xffff0000, v18
    v_lshlrev_b32 v64, 16, v12
    v_and_b32 v65, 0xffff0000, v12
    v_lshlrev_b32 v62, 16, v19
    v_and_b32 v63, 0xffff0000, v19
    v_lshlrev_b32 v66, 16, v13
    v_and_b32 v67, 0xffff0000, v13
    v_fma_f32 v12, v60, v14, v64
    v_fma_f32 v13, v61, v14, v65
    v_fma_f32 v18, v62, v14, v66
    v_fma_f32 v19, v63, v14, v67
    s_mov_b64 exec, 1
    s_waitcnt lgkmcnt(0)
    v_readfirstlane_b32 s28, v34
    s_nop 0
    s_cmp_ge_u32 s28, 3
    s_cbranch_scc1 K1_SYDD
    s_mov_b32 s29, 0x1000000
K1_SYDL:
    ds_read_b32 v34, v32 offset:51240
    s_sub_u32 s29, s29, 1
    s_cmp_eq_u32 s29, 0
    s_cbranch_scc1 K1_SYDD
    s_waitcnt lgkmcnt(0)
    v_readfirstlane_b32 s28, v34
    s_nop 0
    s_cmp_lt_u32 s28, 4
    s_cbranch_scc1 K1_SYDL
K1_SYDD:
    s_mov_b64 exec, -1
    s_cmp_lg_u32 s27, 0
    s_cbranch_scc1 K1_OW_11
    ds_read_b64 v[112:113], v162 offset:44024
    ds_read_b64 v[114:115], v162 offset:44032
    ds_read_b64 v[116:117], v162 offset:44040
    ds_read_b64 v[118:119], v162 offset:46072
    ds_read_b64 v[120:121], v162 offset:46080
    ds_read_b64 v[122:123], v162 offset:46088
    ds_read_b64 v[32:33], v21 offset:1032
    ds_read_b64 v[34:35], v21 offset:1040
    ds_read_b128 v[36:39], v20 offset:448
    ds_read_b128 v[40:43], v20 offset:960
    ds_read_b64 v[44:45], v21 offset:776
    ds_read_b64 v[46:47], v21 offset:784
    ds_read_b128 v[48:51], v20 offset:192
    ds_read_b128 v[52:55], v20 offset:704
    buffer_load_dwordx4 v[24:27], v166, s[8:11], s86 offen
    buffer_load_dwordx4 v[28:31], v166, s[8:11], s26 offen
    s_mov_b32 s86, s89
    s_waitcnt lgkmcnt(13)
    v_lshlrev_b32 v64, 16, v112
    v_and_b32 v65, 0xffff0000, v112
    v_lshlrev_b32 v66, 16, v113
    v_and_b32 v67, 0xffff0000, v113
    s_waitcnt lgkmcnt(12)
    v_lshlrev_b32 v68, 16, v114
    ds_read_b64 v[56:57], v21 offset:520
    ds_read_b64 v[58:59], v21 offset:528
    v_and_b32 v69, 0xffff0000, v114
    v_lshlrev_b32 v70, 16, v115
    v_and_b32 v71, 0xffff0000, v115
    s_waitcnt lgkmcnt(13)
    v_lshlrev_b32 v72, 16, v116
    v_and_b32 v73, 0xffff0000, v116
    ds_read_b64 v[60:61], v21 offset:264
    ds_read_b64 v[62:63], v21 offset:272
    v_lshlrev_b32 v74, 16, v117
    v_and_b32 v75, 0xffff0000, v117
    v_add_f32 v124, v65, v66
    v_add_f32 v125, v64, v65
    v_add_f32 v126, v74, v75
    ds_read_b64 v[96:97], v21 offset:968
    ds_read_b64 v[98:99], v21 offset:976
    v_add_f32 v127, v73, v74
    v_add_f32 v92, v68, v69
    v_add_f32 v93, v70, v71
    v_add_f32 v94, v66, v67
    v_add_f32 v95, v72, v73
    ds_read_b128 v[100:103], v20 offset:384
    v_add_f32 v76, v67, v92
    v_add_f32 v77, v92, v70
    v_add_f32 v78, v69, v93
    v_add_f32 v79, v93, v72
    v_add_f32 v80, v77, v94
    ds_read_b128 v[104:107], v20 offset:896
    v_add_f32 v81, v76, v93
    v_add_f32 v82, v79, v92
    v_add_f32 v83, v78, v95
    v_cvt_pk_bf16_f32 v112, v76, v77
    v_cvt_pk_bf16_f32 v113, v78, v79
    ds_read_b64 v[108:109], v21 offset:712
    ds_read_b64 v[110:111], v21 offset:720
    ds_write_b64 v162, v[112:113] offset:13744
    v_add_f32 v84, v81, v124
    v_add_f32 v85, v82, v94
    v_add_f32 v86, v81, v95
    v_add_f32 v87, v82, v127
    ds_read_b128 v[136:139], v20 offset:128
    v_cvt_pk_bf16_f32 v114, v80, v81
    v_cvt_pk_bf16_f32 v115, v82, v83
    ds_write_b64 v162, v[114:115] offset:8480
    v_add_f32 v88, v85, v125
    v_add_f32 v89, v86, v124
    ds_read_b128 v[140:143], v20 offset:640
    v_add_f32 v90, v87, v94
    v_add_f32 v91, v86, v126
    v_cvt_pk_bf16_f32 v116, v84, v85
    v_cvt_pk_bf16_f32 v117, v86, v87
    ds_write_b64 v162, v[116:117] offset:16896
    ds_read_b64 v[144:145], v21 offset:456
    ds_read_b64 v[146:147], v21 offset:464
    v_cvt_pk_bf16_f32 v76, v88, v89
    v_cvt_pk_bf16_f32 v77, v90, v91
    ds_write_b64 v162, v[76:77] offset:11624
    s_waitcnt lgkmcnt(15)
    v_lshlrev_b32 v66, 16, v119
    v_and_b32 v67, 0xffff0000, v119
    ds_read_b64 v[148:149], v21 offset:200
    ds_read_b64 v[150:151], v21 offset:208
    v_lshlrev_b32 v68, 16, v120
    v_and_b32 v69, 0xffff0000, v120
    v_lshlrev_b32 v70, 16, v121
    v_and_b32 v71, 0xffff0000, v121
    v_lshlrev_b32 v72, 16, v122
    ds_read_b64 v[152:153], v21 offset:904
    ds_read_b64 v[154:155], v21 offset:912
    v_and_b32 v73, 0xffff0000, v122
    v_add_f32 v92, v68, v69
    v_add_f32 v93, v70, v71
    v_add_f32 v94, v66, v67
    v_add_f32 v95, v72, v73
    ds_read_b128 v[156:159], v20 offset:320
    v_add_f32 v76, v67, v92
    v_add_f32 v77, v92, v70
    v_add_f32 v78, v69, v93
    v_add_f32 v79, v93, v72
    v_add_f32 v80, v77, v94
    v_add_f32 v81, v76, v93
    v_add_f32 v82, v79, v92
    v_add_f32 v83, v78, v95
    v_cvt_pk_bf16_f32 v118, v76, v77
    v_cvt_pk_bf16_f32 v119, v78, v79
    ds_write_b64 v162, v[118:119] offset:15792
    v_cvt_pk_bf16_f32 v120, v80, v81
    v_cvt_pk_bf16_f32 v121, v82, v83
    ds_write_b64 v162, v[120:121] offset:10528
    v_mov_b32 v124, s34
    v_mov_b32 v125, 1
    s_mov_b64 exec, 1
    ds_add_u32 v124, v125 offset:51264
    s_mov_b64 exec, -1
    v_subrev_u32 v126, 192, v21
    v_mfma_f32_16x16x32_bf16 v[128:131], v[32:35], v[36:39], 0
    ds_read_b128 v[64:67], v20 offset:832
    ds_read_b64 v[68:69], v21 offset:648
    ds_read_b64 v[70:71], v21 offset:656
    v_mfma_f32_16x16x32_bf16 v[132:135], v[32:35], v[40:43], 0
    ds_read_b128 v[72:75], v20 offset:64
    ds_read_b128 v[76:79], v20 offset:576
    v_mfma_f32_16x16x32_bf16 v[128:131], v[44:47], v[48:51], v[128:131]
    ds_read_b64 v[80:81], v21 offset:392
    ds_read_b64 v[82:83], v21 offset:400
    ds_read_b64 v[84:85], v21 offset:136
    ds_read_b64 v[86:87], v21 offset:144
    v_mfma_f32_16x16x32_bf16 v[132:135], v[44:47], v[52:55], v[132:135]
    ds_read_b64 v[88:89], v21 offset:840
    ds_read_b64 v[90:91], v21 offset:848
    ds_read_b128 v[92:95], v20 offset:256
    v_mfma_f32_16x16x32_bf16 v[132:135], v[56:59], v[36:39], v[132:135]
    ds_read_b128 v[112:115], v20 offset:768
    ds_read_b64 v[116:117], v21 offset:584
    ds_read_b64 v[118:119], v21 offset:592
    s_waitcnt lgkmcnt(15)
    v_mfma_f32_16x16x32_bf16 v[132:135], v[60:63], v[48:51], v[132:135]
    ds_read_b128 v[120:123], v20 offset:0
    ds_read_b128 v[32:35], v20 offset:512
    v_mfma_f32_16x16x32_bf16 v[128:131], v[96:99], v[100:103], v[128:131]
    ds_read_b64 v[40:41], v21 offset:328
    ds_read_b64 v[42:43], v21 offset:336
    ds_read_b64 v[44:45], v21 offset:72
    ds_read_b64 v[46:47], v21 offset:80
    v_mfma_f32_16x16x32_bf16 v[132:135], v[96:99], v[104:107], v[132:135]
    v_mfma_f32_16x16x32_bf16 v[128:131], v[108:111], v[136:139], v[128:131]
    v_mfma_f32_16x16x32_bf16 v[132:135], v[108:111], v[140:143], v[132:135]
    v_mfma_f32_16x16x32_bf16 v[132:135], v[144:147], v[100:103], v[132:135]
    v_mfma_f32_16x16x32_bf16 v[132:135], v[148:151], v[136:139], v[132:135]
    v_mfma_f32_16x16x32_bf16 v[128:131], v[152:155], v[156:159], v[128:131]
    s_waitcnt lgkmcnt(15)
    v_mfma_f32_16x16x32_bf16 v[132:135], v[152:155], v[64:67], v[132:135]
    v_mfma_f32_16x16x32_bf16 v[128:131], v[68:71], v[72:75], v[128:131]
    v_mfma_f32_16x16x32_bf16 v[132:135], v[68:71], v[76:79], v[132:135]
    s_waitcnt lgkmcnt(14)
    v_mfma_f32_16x16x32_bf16 v[132:135], v[80:83], v[156:159], v[132:135]
    s_waitcnt lgkmcnt(12)
    v_mfma_f32_16x16x32_bf16 v[132:135], v[84:87], v[72:75], v[132:135]
    s_waitcnt lgkmcnt(9)
    v_mfma_f32_16x16x32_bf16 v[128:131], v[88:91], v[92:95], v[128:131]
    s_waitcnt lgkmcnt(8)
    v_mfma_f32_16x16x32_bf16 v[132:135], v[88:91], v[112:115], v[132:135]
    s_waitcnt lgkmcnt(5)
    v_mfma_f32_16x16x32_bf16 v[128:131], v[116:119], v[120:123], v[128:131]
    s_waitcnt lgkmcnt(4)
    v_mfma_f32_16x16x32_bf16 v[132:135], v[116:119], v[32:35], v[132:135]
    s_waitcnt lgkmcnt(2)
    v_mfma_f32_16x16x32_bf16 v[132:135], v[40:43], v[92:95], v[132:135]
    s_waitcnt lgkmcnt(0)
    v_mfma_f32_16x16x32_bf16 v[132:135], v[44:47], v[120:123], v[132:135]
    s_branch K1_FEND
K1_OW_11:
    s_cmp_lg_u32 s27, 1
    s_cbranch_scc1 K1_OW_12
    ds_read_b64 v[112:113], v162 offset:44024
    ds_read_b64 v[114:115], v162 offset:44032
    ds_read_b64 v[116:117], v162 offset:44040
    ds_read_b64 v[118:119], v162 offset:46072
    ds_read_b64 v[120:121], v162 offset:46080
    ds_read_b64 v[122:123], v162 offset:46088
    ds_read_b64 v[32:33], v21 offset:1032
    ds_read_b64 v[34:35], v21 offset:1040
    ds_read_b128 v[36:39], v20 offset:1472
    ds_read_b128 v[40:43], v20 offset:1984
    ds_read_b64 v[44:45], v21 offset:776
    ds_read_b64 v[46:47], v21 offset:784
    ds_read_b128 v[48:51], v20 offset:1216
    ds_read_b128 v[52:55], v20 offset:1728
    buffer_load_dwordx4 v[24:27], v166, s[8:11], s86 offen
    buffer_load_dwordx4 v[28:31], v166, s[8:11], s26 offen
    s_mov_b32 s86, s89
    s_waitcnt lgkmcnt(13)
    v_lshlrev_b32 v64, 16, v112
    v_and_b32 v65, 0xffff0000, v112
    v_lshlrev_b32 v66, 16, v113
    v_and_b32 v67, 0xffff0000, v113
    s_waitcnt lgkmcnt(12)
    v_lshlrev_b32 v68, 16, v114
    ds_read_b64 v[56:57], v21 offset:520
    ds_read_b64 v[58:59], v21 offset:528
    v_and_b32 v69, 0xffff0000, v114
    v_lshlrev_b32 v70, 16, v115
    v_and_b32 v71, 0xffff0000, v115
    s_waitcnt lgkmcnt(13)
    v_lshlrev_b32 v72, 16, v116
    v_and_b32 v73, 0xffff0000, v116
    ds_read_b128 v[60:63], v20 offset:960
    v_lshlrev_b32 v74, 16, v117
    v_and_b32 v75, 0xffff0000, v117
    v_add_f32 v124, v65, v66
    v_add_f32 v125, v64, v65
    v_add_f32 v126, v74, v75
    ds_read_b64 v[96:97], v21 offset:264
    ds_read_b64 v[98:99], v21 offset:272
    v_add_f32 v127, v73, v74
    v_add_f32 v92, v68, v69
    v_add_f32 v93, v70, v71
    v_add_f32 v94, v66, v67
    v_add_f32 v95, v72, v73
    ds_read_b128 v[100:103], v20 offset:704
    v_add_f32 v76, v67, v92
    v_add_f32 v77, v92, v70
    v_add_f32 v78, v69, v93
    v_add_f32 v79, v93, v72
    v_add_f32 v80, v77, v94
    ds_read_b64 v[104:105], v21 offset:968
    ds_read_b64 v[106:107], v21 offset:976
    v_add_f32 v81, v76, v93
    v_add_f32 v82, v79, v92
    v_add_f32 v83, v78, v95
    v_cvt_pk_bf16_f32 v112, v76, v77
    v_cvt_pk_bf16_f32 v113, v78, v79
    ds_read_b128 v[108:111], v20 offset:1408
    ds_write_b64 v162, v[112:113] offset:13744
    v_add_f32 v84, v81, v124
    v_add_f32 v85, v82, v94
    v_add_f32 v86, v81, v95
    v_add_f32 v87, v82, v127
    ds_read_b128 v[136:139], v20 offset:1920
    v_cvt_pk_bf16_f32 v114, v80, v81
    v_cvt_pk_bf16_f32 v115, v82, v83
    ds_write_b64 v162, v[114:115] offset:8480
    v_add_f32 v88, v85, v125
    v_add_f32 v89, v86, v124
    ds_read_b64 v[140:141], v21 offset:712
    ds_read_b64 v[142:143], v21 offset:720
    v_add_f32 v90, v87, v94
    v_add_f32 v91, v86, v126
    v_cvt_pk_bf16_f32 v116, v84, v85
    v_cvt_pk_bf16_f32 v117, v86, v87
    ds_write_b64 v162, v[116:117] offset:16896
    ds_read_b128 v[144:147], v20 offset:1152
    v_cvt_pk_bf16_f32 v76, v88, v89
    v_cvt_pk_bf16_f32 v77, v90, v91
    ds_write_b64 v162, v[76:77] offset:11624
    s_waitcnt lgkmcnt(15)
    v_lshlrev_b32 v66, 16, v119
    v_and_b32 v67, 0xffff0000, v119
    ds_read_b128 v[148:151], v20 offset:1664
    v_lshlrev_b32 v68, 16, v120
    v_and_b32 v69, 0xffff0000, v120
    v_lshlrev_b32 v70, 16, v121
    v_and_b32 v71, 0xffff0000, v121
    v_lshlrev_b32 v72, 16, v122
    ds_read_b64 v[152:153], v21 offset:456
    ds_read_b64 v[154:155], v21 offset:464
    v_and_b32 v73, 0xffff0000, v122
    v_add_f32 v92, v68, v69
    v_add_f32 v93, v70, v71
    v_add_f32 v94, v66, v67
    v_add_f32 v95, v72, v73
    ds_read_b128 v[156:159], v20 offset:896
    v_add_f32 v76, v67, v92
    v_add_f32 v77, v92, v70
    v_add_f32 v78, v69, v93
    v_add_f32 v79, v93, v72
    v_add_f32 v80, v77, v94
    v_add_f32 v81, v76, v93
    v_add_f32 v82, v79, v92
    v_add_f32 v83, v78, v95
    v_cvt_pk_bf16_f32 v118, v76, v77
    v_cvt_pk_bf16_f32 v119, v78, v79
    ds_write_b64 v162, v[118:119] offset:15792
    v_cvt_pk_bf16_f32 v120, v80, v81
    v_cvt_pk_bf16_f32 v121, v82, v83
    ds_write_b64 v162, v[120:121] offset:10528
    v_mov_b32 v124, s34
    v_mov_b32 v125, 1
    s_mov_b64 exec, 1
    ds_add_u32 v124, v125 offset:51264
    s_mov_b64 exec, -1
    v_subrev_u32 v126, 192, v21
    v_mfma_f32_16x16x32_bf16 v[128:131], v[32:35], v[36:39], 0
    ds_read_b64 v[64:65], v21 offset:200
    ds_read_b64 v[66:67], v21 offset:208
    ds_read_b128 v[68:71], v20 offset:640
    v_mfma_f32_16x16x32_bf16 v[132:135], v[32:35], v[40:43], 0
    ds_read_b64 v[72:73], v21 offset:904
    ds_read_b64 v[74:75], v21 offset:912
    ds_read_b128 v[76:79], v20 offset:1344
    v_mfma_f32_16x16x32_bf16 v[128:131], v[44:47], v[48:51], v[128:131]
    ds_read_b128 v[80:83], v20 offset:1856
    ds_read_b64 v[84:85], v21 offset:648
    ds_read_b64 v[86:87], v21 offset:656
    v_mfma_f32_16x16x32_bf16 v[132:135], v[44:47], v[52:55], v[132:135]
    ds_read_b128 v[88:91], v20 offset:1088
    ds_read_b128 v[92:95], v20 offset:1600
    s_waitcnt lgkmcnt(15)
    v_mfma_f32_16x16x32_bf16 v[128:131], v[56:59], v[60:63], v[128:131]
    ds_read_b64 v[112:113], v21 offset:392
    ds_read_b64 v[114:115], v21 offset:400
    ds_read_b128 v[116:119], v20 offset:832
    v_mfma_f32_16x16x32_bf16 v[132:135], v[56:59], v[36:39], v[132:135]
    ds_read_b64 v[120:121], v21 offset:136
    ds_read_b64 v[122:123], v21 offset:144
    ds_read_b128 v[32:35], v20 offset:576
    v_mfma_f32_16x16x32_bf16 v[128:131], v[96:99], v[100:103], v[128:131]
    ds_read_b64 v[40:41], v21 offset:8
    ds_read_b64 v[42:43], v21 offset:16
    ds_read_b128 v[44:47], v20 offset:448
    v_mfma_f32_16x16x32_bf16 v[132:135], v[96:99], v[48:51], v[132:135]
    ds_read_b64 v[52:53], v21 offset:840
    ds_read_b64 v[54:55], v21 offset:848
    ds_read_b128 v[56:59], v20 offset:1280
    v_mfma_f32_16x16x32_bf16 v[128:131], v[104:107], v[108:111], v[128:131]
    ds_read_b128 v[36:39], v20 offset:1792
    ds_read_b64 v[100:101], v21 offset:584
    ds_read_b64 v[102:103], v21 offset:592
    v_mfma_f32_16x16x32_bf16 v[132:135], v[104:107], v[136:139], v[132:135]
    ds_read_b128 v[96:99], v20 offset:1024
    ds_read_b128 v[48:51], v20 offset:1536
    v_mfma_f32_16x16x32_bf16 v[128:131], v[140:143], v[144:147], v[128:131]
    ds_read_b64 v[104:105], v21 offset:328
    ds_read_b64 v[106:107], v21 offset:336
    ds_read_b128 v[136:139], v20 offset:768
    v_mfma_f32_16x16x32_bf16 v[132:135], v[140:143], v[148:151], v[132:135]
    ds_read_b64 v[140:141], v21 offset:72
    ds_read_b64 v[142:143], v21 offset:80
    ds_read_b128 v[148:151], v20 offset:512
    s_waitcnt lgkmcnt(15)
    v_mfma_f32_16x16x32_bf16 v[128:131], v[152:155], v[156:159], v[128:131]
    ds_read_b64 v[156:157], v164 offset:1328
    ds_read_b64 v[158:159], v164 offset:1344
    v_mfma_f32_16x16x32_bf16 v[132:135], v[152:155], v[108:111], v[132:135]
    ds_read_b64 v[152:153], v164 offset:1360
    ds_read_b64 v[154:155], v164 offset:1376
    ds_read_b64 v[108:109], v164 offset:1552
    ds_read_b64 v[110:111], v164 offset:1568
    v_mfma_f32_16x16x32_bf16 v[128:131], v[64:67], v[68:71], v[128:131]
    ds_read_b64 v[68:69], v164 offset:1520
    ds_read_b64 v[70:71], v164 offset:1536
    v_mfma_f32_16x16x32_bf16 v[132:135], v[64:67], v[144:147], v[132:135]
    v_mfma_f32_16x16x32_bf16 v[128:131], v[72:75], v[76:79], v[128:131]
    v_mfma_f32_16x16x32_bf16 v[132:135], v[72:75], v[80:83], v[132:135]
    v_mfma_f32_16x16x32_bf16 v[128:131], v[84:87], v[88:91], v[128:131]
    v_mfma_f32_16x16x32_bf16 v[132:135], v[84:87], v[92:95], v[132:135]
    v_mfma_f32_16x16x32_bf16 v[128:131], v[112:115], v[116:119], v[128:131]
    v_mfma_f32_16x16x32_bf16 v[132:135], v[112:115], v[76:79], v[132:135]
    ds_read_b32 v125, v124 offset:51264
    v_mfma_f32_16x16x32_bf16 v[128:131], v[120:123], v[32:35], v[128:131]
    v_mfma_f32_16x16x32_bf16 v[132:135], v[120:123], v[88:91], v[132:135]
    s_waitcnt lgkmcnt(15)
    v_mfma_f32_16x16x32_bf16 v[128:131], v[40:43], v[44:47], v[128:131]
    v_mfma_f32_16x16x32_bf16 v[132:135], v[40:43], v[60:63], v[132:135]
    s_waitcnt lgkmcnt(0)
    v_readfirstlane_b32 s36, v125
    s_nop 0
    s_cmp_ge_u32 s36, 4
    s_cbranch_scc1 K1_FQ_14
    s_mov_b32 s37, 0x1000000
K1_FP_13:
    ds_read_b32 v125, v124 offset:51264
    s_sub_u32 s37, s37, 1
    s_cmp_eq_u32 s37, 0
    s_cbranch_scc1 K1_FQ_14
    s_waitcnt lgkmcnt(0)
    v_readfirstlane_b32 s36, v125
    s_nop 0
    s_cmp_lt_u32 s36, 4
    s_cbranch_scc1 K1_FP_13
K1_FQ_14:
    ds_read_b64_tr_b16 v[64:65], v163 offset:16
    ds_read_b64_tr_b16 v[66:67], v163 offset:272
    ds_read_b64_tr_b16 v[144:145], v163 offset:528
    ds_read_b64_tr_b16 v[146:147], v163 offset:784
    ds_read_b64_tr_b16 v[72:73], v163 offset:0
    ds_read_b64_tr_b16 v[74:75], v163 offset:256
    v_mfma_f32_16x16x32_bf16 v[128:131], v[52:55], v[56:59], v[128:131]
    ds_read_b64_tr_b16 v[80:81], v163 offset:512
    ds_read_b64_tr_b16 v[82:83], v163 offset:768
    v_mfma_f32_16x16x32_bf16 v[132:135], v[52:55], v[36:39], v[132:135]
    v_mfma_f32_16x16x32_bf16 v[128:131], v[100:103], v[96:99], v[128:131]
    v_mfma_f32_16x16x32_bf16 v[132:135], v[100:103], v[48:51], v[132:135]
    v_mfma_f32_16x16x32_bf16 v[128:131], v[104:107], v[136:139], v[128:131]
    v_mfma_f32_16x16x32_bf16 v[132:135], v[104:107], v[56:59], v[132:135]
    v_mfma_f32_16x16x32_bf16 v[128:131], v[140:143], v[148:151], v[128:131]
    v_mfma_f32_16x16x32_bf16 v[132:135], v[140:143], v[96:99], v[132:135]
    s_waitcnt lgkmcnt(6)
    v_mfma_f32_16x16x32_bf16 v[132:135], v[64:67], v[156:159], v[132:135]
    v_mfma_f32_16x16x32_bf16 v[128:131], v[64:67], v[152:155], v[128:131]
    s_waitcnt lgkmcnt(4)
    v_mfma_f32_16x16x32_bf16 v[132:135], v[144:147], v[152:155], v[132:135]
    s_waitcnt lgkmcnt(2)
    v_mfma_f32_16x16x32_bf16 v[128:131], v[72:75], v[108:111], v[128:131]
    v_mfma_f32_16x16x32_bf16 v[132:135], v[72:75], v[68:71], v[132:135]
    s_waitcnt lgkmcnt(0)
    v_mfma_f32_16x16x32_bf16 v[132:135], v[80:83], v[108:111], v[132:135]
    s_branch K1_FEND
K1_OW_12:
    s_cmp_lg_u32 s27, 2
    s_cbranch_scc1 K1_OW_15
    ds_read_b64 v[112:113], v162 offset:44024
    ds_read_b64 v[114:115], v162 offset:44032
    ds_read_b64 v[116:117], v162 offset:44040
    ds_read_b64 v[32:33], v21 offset:1032
    ds_read_b64 v[34:35], v21 offset:1040
    ds_read_b128 v[36:39], v20 offset:2496
    ds_read_b128 v[40:43], v20 offset:3008
    ds_read_b64 v[44:45], v21 offset:776
    ds_read_b64 v[46:47], v21 offset:784
    ds_read_b128 v[48:51], v20 offset:2240
    ds_read_b128 v[52:55], v20 offset:2752
    ds_read_b64 v[56:57], v21 offset:520
    ds_read_b64 v[58:59], v21 offset:528
    ds_read_b128 v[60:63], v20 offset:1984
    buffer_load_dwordx4 v[24:27], v166, s[8:11], s86 offen
    buffer_load_dwordx4 v[28:31], v166, s[8:11], s26 offen
    s_mov_b32 s86, s89
    s_waitcnt lgkmcnt(13)
    v_lshlrev_b32 v64, 16, v112
    v_and_b32 v65, 0xffff0000, v112
    v_lshlrev_b32 v66, 16, v113
    v_and_b32 v67, 0xffff0000, v113
    s_waitcnt lgkmcnt(12)
    v_lshlrev_b32 v68, 16, v114
    ds_read_b64 v[96:97], v21 offset:264
    ds_read_b64 v[98:99], v21 offset:272
    v_and_b32 v69, 0xffff0000, v114
    v_lshlrev_b32 v70, 16, v115
    v_and_b32 v71, 0xffff0000, v115
    s_waitcnt lgkmcnt(13)
    v_lshlrev_b32 v72, 16, v116
    v_and_b32 v73, 0xffff0000, v116
    ds_read_b128 v[100:103], v20 offset:1728
    v_lshlrev_b32 v74, 16, v117
    v_and_b32 v75, 0xffff0000, v117
    v_add_f32 v124, v65, v66
    v_add_f32 v125, v64, v65
    v_add_f32 v126, v74, v75
    ds_read_b64 v[104:105], v21 offset:968
    ds_read_b64 v[106:107], v21 offset:976
    v_add_f32 v127, v73, v74
    v_add_f32 v92, v68, v69
    v_add_f32 v93, v70, v71
    v_add_f32 v94, v66, v67
    v_add_f32 v95, v72, v73
    ds_read_b128 v[108:111], v20 offset:2432
    v_add_f32 v76, v67, v92
    v_add_f32 v77, v92, v70
    v_add_f32 v78, v69, v93
    v_add_f32 v79, v93, v72
    v_add_f32 v80, v77, v94
    ds_read_b128 v[136:139], v20 offset:2944
    v_add_f32 v81, v76, v93
    v_add_f32 v82, v79, v92
    v_add_f32 v83, v78, v95
    v_cvt_pk_bf16_f32 v112, v76, v77
    v_cvt_pk_bf16_f32 v113, v78, v79
    ds_read_b64 v[140:141], v21 offset:712
    ds_read_b64 v[142:143], v21 offset:720
    ds_write_b64 v162, v[112:113] offset:13744
    v_add_f32 v84, v81, v124
    v_add_f32 v85, v82, v94
    v_add_f32 v86, v81, v95
    v_add_f32 v87, v82, v127
    ds_read_b128 v[144:147], v20 offset:2176
    v_cvt_pk_bf16_f32 v114, v80, v81
    v_cvt_pk_bf16_f32 v115, v82, v83
    ds_write_b64 v162, v[114:115] offset:8480
    v_add_f32 v88, v85, v125
    v_add_f32 v89, v86, v124
    ds_read_b128 v[148:151], v20 offset:2688
    v_add_f32 v90, v87, v94
    v_add_f32 v91, v86, v126
    v_cvt_pk_bf16_f32 v116, v84, v85
    v_cvt_pk_bf16_f32 v117, v86, v87
    ds_write_b64 v162, v[116:117] offset:16896
    ds_read_b64 v[152:153], v21 offset:456
    ds_read_b64 v[154:155], v21 offset:464
    v_cvt_pk_bf16_f32 v76, v88, v89
    v_cvt_pk_bf16_f32 v77, v90, v91
    ds_write_b64 v162, v[76:77] offset:11624
    v_mov_b32 v124, s34
    v_mov_b32 v125, 1
    s_mov_b64 exec, 1
    ds_add_u32 v124, v125 offset:51264
    s_mov_b64 exec, -1
    v_subrev_u32 v126, 192, v21
    s_waitcnt lgkmcnt(15)
    v_mfma_f32_16x16x32_bf16 v[128:131], v[32:35], v[36:39], 0
    ds_read_b128 v[156:159], v20 offset:1920
    ds_read_b64 v[64:65], v21 offset:200
    ds_read_b64 v[66:67], v21 offset:208
    v_mfma_f32_16x16x32_bf16 v[132:135], v[32:35], v[40:43], 0
    ds_read_b128 v[68:71], v20 offset:1664
    ds_read_b64 v[72:73], v21 offset:904
    ds_read_b64 v[74:75], v21 offset:912
    v_mfma_f32_16x16x32_bf16 v[128:131], v[44:47], v[48:51], v[128:131]
    ds_read_b128 v[76:79], v20 offset:2368
    ds_read_b128 v[80:83], v20 offset:2880
    v_mfma_f32_16x16x32_bf16 v[132:135], v[44:47], v[52:55], v[132:135]
    ds_read_b64 v[84:85], v21 offset:648
    ds_read_b64 v[86:87], v21 offset:656
    ds_read_b128 v[88:91], v20 offset:2112
    v_mfma_f32_16x16x32_bf16 v[128:131], v[56:59], v[60:63], v[128:131]
    ds_read_b128 v[92:95], v20 offset:2624
    ds_read_b64 v[112:113], v21 offset:392
    ds_read_b64 v[114:115], v21 offset:400
    v_mfma_f32_16x16x32_bf16 v[132:135], v[56:59], v[36:39], v[132:135]
    ds_read_b128 v[116:119], v20 offset:1856
    ds_read_b64 v[120:121], v21 offset:136
    ds_read_b64 v[122:123], v21 offset:144
    v_mfma_f32_16x16x32_bf16 v[128:131], v[96:99], v[100:103], v[128:131]
    ds_read_b128 v[32:35], v20 offset:1600
    ds_read_b64 v[40:41], v21 offset:8
    ds_read_b64 v[42:43], v21 offset:16
    v_mfma_f32_16x16x32_bf16 v[132:135], v[96:99], v[48:51], v[132:135]
    ds_read_b128 v[44:47], v20 offset:1472
    ds_read_b64 v[52:53], v126 offset:0
    ds_read_b64 v[54:55], v126 offset:8
    s_waitcnt lgkmcnt(15)
    v_mfma_f32_16x16x32_bf16 v[128:131], v[104:107], v[108:111], v[128:131]
    ds_read_b128 v[56:59], v20 offset:448
    ds_read_b128 v[36:39], v20 offset:960
    v_mfma_f32_16x16x32_bf16 v[132:135], v[104:107], v[136:139], v[132:135]
    ds_read_b64 v[100:101], v21 offset:840
    ds_read_b64 v[102:103], v21 offset:848
    ds_read_b128 v[96:99], v20 offset:2304
    v_mfma_f32_16x16x32_bf16 v[128:131], v[140:143], v[144:147], v[128:131]
    ds_read_b128 v[48:51], v20 offset:2816
    ds_read_b64 v[104:105], v21 offset:584
    ds_read_b64 v[106:107], v21 offset:592
    v_mfma_f32_16x16x32_bf16 v[132:135], v[140:143], v[148:151], v[132:135]
    ds_read_b128 v[136:139], v20 offset:2048
    ds_read_b128 v[140:143], v20 offset:2560
    v_mfma_f32_16x16x32_bf16 v[128:131], v[152:155], v[156:159], v[128:131]
    ds_read_b64 v[148:149], v21 offset:328
    ds_read_b64 v[150:151], v21 offset:336
    ds_read_b128 v[156:159], v20 offset:1792
    v_mfma_f32_16x16x32_bf16 v[132:135], v[152:155], v[108:111], v[132:135]
    ds_read_b64 v[152:153], v21 offset:72
    ds_read_b64 v[154:155], v21 offset:80
    ds_read_b128 v[108:111], v20 offset:1536
    v_mfma_f32_16x16x32_bf16 v[128:131], v[64:67], v[68:71], v[128:131]
    ds_read_b64 v[68:69], v164 offset:1296
    ds_read_b64 v[70:71], v164 offset:1312
    v_mfma_f32_16x16x32_bf16 v[132:135], v[64:67], v[144:147], v[132:135]
    ds_read_b64 v[64:65], v164 offset:1328
    ds_read_b64 v[66:67], v164 offset:1344
    ds_read_b64 v[144:145], v164 offset:1360
    ds_read_b64 v[146:147], v164 offset:1376
    v_mfma_f32_16x16x32_bf16 v[128:131], v[72:75], v[76:79], v[128:131]
    v_mfma_f32_16x16x32_bf16 v[132:135], v[72:75], v[80:83], v[132:135]
    ds_read_b64 v[72:73], v164 offset:1488
    ds_read_b64 v[74:75], v164 offset:1504
    ds_read_b64 v[80:81], v164 offset:1520
    ds_read_b64 v[82:83], v164 offset:1536
    s_waitcnt lgkmcnt(15)
    v_mfma_f32_16x16x32_bf16 v[128:131], v[84:87], v[88:91], v[128:131]
    v_mfma_f32_16x16x32_bf16 v[132:135], v[84:87], v[92:95], v[132:135]
    ds_read_b64 v[84:85], v164 offset:1552
    ds_read_b64 v[86:87], v164 offset:1568
    ds_read_b64 v[92:93], v165 offset:1776
    ds_read_b64 v[94:95], v165 offset:1792
    v_mfma_f32_16x16x32_bf16 v[128:131], v[112:115], v[116:119], v[128:131]
    ds_read_b64 v[116:117], v165 offset:1808
    ds_read_b64 v[118:119], v165 offset:1824
    v_mfma_f32_16x16x32_bf16 v[132:135], v[112:115], v[76:79], v[132:135]
    v_mfma_f32_16x16x32_bf16 v[128:131], v[120:123], v[32:35], v[128:131]
    v_mfma_f32_16x16x32_bf16 v[132:135], v[120:123], v[88:91], v[132:135]
    ds_read_b32 v125, v124 offset:51264
    v_mfma_f32_16x16x32_bf16 v[128:131], v[40:43], v[44:47], v[128:131]
    v_mfma_f32_16x16x32_bf16 v[132:135], v[40:43], v[60:63], v[132:135]
    v_mfma_f32_16x16x32_bf16 v[128:131], v[52:55], v[56:59], v[128:131]
    v_mfma_f32_16x16x32_bf16 v[132:135], v[52:55], v[36:39], v[132:135]
    s_waitcnt lgkmcnt(0)
    v_readfirstlane_b32 s36, v125
    s_nop 0
    s_cmp_ge_u32 s36, 4
    s_cbranch_scc1 K1_FQ_17
    s_mov_b32 s37, 0x1000000
K1_FP_16:
    ds_read_b32 v125, v124 offset:51264
    s_sub_u32 s37, s37, 1
    s_cmp_eq_u32 s37, 0
    s_cbranch_scc1 K1_FQ_17
    s_waitcnt lgkmcnt(0)
    v_readfirstlane_b32 s36, v125
    s_nop 0
    s_cmp_lt_u32 s36, 4
    s_cbranch_scc1 K1_FP_16
K1_FQ_17:
    ds_read_b64_tr_b16 v[112:113], v163 offset:528
    ds_read_b64_tr_b16 v[114:115], v163 offset:784
    ds_read_b64_tr_b16 v[76:77], v163 offset:16
    ds_read_b64_tr_b16 v[78:79], v163 offset:272
    ds_read_b64_tr_b16 v[32:33], v163 offset:1040
    ds_read_b64_tr_b16 v[34:35], v163 offset:1296
    v_mfma_f32_16x16x32_bf16 v[128:131], v[100:103], v[96:99], v[128:131]
    ds_read_b64_tr_b16 v[120:121], v163 offset:1552
    ds_read_b64_tr_b16 v[122:123], v163 offset:1808
    ds_read_b64_tr_b16 v[88:89], v163 offset:512
    ds_read_b64_tr_b16 v[90:91], v163 offset:768
    v_mfma_f32_16x16x32_bf16 v[132:135], v[100:103], v[48:51], v[132:135]
    ds_read_b64_tr_b16 v[44:45], v163 offset:0
    ds_read_b64_tr_b16 v[46:47], v163 offset:256
    ds_read_b64_tr_b16 v[40:41], v163 offset:1024
    ds_read_b64_tr_b16 v[42:43], v163 offset:1280
    v_mfma_f32_16x16x32_bf16 v[128:131], v[104:107], v[136:139], v[128:131]
    ds_read_b64_tr_b16 v[60:61], v163 offset:1536
    ds_read_b64_tr_b16 v[62:63], v163 offset:1792
    ds_read_b64_tr_b16 v[56:57], v163 offset:3160
    ds_read_b64_tr_b16 v[58:59], v163 offset:3416
    v_mfma_f32_16x16x32_bf16 v[132:135], v[104:107], v[140:143], v[132:135]
    ds_read_b64_tr_b16 v[52:53], v163 offset:3672
    ds_read_b64_tr_b16 v[54:55], v163 offset:3928
    v_mfma_f32_16x16x32_bf16 v[128:131], v[148:151], v[156:159], v[128:131]
    v_mfma_f32_16x16x32_bf16 v[132:135], v[148:151], v[96:99], v[132:135]
    v_mfma_f32_16x16x32_bf16 v[128:131], v[152:155], v[108:111], v[128:131]
    v_mfma_f32_16x16x32_bf16 v[132:135], v[152:155], v[136:139], v[132:135]
    s_waitcnt lgkmcnt(15)
    v_mfma_f32_16x16x32_bf16 v[132:135], v[112:115], v[68:71], v[132:135]
    v_mfma_f32_16x16x32_bf16 v[128:131], v[76:79], v[68:71], v[128:131]
    s_waitcnt lgkmcnt(14)
    v_mfma_f32_16x16x32_bf16 v[132:135], v[32:35], v[64:67], v[132:135]
    v_mfma_f32_16x16x32_bf16 v[128:131], v[112:115], v[64:67], v[128:131]
    s_waitcnt lgkmcnt(12)
    v_mfma_f32_16x16x32_bf16 v[132:135], v[120:123], v[144:147], v[132:135]
    v_mfma_f32_16x16x32_bf16 v[128:131], v[32:35], v[144:147], v[128:131]
    s_waitcnt lgkmcnt(10)
    v_mfma_f32_16x16x32_bf16 v[132:135], v[88:91], v[72:75], v[132:135]
    s_waitcnt lgkmcnt(8)
    v_mfma_f32_16x16x32_bf16 v[128:131], v[44:47], v[72:75], v[128:131]
    s_waitcnt lgkmcnt(6)
    v_mfma_f32_16x16x32_bf16 v[132:135], v[40:43], v[80:83], v[132:135]
    v_mfma_f32_16x16x32_bf16 v[128:131], v[88:91], v[80:83], v[128:131]
    s_waitcnt lgkmcnt(4)
    v_mfma_f32_16x16x32_bf16 v[132:135], v[60:63], v[84:87], v[132:135]
    v_mfma_f32_16x16x32_bf16 v[128:131], v[40:43], v[84:87], v[128:131]
    s_waitcnt lgkmcnt(2)
    v_mfma_f32_16x16x32_bf16 v[132:135], v[56:59], v[92:95], v[132:135]
    v_mfma_f32_16x16x32_bf16 v[128:131], v[56:59], v[116:119], v[128:131]
    s_waitcnt lgkmcnt(0)
    v_mfma_f32_16x16x32_bf16 v[132:135], v[52:55], v[116:119], v[132:135]
    s_branch K1_FEND
K1_OW_15:
    ds_read_b64 v[112:113], v162 offset:44024
    ds_read_b64 v[114:115], v162 offset:44032
    ds_read_b64 v[116:117], v162 offset:44040
    ds_read_b64 v[32:33], v21 offset:1032
    ds_read_b64 v[34:35], v21 offset:1040
    ds_read_b128 v[36:39], v20 offset:3520
    ds_read_b128 v[40:43], v20 offset:4032
    ds_read_b64 v[44:45], v21 offset:776
    ds_read_b64 v[46:47], v21 offset:784
    ds_read_b128 v[48:51], v20 offset:3264
    ds_read_b128 v[52:55], v20 offset:3776
    ds_read_b64 v[56:57], v21 offset:520
    ds_read_b64 v[58:59], v21 offset:528
    ds_read_b128 v[60:63], v20 offset:3008
    buffer_load_dwordx4 v[24:27], v166, s[8:11], s86 offen
    buffer_load_dwordx4 v[28:31], v166, s[8:11], s26 offen
    s_mov_b32 s86, s89
    s_waitcnt lgkmcnt(13)
    v_lshlrev_b32 v64, 16, v112
    v_and_b32 v65, 0xffff0000, v112
    v_lshlrev_b32 v66, 16, v113
    v_and_b32 v67, 0xffff0000, v113
    s_waitcnt lgkmcnt(12)
    v_lshlrev_b32 v68, 16, v114
    ds_read_b64 v[96:97], v21 offset:264
    ds_read_b64 v[98:99], v21 offset:272
    v_and_b32 v69, 0xffff0000, v114
    v_lshlrev_b32 v70, 16, v115
    v_and_b32 v71, 0xffff0000, v115
    s_waitcnt lgkmcnt(13)
    v_lshlrev_b32 v72, 16, v116
    v_and_b32 v73, 0xffff0000, v116
    ds_read_b128 v[100:103], v20 offset:2752
    v_lshlrev_b32 v74, 16, v117
    v_and_b32 v75, 0xffff0000, v117
    v_add_f32 v124, v65, v66
    v_add_f32 v125, v64, v65
    v_add_f32 v126, v74, v75
    ds_read_b64 v[104:105], v21 offset:968
    ds_read_b64 v[106:107], v21 offset:976
    v_add_f32 v127, v73, v74
    v_add_f32 v92, v68, v69
    v_add_f32 v93, v70, v71
    v_add_f32 v94, v66, v67
    v_add_f32 v95, v72, v73
    ds_read_b128 v[108:111], v20 offset:3456
    v_add_f32 v76, v67, v92
    v_add_f32 v77, v92, v70
    v_add_f32 v78, v69, v93
    v_add_f32 v79, v93, v72
    v_add_f32 v80, v77, v94
    ds_read_b128 v[136:139], v20 offset:3968
    v_add_f32 v81, v76, v93
    v_add_f32 v82, v79, v92
    v_add_f32 v83, v78, v95
    v_cvt_pk_bf16_f32 v112, v76, v77
    v_cvt_pk_bf16_f32 v113, v78, v79
    ds_read_b64 v[140:141], v21 offset:712
    ds_read_b64 v[142:143], v21 offset:720
    ds_write_b64 v162, v[112:113] offset:13744
    v_add_f32 v84, v81, v124
    v_add_f32 v85, v82, v94
    v_add_f32 v86, v81, v95
    v_add_f32 v87, v82, v127
    ds_read_b128 v[144:147], v20 offset:3200
    v_cvt_pk_bf16_f32 v114, v80, v81
    v_cvt_pk_bf16_f32 v115, v82, v83
    ds_write_b64 v162, v[114:115] offset:8480
    v_add_f32 v88, v85, v125
    v_add_f32 v89, v86, v124
    ds_read_b128 v[148:151], v20 offset:3712
    v_add_f32 v90, v87, v94
    v_add_f32 v91, v86, v126
    v_cvt_pk_bf16_f32 v116, v84, v85
    v_cvt_pk_bf16_f32 v117, v86, v87
    ds_write_b64 v162, v[116:117] offset:16896
    ds_read_b64 v[152:153], v21 offset:456
    ds_read_b64 v[154:155], v21 offset:464
    v_cvt_pk_bf16_f32 v76, v88, v89
    v_cvt_pk_bf16_f32 v77, v90, v91
    ds_write_b64 v162, v[76:77] offset:11624
    v_mov_b32 v124, s34
    v_mov_b32 v125, 1
    s_mov_b64 exec, 1
    ds_add_u32 v124, v125 offset:51264
    s_mov_b64 exec, -1
    v_subrev_u32 v126, 192, v21
    s_waitcnt lgkmcnt(15)
    v_mfma_f32_16x16x32_bf16 v[128:131], v[32:35], v[36:39], 0
    ds_read_b128 v[156:159], v20 offset:2944
    ds_read_b64 v[64:65], v21 offset:200
    ds_read_b64 v[66:67], v21 offset:208
    v_mfma_f32_16x16x32_bf16 v[132:135], v[32:35], v[40:43], 0
    ds_read_b128 v[68:71], v20 offset:2688
    ds_read_b64 v[72:73], v21 offset:904
    ds_read_b64 v[74:75], v21 offset:912
    v_mfma_f32_16x16x32_bf16 v[128:131], v[44:47], v[48:51], v[128:131]
    ds_read_b128 v[76:79], v20 offset:3392
    ds_read_b128 v[80:83], v20 offset:3904
    v_mfma_f32_16x16x32_bf16 v[132:135], v[44:47], v[52:55], v[132:135]
    ds_read_b64 v[84:85], v21 offset:648
    ds_read_b64 v[86:87], v21 offset:656
    ds_read_b128 v[88:91], v20 offset:3136
    v_mfma_f32_16x16x32_bf16 v[128:131], v[56:59], v[60:63], v[128:131]
    ds_read_b128 v[92:95], v20 offset:3648
    ds_read_b64 v[112:113], v21 offset:392
    ds_read_b64 v[114:115], v21 offset:400
    v_mfma_f32_16x16x32_bf16 v[132:135], v[56:59], v[36:39], v[132:135]
    ds_read_b128 v[116:119], v20 offset:2880
    ds_read_b64 v[120:121], v21 offset:136
    ds_read_b64 v[122:123], v21 offset:144
    v_mfma_f32_16x16x32_bf16 v[128:131], v[96:99], v[100:103], v[128:131]
    ds_read_b128 v[32:35], v20 offset:2624
    ds_read_b64 v[40:41], v21 offset:8
    ds_read_b64 v[42:43], v21 offset:16
    v_mfma_f32_16x16x32_bf16 v[132:135], v[96:99], v[48:51], v[132:135]
    ds_read_b128 v[44:47], v20 offset:2496
    ds_read_b64 v[52:53], v126 offset:0
    ds_read_b64 v[54:55], v126 offset:8
    s_waitcnt lgkmcnt(15)
    v_mfma_f32_16x16x32_bf16 v[128:131], v[104:107], v[108:111], v[128:131]
    ds_read_b128 v[56:59], v20 offset:1472
    ds_read_b128 v[36:39], v20 offset:1984
    v_mfma_f32_16x16x32_bf16 v[132:135], v[104:107], v[136:139], v[132:135]
    ds_read_b64 v[100:101], v21 offset:840
    ds_read_b64 v[102:103], v21 offset:848
    ds_read_b128 v[96:99], v20 offset:3328
    v_mfma_f32_16x16x32_bf16 v[128:131], v[140:143], v[144:147], v[128:131]
    ds_read_b128 v[48:51], v20 offset:3840
    ds_read_b64 v[104:105], v21 offset:584
    ds_read_b64 v[106:107], v21 offset:592
    v_mfma_f32_16x16x32_bf16 v[132:135], v[140:143], v[148:151], v[132:135]
    ds_read_b128 v[136:139], v20 offset:3072
    ds_read_b128 v[140:143], v20 offset:3584
    v_mfma_f32_16x16x32_bf16 v[128:131], v[152:155], v[156:159], v[128:131]
    ds_read_b64 v[148:149], v21 offset:328
    ds_read_b64 v[150:151], v21 offset:336
    ds_read_b128 v[156:159], v20 offset:2816
    v_mfma_f32_16x16x32_bf16 v[132:135], v[152:155], v[108:111], v[132:135]
    ds_read_b64 v[152:153], v21 offset:72
    ds_read_b64 v[154:155], v21 offset:80
    ds_read_b128 v[108:111], v20 offset:2560
    v_mfma_f32_16x16x32_bf16 v[128:131], v[64:67], v[68:71], v[128:131]
    ds_read_b64 v[68:69], v164 offset:1296
    ds_read_b64 v[70:71], v164 offset:1312
    v_mfma_f32_16x16x32_bf16 v[132:135], v[64:67], v[144:147], v[132:135]
    ds_read_b64 v[64:65], v164 offset:1328
    ds_read_b64 v[66:67], v164 offset:1344
    ds_read_b64 v[144:145], v164 offset:1360
    ds_read_b64 v[146:147], v164 offset:1376
    v_mfma_f32_16x16x32_bf16 v[128:131], v[72:75], v[76:79], v[128:131]
    v_mfma_f32_16x16x32_bf16 v[132:135], v[72:75], v[80:83], v[132:135]
    ds_read_b64 v[72:73], v164 offset:1488
    ds_read_b64 v[74:75], v164 offset:1504
    ds_read_b64 v[80:81], v164 offset:1520
    ds_read_b64 v[82:83], v164 offset:1536
    s_waitcnt lgkmcnt(15)
    v_mfma_f32_16x16x32_bf16 v[128:131], v[84:87], v[88:91], v[128:131]
    v_mfma_f32_16x16x32_bf16 v[132:135], v[84:87], v[92:95], v[132:135]
    ds_read_b64 v[84:85], v164 offset:1552
    ds_read_b64 v[86:87], v164 offset:1568
    ds_read_b64 v[92:93], v165 offset:1712
    ds_read_b64 v[94:95], v165 offset:1728
    v_mfma_f32_16x16x32_bf16 v[128:131], v[112:115], v[116:119], v[128:131]
    ds_read_b64 v[116:117], v165 offset:1744
    ds_read_b64 v[118:119], v165 offset:1760
    v_mfma_f32_16x16x32_bf16 v[132:135], v[112:115], v[76:79], v[132:135]
    ds_read_b64 v[112:113], v165 offset:1776
    ds_read_b64 v[114:115], v165 offset:1792
    ds_read_b64 v[76:77], v165 offset:1808
    ds_read_b64 v[78:79], v165 offset:1824
    v_mfma_f32_16x16x32_bf16 v[128:131], v[120:123], v[32:35], v[128:131]
    v_mfma_f32_16x16x32_bf16 v[132:135], v[120:123], v[88:91], v[132:135]
    ds_read_b32 v125, v124 offset:51264
    v_mfma_f32_16x16x32_bf16 v[128:131], v[40:43], v[44:47], v[128:131]
    v_mfma_f32_16x16x32_bf16 v[132:135], v[40:43], v[60:63], v[132:135]
    v_mfma_f32_16x16x32_bf16 v[128:131], v[52:55], v[56:59], v[128:131]
    v_mfma_f32_16x16x32_bf16 v[132:135], v[52:55], v[36:39], v[132:135]
    s_waitcnt lgkmcnt(0)
    v_readfirstlane_b32 s36, v125
    s_nop 0
    s_cmp_ge_u32 s36, 4
    s_cbranch_scc1 K1_FQ_20
    s_mov_b32 s37, 0x1000000
K1_FP_19:
    ds_read_b32 v125, v124 offset:51264
    s_sub_u32 s37, s37, 1
    s_cmp_eq_u32 s37, 0
    s_cbranch_scc1 K1_FQ_20
    s_waitcnt lgkmcnt(0)
    v_readfirstlane_b32 s36, v125
    s_nop 0
    s_cmp_lt_u32 s36, 4
    s_cbranch_scc1 K1_FP_19
K1_FQ_20:
    ds_read_b64_tr_b16 v[32:33], v163 offset:1552
    ds_read_b64_tr_b16 v[34:35], v163 offset:1808
    ds_read_b64_tr_b16 v[120:121], v163 offset:1040
    ds_read_b64_tr_b16 v[122:123], v163 offset:1296
    ds_read_b64_tr_b16 v[88:89], v163 offset:2064
    ds_read_b64_tr_b16 v[90:91], v163 offset:2320
    v_mfma_f32_16x16x32_bf16 v[128:131], v[100:103], v[96:99], v[128:131]
    ds_read_b64_tr_b16 v[44:45], v163 offset:2576
    ds_read_b64_tr_b16 v[46:47], v163 offset:2832
    ds_read_b64_tr_b16 v[40:41], v163 offset:1536
    ds_read_b64_tr_b16 v[42:43], v163 offset:1792
    v_mfma_f32_16x16x32_bf16 v[132:135], v[100:103], v[48:51], v[132:135]
    ds_read_b64_tr_b16 v[60:61], v163 offset:1024
    ds_read_b64_tr_b16 v[62:63], v163 offset:1280
    ds_read_b64_tr_b16 v[56:57], v163 offset:2048
    ds_read_b64_tr_b16 v[58:59], v163 offset:2304
    v_mfma_f32_16x16x32_bf16 v[128:131], v[104:107], v[136:139], v[128:131]
    ds_read_b64_tr_b16 v[52:53], v163 offset:2560
    ds_read_b64_tr_b16 v[54:55], v163 offset:2816
    ds_read_b64_tr_b16 v[36:37], v163 offset:3160
    ds_read_b64_tr_b16 v[38:39], v163 offset:3416
    v_mfma_f32_16x16x32_bf16 v[132:135], v[104:107], v[140:143], v[132:135]
    ds_read_b64_tr_b16 v[100:101], v163 offset:3672
    ds_read_b64_tr_b16 v[102:103], v163 offset:3928
    ds_read_b64_tr_b16 v[48:49], v163 offset:4184
    ds_read_b64_tr_b16 v[50:51], v163 offset:4440
    v_mfma_f32_16x16x32_bf16 v[128:131], v[148:151], v[156:159], v[128:131]
    ds_read_b64_tr_b16 v[104:105], v163 offset:4696
    ds_read_b64_tr_b16 v[106:107], v163 offset:4952
    v_mfma_f32_16x16x32_bf16 v[132:135], v[148:151], v[96:99], v[132:135]
    v_mfma_f32_16x16x32_bf16 v[128:131], v[152:155], v[108:111], v[128:131]
    v_mfma_f32_16x16x32_bf16 v[132:135], v[152:155], v[136:139], v[132:135]
    s_waitcnt lgkmcnt(15)
    v_mfma_f32_16x16x32_bf16 v[132:135], v[32:35], v[68:71], v[132:135]
    v_mfma_f32_16x16x32_bf16 v[128:131], v[120:123], v[68:71], v[128:131]
    v_mfma_f32_16x16x32_bf16 v[132:135], v[88:91], v[64:67], v[132:135]
    v_mfma_f32_16x16x32_bf16 v[128:131], v[32:35], v[64:67], v[128:131]
    v_mfma_f32_16x16x32_bf16 v[132:135], v[44:47], v[144:147], v[132:135]
    v_mfma_f32_16x16x32_bf16 v[128:131], v[88:91], v[144:147], v[128:131]
    s_waitcnt lgkmcnt(14)
    v_mfma_f32_16x16x32_bf16 v[132:135], v[40:43], v[72:75], v[132:135]
    s_waitcnt lgkmcnt(12)
    v_mfma_f32_16x16x32_bf16 v[128:131], v[60:63], v[72:75], v[128:131]
    s_waitcnt lgkmcnt(10)
    v_mfma_f32_16x16x32_bf16 v[132:135], v[56:59], v[80:83], v[132:135]
    v_mfma_f32_16x16x32_bf16 v[128:131], v[40:43], v[80:83], v[128:131]
    s_waitcnt lgkmcnt(8)
    v_mfma_f32_16x16x32_bf16 v[132:135], v[52:55], v[84:87], v[132:135]
    v_mfma_f32_16x16x32_bf16 v[128:131], v[56:59], v[84:87], v[128:131]
    s_waitcnt lgkmcnt(6)
    v_mfma_f32_16x16x32_bf16 v[132:135], v[36:39], v[92:95], v[132:135]
    v_mfma_f32_16x16x32_bf16 v[128:131], v[36:39], v[116:119], v[128:131]
    s_waitcnt lgkmcnt(4)
    v_mfma_f32_16x16x32_bf16 v[132:135], v[100:103], v[116:119], v[132:135]
    v_mfma_f32_16x16x32_bf16 v[128:131], v[100:103], v[112:115], v[128:131]
    s_waitcnt lgkmcnt(2)
    v_mfma_f32_16x16x32_bf16 v[132:135], v[48:51], v[112:115], v[132:135]
    v_mfma_f32_16x16x32_bf16 v[128:131], v[48:51], v[76:79], v[128:131]
    s_waitcnt lgkmcnt(0)
    v_mfma_f32_16x16x32_bf16 v[132:135], v[104:107], v[76:79], v[132:135]
K1_OW_18:
K1_FEND:
    v_subrev_u32 v8, s34, v23
    s_nop 7
    v_pk_add_f32 v[128:129], v[128:129], v[10:11]
    v_pk_add_f32 v[130:131], v[130:131], v[16:17]
    v_cvt_pk_bf16_f32 v70, v128, v129
    v_cvt_pk_bf16_f32 v71, v130, v131
    v_pk_add_f32 v[132:133], v[132:133], v[12:13]
    v_pk_add_f32 v[134:135], v[134:135], v[18:19]
    v_cvt_pk_bf16_f32 v72, v132, v133
    v_cvt_pk_bf16_f32 v73, v134, v135
    s_lshl_b32 s35, s33, 13
    s_lshl_b32 s36, s27, 10
    s_add_u32 s35, s35, s36
    s_add_u32 s35, s35, 4719104
    v_and_b32 v9, 1, v3
    v_mul_u32_u24 v9, 1016, v9
    v_add_u32 v8, v9, v8
    v_permlane16_swap_b32 v70, v72
    v_permlane16_swap_b32 v71, v73
    buffer_store_dwordx4 v[70:73], v8, s[12:15], s35 offen
    s_mov_b32 s8, s6
    s_and_b32 s9, s7, 0xffff
    s_mov_b32 s10, 0x1e10000
    s_mov_b32 s11, 0x00020000
    s_waitcnt vmcnt(1)
K1_CWD:
    buffer_store_dwordx4 v[24:27], v2, s[8:11], s86 offen sc1
    s_add_u32 s86, s86, 18432
    buffer_store_dwordx4 v[28:31], v2, s[8:11], s86 offen sc1
    s_branch K1_END
K1_PF:
    s_waitcnt lgkmcnt(0)
    v_mov_b32 v7, 0
K1_PFW:
    ds_read_b32 v9, v7
    s_waitcnt lgkmcnt(0)
    v_readfirstlane_b32 s37, v9
    s_nop 0
    s_cmp_ge_u32 s37, 8
    s_cbranch_scc1 K1_PFG
    s_sleep 2
    s_branch K1_PFW
K1_PFG:
    s_cmp_ge_u32 s2, 64
    s_cbranch_scc1 K1_END
    s_load_dwordx2 s[16:17], s[0:1], 64
    s_load_dwordx2 s[18:19], s[0:1], 80
    v_and_b32 v1, 63, v0
    v_lshrrev_b32 v2, 6, v0
    s_nop 0
    v_readfirstlane_b32 s27, v2
    s_sub_u32 s3, s2, 0
    s_lshr_b32 s3, s3, 3
    s_mul_i32 s3, s3, 12
    s_add_u32 s3, s3, s27
    s_and_b32 s4, s2, 7
    s_waitcnt lgkmcnt(0)
    v_lshlrev_b32 v70, 16, v1
    s_sub_u32 s50, s3, 0
    s_cmp_ge_u32 s50, 6
    s_cbranch_scc1 PF_TL_21
    s_load_dwordx2 s[48:49], s[0:1], 112
    s_mov_b32 s51, 11862016
    s_mov_b32 s52, 3145724
    s_cmp_eq_u32 s50, 1
    s_cselect_b32 s51, 15007744, s51
    s_cselect_b32 s52, 4194300, s52
    s_cmp_eq_u32 s50, 2
    s_cselect_b32 s51, 19202048, s51
    s_cselect_b32 s52, 2883580, s52
    s_cmp_eq_u32 s50, 3
    s_cselect_b32 s51, 22085632, s51
    s_cselect_b32 s52, 4194300, s52
    s_cmp_eq_u32 s50, 4
    s_cselect_b32 s51, 26279936, s51
    s_cselect_b32 s52, 4194300, s52
    s_cmp_eq_u32 s50, 5
    s_cselect_b32 s51, 30474240, s51
    s_cselect_b32 s52, 1048572, s52
    v_min_u32 v71, s52, v70
    s_waitcnt lgkmcnt(0)
    s_mov_b32 s44, s48
    s_and_b32 s45, s49, 0xffff
    s_mov_b32 s46, 0x6e00000
    s_mov_b32 s47, 0x00020000
    buffer_load_dword v72, v71, s[44:47], s51 offen
PF_TL_21:
    s_mov_b32 s8, s16
    s_and_b32 s9, s17, 0xffff
    s_mov_b32 s10, 0x5a0000
    s_mov_b32 s11, 0x00020000
    s_lshr_b32 s34, s4, 1
    s_lshl_b32 s34, s34, 4
    s_mov_b32 s35, 0x33214320
    s_cmp_ge_u32 s34, 32
    s_cselect_b32 s35, 0x43104210, s35
    s_and_b32 s34, s34, 16
    s_lshr_b32 s35, s35, s34
    v_bfe_u32 v5, v1, 1, 2
    v_lshlrev_b32 v5, 2, v5
    v_lshrrev_b32 v5, v5, s35
    v_and_b32 v5, 15, v5
    s_mul_i32 s34, s4, 4617
    s_lshr_b32 s34, s34, 10
    v_add_u32 v5, s34, v5
    v_lshrrev_b32 v4, 3, v1
    v_mul_u32_u24 v4, 9216, v4
    v_lshl_add_u32 v4, v5, 8, v4
    v_and_b32 v5, 1, v1
    v_lshl_add_u32 v4, v5, 7, v4
    s_mul_i32 s20, s3, 73728
    s_add_u32 s20, s20, 0
    s_cmp_ge_u32 s20, 5898240
    s_cbranch_scc1 PF_SK1_22
    buffer_load_dword v60, v4, s[8:11], s20 offen
PF_SK1_22:
    s_branch K1_END
K1_END:
    s_endpgm
.globl k3_kernel
.p2align 8
.type k3_kernel,@function
k3_kernel:
    s_cmp_ge_u32 s2, 384
    s_cbranch_scc1 K3_END
    s_cmp_ge_u32 s2, 256
    s_cbranch_scc1 K3_PF
    s_load_dwordx2 s[6:7], s[0:1], 112
    s_and_b32 s3, s2, 7
    s_lshl_b32 s3, s3, 5
    s_lshr_b32 s4, s2, 3
    s_add_u32 s3, s3, s4
    v_and_b32 v1, 63, v0
    v_lshlrev_b32 v4, 13, v0
    s_lshr_b32 s28, s3, 5
    s_lshl_b32 s28, s28, 10
    s_and_b32 s29, s3, 31
    s_lshl_b32 s29, s29, 4
    s_add_u32 s28, s28, s29
    s_add_u32 s28, s28, 4719104
    v_and_b32 v5, 7, v1
    v_lshlrev_b32 v5, 1, v5
    v_mov_b32 v6, 0
    s_waitcnt lgkmcnt(0)
    s_mov_b32 s8, s6
    s_and_b32 s9, s7, 0xffff
    s_mov_b32 s10, 0xe50000
    s_mov_b32 s11, 0x00020000
    s_add_u32 s29, s28, 0
    buffer_load_dwordx4 v[10:13], v4, s[8:11], s29 offen
    s_add_u32 s29, s28, 1572864
    buffer_load_dwordx4 v[14:17], v4, s[8:11], s29 offen
    s_add_u32 s29, s28, 3145728
    buffer_load_dwordx4 v[18:21], v4, s[8:11], s29 offen
    buffer_load_dwordx4 v[22:25], v6, s[8:11], s28 offen
    buffer_load_ushort v26, v5, s[8:11], s28 offen
    v_lshrrev_b32 v7, 4, v0
    v_cmp_le_u32 vcc, 6, v7
    s_nop 1
    v_cndmask_b32 v8, 0, 1, vcc
    v_mul_u32_u24 v9, 6, v8
    v_sub_u32 v7, v7, v9
    v_cmp_le_u32 vcc, 3, v7
    s_nop 1
    v_addc_co_u32 v7, vcc, 0, v7, vcc
    v_mul_u32_u24 v8, 16384, v8
    v_lshl_add_u32 v8, v7, 7, v8
    v_and_b32 v7, 7, v0
    v_lshl_add_u32 v8, v7, 4, v8
    v_bfe_u32 v7, v0, 3, 1
    v_lshl_add_u32 v8, v7, 10, v8
    s_lshr_b32 s30, s3, 3
    s_mul_i32 s30, s30, 98304
    s_bfe_u32 s31, s3, 0x10002
    s_mul_i32 s31, s31, 8192
    s_add_u32 s30, s30, s31
    s_and_b32 s31, s3, 3
    s_lshl_b32 s31, s31, 11
    s_add_u32 s30, s30, s31
    s_add_u32 s30, s30, 11862016
    s_mov_b32 s26, 0x3ae38e39
    v_lshrrev_b32 v9, 4, v0
    v_lshlrev_b32 v9, 4, v9
    v_and_b32 v27, 15, v1
    v_cmp_eq_u32 s[34:35], 0, v27
    v_and_b32 v28, 8, v1
    v_cmp_eq_u32 s[36:37], 0, v28
    v_lshlrev_b32 v27, 2, v27
    s_waitcnt vmcnt(0)
    v_lshlrev_b32 v32, 16, v10
    v_and_b32 v33, 0xffff0000, v10
    v_lshlrev_b32 v34, 16, v11
    v_and_b32 v35, 0xffff0000, v11
    v_lshlrev_b32 v36, 16, v12
    v_and_b32 v37, 0xffff0000, v12
    v_lshlrev_b32 v38, 16, v13
    v_and_b32 v39, 0xffff0000, v13
    v_lshlrev_b32 v40, 16, v14
    v_and_b32 v41, 0xffff0000, v14
    v_lshlrev_b32 v42, 16, v15
    v_and_b32 v43, 0xffff0000, v15
    v_lshlrev_b32 v44, 16, v16
    v_and_b32 v45, 0xffff0000, v16
    v_lshlrev_b32 v46, 16, v17
    v_and_b32 v47, 0xffff0000, v17
    v_lshlrev_b32 v48, 16, v18
    v_and_b32 v49, 0xffff0000, v18
    v_lshlrev_b32 v50, 16, v19
    v_and_b32 v51, 0xffff0000, v19
    v_lshlrev_b32 v52, 16, v20
    v_and_b32 v53, 0xffff0000, v20
    v_lshlrev_b32 v54, 16, v21
    v_and_b32 v55, 0xffff0000, v21
    v_lshlrev_b32 v56, 16, v22
    v_and_b32 v57, 0xffff0000, v22
    v_lshlrev_b32 v58, 16, v23
    v_and_b32 v59, 0xffff0000, v23
    v_lshlrev_b32 v60, 16, v24
    v_and_b32 v61, 0xffff0000, v24
    v_lshlrev_b32 v62, 16, v25
    v_and_b32 v63, 0xffff0000, v25
    v_lshlrev_b32 v26, 16, v26
    v_pk_add_f32 v[80:81], v[32:33], v[56:57] neg_lo:[0,1] neg_hi:[0,1]
    v_pk_add_f32 v[82:83], v[34:35], v[58:59] neg_lo:[0,1] neg_hi:[0,1]
    v_pk_add_f32 v[84:85], v[36:37], v[60:61] neg_lo:[0,1] neg_hi:[0,1]
    v_pk_add_f32 v[86:87], v[38:39], v[62:63] neg_lo:[0,1] neg_hi:[0,1]
    v_pk_add_f32 v[88:89], v[40:41], v[56:57] neg_lo:[0,1] neg_hi:[0,1]
    v_pk_add_f32 v[90:91], v[42:43], v[58:59] neg_lo:[0,1] neg_hi:[0,1]
    v_pk_add_f32 v[92:93], v[44:45], v[60:61] neg_lo:[0,1] neg_hi:[0,1]
    v_pk_add_f32 v[94:95], v[46:47], v[62:63] neg_lo:[0,1] neg_hi:[0,1]
    v_pk_add_f32 v[96:97], v[48:49], v[56:57] neg_lo:[0,1] neg_hi:[0,1]
    v_pk_add_f32 v[98:99], v[50:51], v[58:59] neg_lo:[0,1] neg_hi:[0,1]
    v_pk_add_f32 v[100:101], v[52:53], v[60:61] neg_lo:[0,1] neg_hi:[0,1]
    v_pk_add_f32 v[102:103], v[54:55], v[62:63] neg_lo:[0,1] neg_hi:[0,1]
    v_pk_add_f32 v[64:65], v[80:81], v[88:89]
    v_pk_mul_f32 v[72:73], v[80:81], v[80:81]
    v_pk_add_f32 v[66:67], v[82:83], v[90:91]
    v_pk_mul_f32 v[74:75], v[82:83], v[82:83]
    v_pk_add_f32 v[68:69], v[84:85], v[92:93]
    v_pk_mul_f32 v[76:77], v[84:85], v[84:85]
    v_pk_add_f32 v[70:71], v[86:87], v[94:95]
    v_pk_mul_f32 v[78:79], v[86:87], v[86:87]
    v_pk_add_f32 v[64:65], v[64:65], v[96:97]
    v_pk_fma_f32 v[72:73], v[88:89], v[88:89], v[72:73]
    v_pk_add_f32 v[66:67], v[66:67], v[98:99]
    v_pk_fma_f32 v[74:75], v[90:91], v[90:91], v[74:75]
    v_pk_add_f32 v[68:69], v[68:69], v[100:101]
    v_pk_fma_f32 v[76:77], v[92:93], v[92:93], v[76:77]
    v_pk_add_f32 v[70:71], v[70:71], v[102:103]
    v_pk_fma_f32 v[78:79], v[94:95], v[94:95], v[78:79]
    v_pk_fma_f32 v[72:73], v[96:97], v[96:97], v[72:73]
    v_pk_fma_f32 v[74:75], v[98:99], v[98:99], v[74:75]
    v_pk_fma_f32 v[76:77], v[100:101], v[100:101], v[76:77]
    v_pk_fma_f32 v[78:79], v[102:103], v[102:103], v[78:79]
    v_permlane32_swap_b32 v64, v72
    v_permlane32_swap_b32 v65, v73
    v_permlane32_swap_b32 v66, v74
    v_permlane32_swap_b32 v67, v75
    v_permlane32_swap_b32 v68, v76
    v_permlane32_swap_b32 v69, v77
    v_permlane32_swap_b32 v70, v78
    v_permlane32_swap_b32 v71, v79
    v_pk_add_f32 v[64:65], v[64:65], v[72:73]
    v_pk_add_f32 v[66:67], v[66:67], v[74:75]
    v_pk_add_f32 v[68:69], v[68:69], v[76:77]
    v_pk_add_f32 v[70:71], v[70:71], v[78:79]
    s_nop 0
    v_permlane16_swap_b32 v64, v68
    v_permlane16_swap_b32 v65, v69
    v_permlane16_swap_b32 v66, v70
    v_permlane16_swap_b32 v67, v71
    v_pk_add_f32 v[64:65], v[64:65], v[68:69]
    v_pk_add_f32 v[66:67], v[66:67], v[70:71]
    s_nop 0
    v_add_f32_dpp v64, v64, v64 quad_perm:[1,0,3,2] row_mask:0xf bank_mask:0xf
    v_add_f32_dpp v65, v65, v65 quad_perm:[1,0,3,2] row_mask:0xf bank_mask:0xf
    v_add_f32_dpp v66, v66, v66 quad_perm:[1,0,3,2] row_mask:0xf bank_mask:0xf
    v_add_f32_dpp v67, v67, v67 quad_perm:[1,0,3,2] row_mask:0xf bank_mask:0xf
    v_add_f32_dpp v64, v64, v64 quad_perm:[2,3,0,1] row_mask:0xf bank_mask:0xf
    v_add_f32_dpp v65, v65, v65 quad_perm:[2,3,0,1] row_mask:0xf bank_mask:0xf
    v_add_f32_dpp v66, v66, v66 quad_perm:[2,3,0,1] row_mask:0xf bank_mask:0xf
    v_add_f32_dpp v67, v67, v67 quad_perm:[2,3,0,1] row_mask:0xf bank_mask:0xf
    v_add_f32_dpp v64, v64, v64 row_half_mirror row_mask:0xf bank_mask:0xf
    v_add_f32_dpp v65, v65, v65 row_half_mirror row_mask:0xf bank_mask:0xf
    v_add_f32_dpp v66, v66, v66 row_half_mirror row_mask:0xf bank_mask:0xf
    v_add_f32_dpp v67, v67, v67 row_half_mirror row_mask:0xf bank_mask:0xf
    v_add_f32_dpp v64, v64, v64 row_mirror row_mask:0xf bank_mask:0xf
    v_add_f32_dpp v65, v65, v65 row_mirror row_mask:0xf bank_mask:0xf
    v_add_f32_dpp v66, v66, v66 row_mirror row_mask:0xf bank_mask:0xf
    v_add_f32_dpp v67, v67, v67 row_mirror row_mask:0xf bank_mask:0xf
    s_mov_b64 exec, s[34:35]
    ds_write_b128 v9, v[64:67]
    s_mov_b64 exec, -1
    s_waitcnt lgkmcnt(0)
    s_barrier
    ds_read_b32 v80, v27 offset:0
    ds_read_b32 v81, v27 offset:64
    ds_read_b32 v82, v27 offset:128
    s_waitcnt lgkmcnt(0)
    v_add_f32 v80, v80, v81
    v_add_f32 v80, v80, v82
    s_nop 1
    v_mov_b32_dpp v81, v80 row_ror:8 row_mask:0xf bank_mask:0xf
    v_cndmask_b32 v82, v81, v80, s[36:37]
    v_cndmask_b32 v83, v80, v81, s[36:37]
    v_mul_f32 v82, s26, v82
    v_mul_f32 v83, s26, v83
    v_fma_f32 v83, -v82, v82, v83
    v_max_f32 v83, 0, v83
    v_add_f32 v82, v82, v26
    v_cvt_pk_bf16_f32 v82, v82, v82
    v_and_b32 v82, 0xffff0000, v82
    v_cvt_pk_bf16_f32 v83, v83, v83
    v_and_b32 v83, 0xffff0000, v83
    v_add_f32 v83, 0x3727c5ac, v83
    v_cvt_pk_bf16_f32 v83, v83, v83
    v_and_b32 v83, 0xffff0000, v83
    v_sqrt_f32 v83, v83
    s_nop 0
    v_cvt_pk_bf16_f32 v83, v83, v83
    v_and_b32 v83, 0xffff0000, v83
    v_rcp_f32 v83, v83
    v_readlane_b32 s40, v82, 0
    v_readlane_b32 s41, v82, 1
    v_readlane_b32 s42, v82, 2
    v_readlane_b32 s43, v82, 3
    v_readlane_b32 s44, v82, 4
    v_readlane_b32 s45, v82, 5
    v_readlane_b32 s46, v82, 6
    v_readlane_b32 s47, v82, 7
    v_readlane_b32 s48, v83, 0
    v_readlane_b32 s49, v83, 1
    v_readlane_b32 s50, v83, 2
    v_readlane_b32 s51, v83, 3
    v_readlane_b32 s52, v83, 4
    v_readlane_b32 s53, v83, 5
    v_readlane_b32 s54, v83, 6
    v_readlane_b32 s55, v83, 7
    v_pk_add_f32 v[32:33], v[32:33], s[40:41] neg_lo:[0,1] neg_hi:[0,1]
    v_pk_add_f32 v[34:35], v[34:35], s[42:43] neg_lo:[0,1] neg_hi:[0,1]
    v_pk_add_f32 v[36:37], v[36:37], s[44:45] neg_lo:[0,1] neg_hi:[0,1]
    v_pk_add_f32 v[38:39], v[38:39], s[46:47] neg_lo:[0,1] neg_hi:[0,1]
    v_pk_mul_f32 v[32:33], v[32:33], s[48:49]
    v_pk_mul_f32 v[34:35], v[34:35], s[50:51]
    v_pk_mul_f32 v[36:37], v[36:37], s[52:53]
    v_pk_mul_f32 v[38:39], v[38:39], s[54:55]
    v_cvt_pk_bf16_f32 v10, v32, v33
    v_cvt_pk_bf16_f32 v11, v34, v35
    v_cvt_pk_bf16_f32 v12, v36, v37
    v_cvt_pk_bf16_f32 v13, v38, v39
    s_add_u32 s31, s30, 0
    buffer_store_dwordx4 v[10:13], v8, s[8:11], s31 offen
    v_pk_add_f32 v[40:41], v[40:41], s[40:41] neg_lo:[0,1] neg_hi:[0,1]
    v_pk_add_f32 v[42:43], v[42:43], s[42:43] neg_lo:[0,1] neg_hi:[0,1]
    v_pk_add_f32 v[44:45], v[44:45], s[44:45] neg_lo:[0,1] neg_hi:[0,1]
    v_pk_add_f32 v[46:47], v[46:47], s[46:47] neg_lo:[0,1] neg_hi:[0,1]
    v_pk_mul_f32 v[40:41], v[40:41], s[48:49]
    v_pk_mul_f32 v[42:43], v[42:43], s[50:51]
    v_pk_mul_f32 v[44:45], v[44:45], s[52:53]
    v_pk_mul_f32 v[46:47], v[46:47], s[54:55]
    v_cvt_pk_bf16_f32 v14, v40, v41
    v_cvt_pk_bf16_f32 v15, v42, v43
    v_cvt_pk_bf16_f32 v16, v44, v45
    v_cvt_pk_bf16_f32 v17, v46, v47
    s_add_u32 s31, s30, 32768
    buffer_store_dwordx4 v[14:17], v8, s[8:11], s31 offen
    v_pk_add_f32 v[48:49], v[48:49], s[40:41] neg_lo:[0,1] neg_hi:[0,1]
    v_pk_add_f32 v[50:51], v[50:51], s[42:43] neg_lo:[0,1] neg_hi:[0,1]
    v_pk_add_f32 v[52:53], v[52:53], s[44:45] neg_lo:[0,1] neg_hi:[0,1]
    v_pk_add_f32 v[54:55], v[54:55], s[46:47] neg_lo:[0,1] neg_hi:[0,1]
    v_pk_mul_f32 v[48:49], v[48:49], s[48:49]
    v_pk_mul_f32 v[50:51], v[50:51], s[50:51]
    v_pk_mul_f32 v[52:53], v[52:53], s[52:53]
    v_pk_mul_f32 v[54:55], v[54:55], s[54:55]
    v_cvt_pk_bf16_f32 v18, v48, v49
    v_cvt_pk_bf16_f32 v19, v50, v51
    v_cvt_pk_bf16_f32 v20, v52, v53
    v_cvt_pk_bf16_f32 v21, v54, v55
    s_add_u32 s31, s30, 65536
    buffer_store_dwordx4 v[18:21], v8, s[8:11], s31 offen
    s_branch K3_END
K3_PF:
    s_cmp_ge_u32 s2, 384
    s_cbranch_scc1 K3_END
    s_load_dwordx2 s[16:17], s[0:1], 64
    s_load_dwordx2 s[18:19], s[0:1], 80
    v_and_b32 v1, 63, v0
    v_lshrrev_b32 v2, 6, v0
    s_nop 0
    v_readfirstlane_b32 s27, v2
    s_sub_u32 s3, s2, 256
    s_lshr_b32 s3, s3, 3
    s_mul_i32 s3, s3, 3
    s_add_u32 s3, s3, s27
    s_and_b32 s4, s2, 7
    s_waitcnt lgkmcnt(0)
    s_cmp_lg_u32 s27, 0
    s_cbranch_scc1 PF_CP_1
    s_getpc_b64 s[40:41]
CPF_B:
    s_add_u32 s40, s40, k4_kernel-CPF_B
    s_addc_u32 s41, s41, 0
    v_lshlrev_b32 v90, 7, v1
    v_min_u32 v91, k5_kernel-k4_kernel-4, v90
    global_load_dword v92, v91, s[40:41]
    v_add_u32 v91, 8192, v90
    v_min_u32 v91, k5_kernel-k4_kernel-4, v91
    global_load_dword v93, v91, s[40:41]
PF_CP_1:
    s_mov_b32 s8, s16
    s_and_b32 s9, s17, 0xffff
    s_mov_b32 s10, 0x7e0000
    s_mov_b32 s11, 0x00020000
    s_lshr_b32 s34, s4, 1
    s_lshl_b32 s34, s34, 4
    s_mov_b32 s35, 0x33214320
    s_cmp_ge_u32 s34, 32
    s_cselect_b32 s35, 0x43104210, s35
    s_and_b32 s34, s34, 16
    s_lshr_b32 s35, s35, s34
    v_bfe_u32 v5, v1, 1, 2
    v_lshlrev_b32 v5, 2, v5
    v_lshrrev_b32 v5, v5, s35
    v_and_b32 v5, 15, v5
    s_mul_i32 s34, s4, 4617
    s_lshr_b32 s34, s34, 10
    v_add_u32 v5, s34, v5
    v_lshrrev_b32 v4, 3, v1
    v_mul_u32_u24 v4, 9216, v4
    v_lshl_add_u32 v4, v5, 8, v4
    v_and_b32 v5, 1, v1
    v_lshl_add_u32 v4, v5, 7, v4
    s_mul_i32 s20, s3, 73728
    s_add_u32 s20, s20, 5898240
    s_cmp_ge_u32 s20, 8257536
    s_cbranch_scc1 PF_SK3_2
    buffer_load_dword v60, v4, s[8:11], s20 offen
PF_SK3_2:
    s_branch K3_END
K3_END:
    s_endpgm
.globl k4_kernel
.p2align 8
.type k4_kernel,@function
k4_kernel:
    s_cmp_ge_u32 s2, 256
    s_cbranch_scc1 K4_END
    s_cmp_ge_u32 s2, 216
    s_cbranch_scc1 K4_PREF
    s_load_dwordx2 s[6:7], s[0:1], 112
    s_load_dwordx4 s[16:19], s[0:1], 64
    s_load_dwordx2 s[20:21], s[0:1], 96
    v_lshrrev_b32 v2, 6, v0
    s_nop 0
    v_readfirstlane_b32 s27, v2
    s_and_b32 s22, s2, 7
    s_lshr_b32 s23, s2, 3
    s_mul_i32 s3, s22, 27
    s_mul_i32 s24, s3, 171
    s_lshr_b32 s24, s24, 10
    s_add_u32 s3, s3, s23
    s_mul_i32 s4, s3, 171
    s_lshr_b32 s4, s4, 10
    s_mul_i32 s5, s4, 6
    s_sub_u32 s5, s3, s5
    v_and_b32 v1, 63, v0
    v_lshrrev_b32 v2, 6, v0
    s_nop 0
    v_readfirstlane_b32 s27, v2
    v_lshrrev_b32 v3, 4, v1
    s_waitcnt lgkmcnt(0)
    s_mov_b32 s8, s16
    s_and_b32 s9, s17, 0xffff
    s_mov_b32 s10, 0x1200000
    s_mov_b32 s11, 0x00020000
    s_mov_b32 s12, s6
    s_and_b32 s13, s7, 0xffff
    s_mov_b32 s14, 0x22a0000
    s_mov_b32 s15, 0x00020000
    s_cmp_ge_u32 s27, 4
    s_cbranch_scc1 K4_PROD
    s_lshr_b32 s28, s27, 1
    s_and_b32 s29, s27, 1
    v_bfe_u32 v8, v1, 2, 2
    v_and_b32 v9, 3, v1
    v_and_b32 v10, 1, v3
    v_lshl_add_u32 v10, v10, 2, v8
    v_lshl_add_u32 v11, v3, 3, v8
    s_mul_i32 s30, s28, 4
    v_xor_b32 v10, s30, v10
    s_movk_i32 s30, 256
    v_mul_lo_u32 v11, v11, s30
    v_lshl_add_u32 v11, v9, 3, v11
    v_xor_b32 v12, 0, v10
    v_lshl_add_u32 v4, v12, 5, v11
    v_xor_b32 v12, 1, v10
    v_lshl_add_u32 v5, v12, 5, v11
    v_xor_b32 v12, 2, v10
    v_lshl_add_u32 v6, v12, 5, v11
    v_xor_b32 v12, 3, v10
    v_lshl_add_u32 v7, v12, 5, v11
    s_mul_i32 s30, s29, 3072
    s_add_u32 s30, s30, 65536
    v_lshlrev_b32 v8, 4, v1
    v_add_u32 v8, s30, v8
    v_add_u32 v9, 36864, v8
    s_mov_b32 s16, s18
    s_and_b32 s17, s19, 0xffff
    s_mov_b32 s18, 0x2400
    s_mov_b32 s19, 0x00020000
    s_mul_i32 s30, s4, 256
    s_mul_i32 s31, s28, 128
    s_add_u32 s30, s30, s31
    v_lshlrev_b32 v10, 3, v3
    buffer_load_dwordx2 v[16:17], v10, s[16:19], s30 offen offset:0
    buffer_load_dwordx2 v[18:19], v10, s[16:19], s30 offen offset:32
    buffer_load_dwordx2 v[20:21], v10, s[16:19], s30 offen offset:64
    buffer_load_dwordx2 v[22:23], v10, s[16:19], s30 offen offset:96
    v_mov_b32 v160, 0
    v_mov_b32 v161, 0
    v_mov_b32 v162, 0
    v_mov_b32 v163, 0
    v_mov_b32 v164, 0
    v_mov_b32 v165, 0
    v_mov_b32 v166, 0
    v_mov_b32 v167, 0
    v_mov_b32 v168, 0
    v_mov_b32 v169, 0
    v_mov_b32 v170, 0
    v_mov_b32 v171, 0
    v_mov_b32 v172, 0
    v_mov_b32 v173, 0
    v_mov_b32 v174, 0
    v_mov_b32 v175, 0
    v_mov_b32 v176, 0
    v_mov_b32 v177, 0
    v_mov_b32 v178, 0
    v_mov_b32 v179, 0
    v_mov_b32 v180, 0
    v_mov_b32 v181, 0
    v_mov_b32 v182, 0
    v_mov_b32 v183, 0
    v_mov_b32 v184, 0
    v_mov_b32 v185, 0
    v_mov_b32 v186, 0
    v_mov_b32 v187, 0
    v_mov_b32 v188, 0
    v_mov_b32 v189, 0
    v_mov_b32 v190, 0
    v_mov_b32 v191, 0
    v_mov_b32 v192, 0
    v_mov_b32 v193, 0
    v_mov_b32 v194, 0
    v_mov_b32 v195, 0
    v_mov_b32 v196, 0
    v_mov_b32 v197, 0
    v_mov_b32 v198, 0
    v_mov_b32 v199, 0
    v_mov_b32 v200, 0
    v_mov_b32 v201, 0
    v_mov_b32 v202, 0
    v_mov_b32 v203, 0
    v_mov_b32 v204, 0
    v_mov_b32 v205, 0
    v_mov_b32 v206, 0
    v_mov_b32 v207, 0
    s_barrier
    ds_read_b64_tr_b16 v[32:33], v4 offset:0
    ds_read_b64_tr_b16 v[34:35], v4 offset:1024
    ds_read_b128 v[48:51], v8 offset:0
    ds_read_b128 v[52:55], v8 offset:1024
    ds_read_b128 v[56:59], v8 offset:2048
    ds_read_b64_tr_b16 v[36:37], v5 offset:0
    ds_read_b64_tr_b16 v[38:39], v5 offset:1024
    ds_read_b64_tr_b16 v[40:41], v6 offset:0
    ds_read_b64_tr_b16 v[42:43], v6 offset:1024
    ds_read_b64_tr_b16 v[44:45], v7 offset:0
    ds_read_b64_tr_b16 v[46:47], v7 offset:1024
    ds_read_b64_tr_b16 v[60:61], v4 offset:8192
    ds_read_b64_tr_b16 v[62:63], v4 offset:9216
    ds_read_b128 v[76:79], v8 offset:6144
    ds_read_b128 v[80:83], v8 offset:7168
    ds_read_b128 v[84:87], v8 offset:8192
    ds_read_b64_tr_b16 v[64:65], v5 offset:8192
    ds_read_b64_tr_b16 v[66:67], v5 offset:9216
    ds_read_b64_tr_b16 v[68:69], v6 offset:8192
    ds_read_b64_tr_b16 v[70:71], v6 offset:9216
    ds_read_b64_tr_b16 v[72:73], v7 offset:8192
    ds_read_b64_tr_b16 v[74:75], v7 offset:9216
    s_movk_i32 s31, 7
K4_CLOOP:
    s_waitcnt lgkmcnt(15)
    v_mfma_f32_16x16x32_bf16 v[160:163], v[32:35], v[48:51], v[160:163]
    v_mfma_f32_16x16x32_bf16 v[164:167], v[32:35], v[52:55], v[164:167]
    v_mfma_f32_16x16x32_bf16 v[168:171], v[32:35], v[56:59], v[168:171]
    v_mfma_f32_16x16x32_bf16 v[172:175], v[36:39], v[48:51], v[172:175]
    s_waitcnt lgkmcnt(0)
    s_barrier
    v_mfma_f32_16x16x32_bf16 v[176:179], v[36:39], v[52:55], v[176:179]
    ds_read_b64_tr_b16 v[88:89], v4 offset:16384
    ds_read_b64_tr_b16 v[90:91], v4 offset:17408
    v_mfma_f32_16x16x32_bf16 v[180:183], v[36:39], v[56:59], v[180:183]
    ds_read_b128 v[104:107], v8 offset:12288
    ds_read_b128 v[108:111], v8 offset:13312
    v_mfma_f32_16x16x32_bf16 v[184:187], v[40:43], v[48:51], v[184:187]
    ds_read_b128 v[112:115], v8 offset:14336
    ds_read_b64_tr_b16 v[92:93], v5 offset:16384
    v_mfma_f32_16x16x32_bf16 v[188:191], v[40:43], v[52:55], v[188:191]
    ds_read_b64_tr_b16 v[94:95], v5 offset:17408
    v_mfma_f32_16x16x32_bf16 v[192:195], v[40:43], v[56:59], v[192:195]
    ds_read_b64_tr_b16 v[96:97], v6 offset:16384
    v_mfma_f32_16x16x32_bf16 v[196:199], v[44:47], v[48:51], v[196:199]
    ds_read_b64_tr_b16 v[98:99], v6 offset:17408
    v_mfma_f32_16x16x32_bf16 v[200:203], v[44:47], v[52:55], v[200:203]
    ds_read_b64_tr_b16 v[100:101], v7 offset:16384
    v_mfma_f32_16x16x32_bf16 v[204:207], v[44:47], v[56:59], v[204:207]
    ds_read_b64_tr_b16 v[102:103], v7 offset:17408
    v_mfma_f32_16x16x32_bf16 v[160:163], v[60:63], v[76:79], v[160:163]
    ds_read_b64_tr_b16 v[116:117], v4 offset:24576
    v_mfma_f32_16x16x32_bf16 v[164:167], v[60:63], v[80:83], v[164:167]
    ds_read_b64_tr_b16 v[118:119], v4 offset:25600
    v_mfma_f32_16x16x32_bf16 v[168:171], v[60:63], v[84:87], v[168:171]
    ds_read_b128 v[132:135], v8 offset:18432
    v_mfma_f32_16x16x32_bf16 v[172:175], v[64:67], v[76:79], v[172:175]
    ds_read_b128 v[136:139], v8 offset:19456
    v_mfma_f32_16x16x32_bf16 v[176:179], v[64:67], v[80:83], v[176:179]
    ds_read_b128 v[140:143], v8 offset:20480
    v_mfma_f32_16x16x32_bf16 v[180:183], v[64:67], v[84:87], v[180:183]
    ds_read_b64_tr_b16 v[120:121], v5 offset:24576
    v_mfma_f32_16x16x32_bf16 v[184:187], v[68:71], v[76:79], v[184:187]
    ds_read_b64_tr_b16 v[122:123], v5 offset:25600
    v_mfma_f32_16x16x32_bf16 v[188:191], v[68:71], v[80:83], v[188:191]
    ds_read_b64_tr_b16 v[124:125], v6 offset:24576
    v_mfma_f32_16x16x32_bf16 v[192:195], v[68:71], v[84:87], v[192:195]
    ds_read_b64_tr_b16 v[126:127], v6 offset:25600
    v_mfma_f32_16x16x32_bf16 v[196:199], v[72:75], v[76:79], v[196:199]
    ds_read_b64_tr_b16 v[128:129], v7 offset:24576
    v_mfma_f32_16x16x32_bf16 v[200:203], v[72:75], v[80:83], v[200:203]
    ds_read_b64_tr_b16 v[130:131], v7 offset:25600
    v_mfma_f32_16x16x32_bf16 v[204:207], v[72:75], v[84:87], v[204:207]
    s_waitcnt lgkmcnt(15)
    v_mfma_f32_16x16x32_bf16 v[160:163], v[88:91], v[104:107], v[160:163]
    v_mfma_f32_16x16x32_bf16 v[164:167], v[88:91], v[108:111], v[164:167]
    v_mfma_f32_16x16x32_bf16 v[168:171], v[88:91], v[112:115], v[168:171]
    v_mfma_f32_16x16x32_bf16 v[172:175], v[92:95], v[104:107], v[172:175]
    s_waitcnt lgkmcnt(0)
    s_barrier
    v_mfma_f32_16x16x32_bf16 v[176:179], v[92:95], v[108:111], v[176:179]
    ds_read_b64_tr_b16 v[32:33], v4 offset:32768
    ds_read_b64_tr_b16 v[34:35], v4 offset:33792
    v_mfma_f32_16x16x32_bf16 v[180:183], v[92:95], v[112:115], v[180:183]
    ds_read_b128 v[48:51], v8 offset:24576
    ds_read_b128 v[52:55], v8 offset:25600
    v_mfma_f32_16x16x32_bf16 v[184:187], v[96:99], v[104:107], v[184:187]
    ds_read_b128 v[56:59], v8 offset:26624
    ds_read_b64_tr_b16 v[36:37], v5 offset:32768
    v_mfma_f32_16x16x32_bf16 v[188:191], v[96:99], v[108:111], v[188:191]
    ds_read_b64_tr_b16 v[38:39], v5 offset:33792
    v_mfma_f32_16x16x32_bf16 v[192:195], v[96:99], v[112:115], v[192:195]
    ds_read_b64_tr_b16 v[40:41], v6 offset:32768
    v_mfma_f32_16x16x32_bf16 v[196:199], v[100:103], v[104:107], v[196:199]
    ds_read_b64_tr_b16 v[42:43], v6 offset:33792
    v_mfma_f32_16x16x32_bf16 v[200:203], v[100:103], v[108:111], v[200:203]
    ds_read_b64_tr_b16 v[44:45], v7 offset:32768
    v_mfma_f32_16x16x32_bf16 v[204:207], v[100:103], v[112:115], v[204:207]
    ds_read_b64_tr_b16 v[46:47], v7 offset:33792
    v_mfma_f32_16x16x32_bf16 v[160:163], v[116:119], v[132:135], v[160:163]
    ds_read_b64_tr_b16 v[60:61], v4 offset:40960
    v_mfma_f32_16x16x32_bf16 v[164:167], v[116:119], v[136:139], v[164:167]
    ds_read_b64_tr_b16 v[62:63], v4 offset:41984
    v_mfma_f32_16x16x32_bf16 v[168:171], v[116:119], v[140:143], v[168:171]
    ds_read_b128 v[76:79], v8 offset:30720
    v_mfma_f32_16x16x32_bf16 v[172:175], v[120:123], v[132:135], v[172:175]
    ds_read_b128 v[80:83], v8 offset:31744
    v_mfma_f32_16x16x32_bf16 v[176:179], v[120:123], v[136:139], v[176:179]
    ds_read_b128 v[84:87], v8 offset:32768
    v_mfma_f32_16x16x32_bf16 v[180:183], v[120:123], v[140:143], v[180:183]
    ds_read_b64_tr_b16 v[64:65], v5 offset:40960
    v_mfma_f32_16x16x32_bf16 v[184:187], v[124:127], v[132:135], v[184:187]
    ds_read_b64_tr_b16 v[66:67], v5 offset:41984
    v_mfma_f32_16x16x32_bf16 v[188:191], v[124:127], v[136:139], v[188:191]
    ds_read_b64_tr_b16 v[68:69], v6 offset:40960
    v_mfma_f32_16x16x32_bf16 v[192:195], v[124:127], v[140:143], v[192:195]
    ds_read_b64_tr_b16 v[70:71], v6 offset:41984
    v_mfma_f32_16x16x32_bf16 v[196:199], v[128:131], v[132:135], v[196:199]
    ds_read_b64_tr_b16 v[72:73], v7 offset:40960
    v_mfma_f32_16x16x32_bf16 v[200:203], v[128:131], v[136:139], v[200:203]
    ds_read_b64_tr_b16 v[74:75], v7 offset:41984
    v_mfma_f32_16x16x32_bf16 v[204:207], v[128:131], v[140:143], v[204:207]
    s_waitcnt lgkmcnt(15)
    v_mfma_f32_16x16x32_bf16 v[160:163], v[32:35], v[48:51], v[160:163]
    v_mfma_f32_16x16x32_bf16 v[164:167], v[32:35], v[52:55], v[164:167]
    v_mfma_f32_16x16x32_bf16 v[168:171], v[32:35], v[56:59], v[168:171]
    v_mfma_f32_16x16x32_bf16 v[172:175], v[36:39], v[48:51], v[172:175]
    s_waitcnt lgkmcnt(0)
    s_barrier
    v_mfma_f32_16x16x32_bf16 v[176:179], v[36:39], v[52:55], v[176:179]
    ds_read_b64_tr_b16 v[88:89], v4 offset:49152
    ds_read_b64_tr_b16 v[90:91], v4 offset:50176
    v_mfma_f32_16x16x32_bf16 v[180:183], v[36:39], v[56:59], v[180:183]
    ds_read_b128 v[104:107], v9 offset:0
    ds_read_b128 v[108:111], v9 offset:1024
    v_mfma_f32_16x16x32_bf16 v[184:187], v[40:43], v[48:51], v[184:187]
    ds_read_b128 v[112:115], v9 offset:2048
    ds_read_b64_tr_b16 v[92:93], v5 offset:49152
    v_mfma_f32_16x16x32_bf16 v[188:191], v[40:43], v[52:55], v[188:191]
    ds_read_b64_tr_b16 v[94:95], v5 offset:50176
    v_mfma_f32_16x16x32_bf16 v[192:195], v[40:43], v[56:59], v[192:195]
    ds_read_b64_tr_b16 v[96:97], v6 offset:49152
    v_mfma_f32_16x16x32_bf16 v[196:199], v[44:47], v[48:51], v[196:199]
    ds_read_b64_tr_b16 v[98:99], v6 offset:50176
    v_mfma_f32_16x16x32_bf16 v[200:203], v[44:47], v[52:55], v[200:203]
    ds_read_b64_tr_b16 v[100:101], v7 offset:49152
    v_mfma_f32_16x16x32_bf16 v[204:207], v[44:47], v[56:59], v[204:207]
    ds_read_b64_tr_b16 v[102:103], v7 offset:50176
    v_mfma_f32_16x16x32_bf16 v[160:163], v[60:63], v[76:79], v[160:163]
    ds_read_b64_tr_b16 v[116:117], v4 offset:57344
    v_mfma_f32_16x16x32_bf16 v[164:167], v[60:63], v[80:83], v[164:167]
    ds_read_b64_tr_b16 v[118:119], v4 offset:58368
    v_mfma_f32_16x16x32_bf16 v[168:171], v[60:63], v[84:87], v[168:171]
    ds_read_b128 v[132:135], v9 offset:6144
    v_mfma_f32_16x16x32_bf16 v[172:175], v[64:67], v[76:79], v[172:175]
    ds_read_b128 v[136:139], v9 offset:7168
    v_mfma_f32_16x16x32_bf16 v[176:179], v[64:67], v[80:83], v[176:179]
    ds_read_b128 v[140:143], v9 offset:8192
    v_mfma_f32_16x16x32_bf16 v[180:183], v[64:67], v[84:87], v[180:183]
    ds_read_b64_tr_b16 v[120:121], v5 offset:57344
    v_mfma_f32_16x16x32_bf16 v[184:187], v[68:71], v[76:79], v[184:187]
    ds_read_b64_tr_b16 v[122:123], v5 offset:58368
    v_mfma_f32_16x16x32_bf16 v[188:191], v[68:71], v[80:83], v[188:191]
    ds_read_b64_tr_b16 v[124:125], v6 offset:57344
    v_mfma_f32_16x16x32_bf16 v[192:195], v[68:71], v[84:87], v[192:195]
    ds_read_b64_tr_b16 v[126:127], v6 offset:58368
    v_mfma_f32_16x16x32_bf16 v[196:199], v[72:75], v[76:79], v[196:199]
    ds_read_b64_tr_b16 v[128:129], v7 offset:57344
    v_mfma_f32_16x16x32_bf16 v[200:203], v[72:75], v[80:83], v[200:203]
    ds_read_b64_tr_b16 v[130:131], v7 offset:58368
    v_mfma_f32_16x16x32_bf16 v[204:207], v[72:75], v[84:87], v[204:207]
    s_waitcnt lgkmcnt(15)
    v_mfma_f32_16x16x32_bf16 v[160:163], v[88:91], v[104:107], v[160:163]
    v_mfma_f32_16x16x32_bf16 v[164:167], v[88:91], v[108:111], v[164:167]
    v_mfma_f32_16x16x32_bf16 v[168:171], v[88:91], v[112:115], v[168:171]
    v_mfma_f32_16x16x32_bf16 v[172:175], v[92:95], v[104:107], v[172:175]
    s_waitcnt lgkmcnt(0)
    s_barrier
    v_mfma_f32_16x16x32_bf16 v[176:179], v[92:95], v[108:111], v[176:179]
    ds_read_b64_tr_b16 v[32:33], v4 offset:0
    ds_read_b64_tr_b16 v[34:35], v4 offset:1024
    v_mfma_f32_16x16x32_bf16 v[180:183], v[92:95], v[112:115], v[180:183]
    ds_read_b128 v[48:51], v8 offset:0
    ds_read_b128 v[52:55], v8 offset:1024
    v_mfma_f32_16x16x32_bf16 v[184:187], v[96:99], v[104:107], v[184:187]
    ds_read_b128 v[56:59], v8 offset:2048
    ds_read_b64_tr_b16 v[36:37], v5 offset:0
    v_mfma_f32_16x16x32_bf16 v[188:191], v[96:99], v[108:111], v[188:191]
    ds_read_b64_tr_b16 v[38:39], v5 offset:1024
    v_mfma_f32_16x16x32_bf16 v[192:195], v[96:99], v[112:115], v[192:195]
    ds_read_b64_tr_b16 v[40:41], v6 offset:0
    v_mfma_f32_16x16x32_bf16 v[196:199], v[100:103], v[104:107], v[196:199]
    ds_read_b64_tr_b16 v[42:43], v6 offset:1024
    v_mfma_f32_16x16x32_bf16 v[200:203], v[100:103], v[108:111], v[200:203]
    ds_read_b64_tr_b16 v[44:45], v7 offset:0
    v_mfma_f32_16x16x32_bf16 v[204:207], v[100:103], v[112:115], v[204:207]
    ds_read_b64_tr_b16 v[46:47], v7 offset:1024
    v_mfma_f32_16x16x32_bf16 v[160:163], v[116:119], v[132:135], v[160:163]
    ds_read_b64_tr_b16 v[60:61], v4 offset:8192
    v_mfma_f32_16x16x32_bf16 v[164:167], v[116:119], v[136:139], v[164:167]
    ds_read_b64_tr_b16 v[62:63], v4 offset:9216
    v_mfma_f32_16x16x32_bf16 v[168:171], v[116:119], v[140:143], v[168:171]
    ds_read_b128 v[76:79], v8 offset:6144
    v_mfma_f32_16x16x32_bf16 v[172:175], v[120:123], v[132:135], v[172:175]
    ds_read_b128 v[80:83], v8 offset:7168
    v_mfma_f32_16x16x32_bf16 v[176:179], v[120:123], v[136:139], v[176:179]
    ds_read_b128 v[84:87], v8 offset:8192
    v_mfma_f32_16x16x32_bf16 v[180:183], v[120:123], v[140:143], v[180:183]
    ds_read_b64_tr_b16 v[64:65], v5 offset:8192
    v_mfma_f32_16x16x32_bf16 v[184:187], v[124:127], v[132:135], v[184:187]
    ds_read_b64_tr_b16 v[66:67], v5 offset:9216
    v_mfma_f32_16x16x32_bf16 v[188:191], v[124:127], v[136:139], v[188:191]
    ds_read_b64_tr_b16 v[68:69], v6 offset:8192
    v_mfma_f32_16x16x32_bf16 v[192:195], v[124:127], v[140:143], v[192:195]
    ds_read_b64_tr_b16 v[70:71], v6 offset:9216
    v_mfma_f32_16x16x32_bf16 v[196:199], v[128:131], v[132:135], v[196:199]
    ds_read_b64_tr_b16 v[72:73], v7 offset:8192
    v_mfma_f32_16x16x32_bf16 v[200:203], v[128:131], v[136:139], v[200:203]
    ds_read_b64_tr_b16 v[74:75], v7 offset:9216
    v_mfma_f32_16x16x32_bf16 v[204:207], v[128:131], v[140:143], v[204:207]
    s_sub_u32 s31, s31, 1
    s_cmp_lg_u32 s31, 0
    s_cbranch_scc1 K4_CLOOP
    s_waitcnt vmcnt(0)
    v_lshlrev_b32 v144, 16, v16
    v_and_b32 v145, 0xffff0000, v16
    v_lshlrev_b32 v146, 16, v17
    v_and_b32 v147, 0xffff0000, v17
    v_lshlrev_b32 v148, 16, v18
    v_and_b32 v149, 0xffff0000, v18
    v_lshlrev_b32 v150, 16, v19
    v_and_b32 v151, 0xffff0000, v19
    v_lshlrev_b32 v152, 16, v20
    v_and_b32 v153, 0xffff0000, v20
    v_lshlrev_b32 v154, 16, v21
    v_and_b32 v155, 0xffff0000, v21
    v_lshlrev_b32 v156, 16, v22
    v_and_b32 v157, 0xffff0000, v22
    v_lshlrev_b32 v158, 16, v23
    v_and_b32 v159, 0xffff0000, v23
    s_mov_b32 s34, 0xbdd2d3e8
    s_mov_b32 s35, 0xbdd2d3e8
    s_mov_b32 s36, 0x3f800000
    s_mov_b32 s37, 0x3f800000
    v_mov_b32 v30, 0xc0135761
    v_mov_b32 v31, 0xc0135761
    s_lshl_b32 s39, s4, 1
    s_add_u32 s38, s39, s28
    s_mul_i32 s38, s38, 6
    s_add_u32 s38, s38, s5
    s_mul_i32 s38, s38, 16384
    s_lshl_b32 s39, s29, 9
    s_add_u32 s38, s38, s39
    s_add_u32 s38, s38, 15007744
    v_lshrrev_b32 v28, 3, v1
    v_lshlrev_b32 v28, 10, v28
    v_and_b32 v29, 7, v1
    v_lshl_add_u32 v28, v29, 4, v28
    s_add_u32 s39, s38, 8192
    s_waitcnt lgkmcnt(15)
    v_mfma_f32_16x16x32_bf16 v[160:163], v[32:35], v[48:51], v[160:163]
    v_mfma_f32_16x16x32_bf16 v[164:167], v[32:35], v[52:55], v[164:167]
    v_mfma_f32_16x16x32_bf16 v[168:171], v[32:35], v[56:59], v[168:171]
    v_mfma_f32_16x16x32_bf16 v[172:175], v[36:39], v[48:51], v[172:175]
    s_waitcnt lgkmcnt(0)
    s_barrier
    v_mfma_f32_16x16x32_bf16 v[176:179], v[36:39], v[52:55], v[176:179]
    ds_read_b64_tr_b16 v[88:89], v4 offset:16384
    ds_read_b64_tr_b16 v[90:91], v4 offset:17408
    v_mfma_f32_16x16x32_bf16 v[180:183], v[36:39], v[56:59], v[180:183]
    ds_read_b128 v[104:107], v8 offset:12288
    ds_read_b128 v[108:111], v8 offset:13312
    v_mfma_f32_16x16x32_bf16 v[184:187], v[40:43], v[48:51], v[184:187]
    ds_read_b128 v[112:115], v8 offset:14336
    ds_read_b64_tr_b16 v[92:93], v5 offset:16384
    v_mfma_f32_16x16x32_bf16 v[188:191], v[40:43], v[52:55], v[188:191]
    ds_read_b64_tr_b16 v[94:95], v5 offset:17408
    v_mfma_f32_16x16x32_bf16 v[192:195], v[40:43], v[56:59], v[192:195]
    ds_read_b64_tr_b16 v[96:97], v6 offset:16384
    v_mfma_f32_16x16x32_bf16 v[196:199], v[44:47], v[48:51], v[196:199]
    ds_read_b64_tr_b16 v[98:99], v6 offset:17408
    v_mfma_f32_16x16x32_bf16 v[200:203], v[44:47], v[52:55], v[200:203]
    ds_read_b64_tr_b16 v[100:101], v7 offset:16384
    v_mfma_f32_16x16x32_bf16 v[204:207], v[44:47], v[56:59], v[204:207]
    ds_read_b64_tr_b16 v[102:103], v7 offset:17408
    v_mfma_f32_16x16x32_bf16 v[160:163], v[60:63], v[76:79], v[160:163]
    ds_read_b64_tr_b16 v[116:117], v4 offset:24576
    v_mfma_f32_16x16x32_bf16 v[164:167], v[60:63], v[80:83], v[164:167]
    ds_read_b64_tr_b16 v[118:119], v4 offset:25600
    v_mfma_f32_16x16x32_bf16 v[168:171], v[60:63], v[84:87], v[168:171]
    ds_read_b128 v[132:135], v8 offset:18432
    v_mfma_f32_16x16x32_bf16 v[172:175], v[64:67], v[76:79], v[172:175]
    ds_read_b128 v[136:139], v8 offset:19456
    v_mfma_f32_16x16x32_bf16 v[176:179], v[64:67], v[80:83], v[176:179]
    ds_read_b128 v[140:143], v8 offset:20480
    v_mfma_f32_16x16x32_bf16 v[180:183], v[64:67], v[84:87], v[180:183]
    ds_read_b64_tr_b16 v[120:121], v5 offset:24576
    v_mfma_f32_16x16x32_bf16 v[184:187], v[68:71], v[76:79], v[184:187]
    ds_read_b64_tr_b16 v[122:123], v5 offset:25600
    v_mfma_f32_16x16x32_bf16 v[188:191], v[68:71], v[80:83], v[188:191]
    ds_read_b64_tr_b16 v[124:125], v6 offset:24576
    v_mfma_f32_16x16x32_bf16 v[192:195], v[68:71], v[84:87], v[192:195]
    ds_read_b64_tr_b16 v[126:127], v6 offset:25600
    v_mfma_f32_16x16x32_bf16 v[196:199], v[72:75], v[76:79], v[196:199]
    ds_read_b64_tr_b16 v[128:129], v7 offset:24576
    v_mfma_f32_16x16x32_bf16 v[200:203], v[72:75], v[80:83], v[200:203]
    ds_read_b64_tr_b16 v[130:131], v7 offset:25600
    v_mfma_f32_16x16x32_bf16 v[204:207], v[72:75], v[84:87], v[204:207]
    s_waitcnt lgkmcnt(15)
    v_mfma_f32_16x16x32_bf16 v[160:163], v[88:91], v[104:107], v[160:163]
    v_mfma_f32_16x16x32_bf16 v[164:167], v[88:91], v[108:111], v[164:167]
    v_mfma_f32_16x16x32_bf16 v[168:171], v[88:91], v[112:115], v[168:171]
    v_mfma_f32_16x16x32_bf16 v[172:175], v[92:95], v[104:107], v[172:175]
    s_waitcnt lgkmcnt(0)
    s_barrier
    v_mfma_f32_16x16x32_bf16 v[176:179], v[92:95], v[108:111], v[176:179]
    ds_read_b64_tr_b16 v[32:33], v4 offset:32768
    ds_read_b64_tr_b16 v[34:35], v4 offset:33792
    v_mfma_f32_16x16x32_bf16 v[180:183], v[92:95], v[112:115], v[180:183]
    ds_read_b128 v[48:51], v8 offset:24576
    ds_read_b128 v[52:55], v8 offset:25600
    v_mfma_f32_16x16x32_bf16 v[184:187], v[96:99], v[104:107], v[184:187]
    ds_read_b128 v[56:59], v8 offset:26624
    ds_read_b64_tr_b16 v[36:37], v5 offset:32768
    v_mfma_f32_16x16x32_bf16 v[188:191], v[96:99], v[108:111], v[188:191]
    ds_read_b64_tr_b16 v[38:39], v5 offset:33792
    v_mfma_f32_16x16x32_bf16 v[192:195], v[96:99], v[112:115], v[192:195]
    ds_read_b64_tr_b16 v[40:41], v6 offset:32768
    v_mfma_f32_16x16x32_bf16 v[196:199], v[100:103], v[104:107], v[196:199]
    ds_read_b64_tr_b16 v[42:43], v6 offset:33792
    v_mfma_f32_16x16x32_bf16 v[200:203], v[100:103], v[108:111], v[200:203]
    ds_read_b64_tr_b16 v[44:45], v7 offset:32768
    v_mfma_f32_16x16x32_bf16 v[204:207], v[100:103], v[112:115], v[204:207]
    ds_read_b64_tr_b16 v[46:47], v7 offset:33792
    v_mfma_f32_16x16x32_bf16 v[160:163], v[116:119], v[132:135], v[160:163]
    ds_read_b64_tr_b16 v[60:61], v4 offset:40960
    v_mfma_f32_16x16x32_bf16 v[164:167], v[116:119], v[136:139], v[164:167]
    ds_read_b64_tr_b16 v[62:63], v4 offset:41984
    v_mfma_f32_16x16x32_bf16 v[168:171], v[116:119], v[140:143], v[168:171]
    ds_read_b128 v[76:79], v8 offset:30720
    v_mfma_f32_16x16x32_bf16 v[172:175], v[120:123], v[132:135], v[172:175]
    ds_read_b128 v[80:83], v8 offset:31744
    v_mfma_f32_16x16x32_bf16 v[176:179], v[120:123], v[136:139], v[176:179]
    ds_read_b128 v[84:87], v8 offset:32768
    v_mfma_f32_16x16x32_bf16 v[180:183], v[120:123], v[140:143], v[180:183]
    ds_read_b64_tr_b16 v[64:65], v5 offset:40960
    v_mfma_f32_16x16x32_bf16 v[184:187], v[124:127], v[132:135], v[184:187]
    ds_read_b64_tr_b16 v[66:67], v5 offset:41984
    v_mfma_f32_16x16x32_bf16 v[188:191], v[124:127], v[136:139], v[188:191]
    ds_read_b64_tr_b16 v[68:69], v6 offset:40960
    v_mfma_f32_16x16x32_bf16 v[192:195], v[124:127], v[140:143], v[192:195]
    ds_read_b64_tr_b16 v[70:71], v6 offset:41984
    v_mfma_f32_16x16x32_bf16 v[196:199], v[128:131], v[132:135], v[196:199]
    ds_read_b64_tr_b16 v[72:73], v7 offset:40960
    v_mfma_f32_16x16x32_bf16 v[200:203], v[128:131], v[136:139], v[200:203]
    ds_read_b64_tr_b16 v[74:75], v7 offset:41984
    v_mfma_f32_16x16x32_bf16 v[204:207], v[128:131], v[140:143], v[204:207]
    s_waitcnt lgkmcnt(15)
    v_mfma_f32_16x16x32_bf16 v[160:163], v[32:35], v[48:51], v[160:163]
    v_mfma_f32_16x16x32_bf16 v[164:167], v[32:35], v[52:55], v[164:167]
    v_mfma_f32_16x16x32_bf16 v[168:171], v[32:35], v[56:59], v[168:171]
    v_mfma_f32_16x16x32_bf16 v[172:175], v[36:39], v[48:51], v[172:175]
    s_waitcnt lgkmcnt(0)
    s_barrier
    v_mfma_f32_16x16x32_bf16 v[176:179], v[36:39], v[52:55], v[176:179]
    ds_read_b64_tr_b16 v[88:89], v4 offset:49152
    ds_read_b64_tr_b16 v[90:91], v4 offset:50176
    v_mfma_f32_16x16x32_bf16 v[180:183], v[36:39], v[56:59], v[180:183]
    ds_read_b128 v[104:107], v9 offset:0
    ds_read_b128 v[108:111], v9 offset:1024
    v_mfma_f32_16x16x32_bf16 v[184:187], v[40:43], v[48:51], v[184:187]
    ds_read_b128 v[112:115], v9 offset:2048
    ds_read_b64_tr_b16 v[92:93], v5 offset:49152
    v_mfma_f32_16x16x32_bf16 v[188:191], v[40:43], v[52:55], v[188:191]
    ds_read_b64_tr_b16 v[94:95], v5 offset:50176
    v_mfma_f32_16x16x32_bf16 v[192:195], v[40:43], v[56:59], v[192:195]
    ds_read_b64_tr_b16 v[96:97], v6 offset:49152
    v_mfma_f32_16x16x32_bf16 v[196:199], v[44:47], v[48:51], v[196:199]
    ds_read_b64_tr_b16 v[98:99], v6 offset:50176
    v_mfma_f32_16x16x32_bf16 v[200:203], v[44:47], v[52:55], v[200:203]
    ds_read_b64_tr_b16 v[100:101], v7 offset:49152
    v_mfma_f32_16x16x32_bf16 v[204:207], v[44:47], v[56:59], v[204:207]
    ds_read_b64_tr_b16 v[102:103], v7 offset:50176
    v_mfma_f32_16x16x32_bf16 v[160:163], v[60:63], v[76:79], v[160:163]
    ds_read_b64_tr_b16 v[116:117], v4 offset:57344
    v_mfma_f32_16x16x32_bf16 v[164:167], v[60:63], v[80:83], v[164:167]
    ds_read_b64_tr_b16 v[118:119], v4 offset:58368
    v_mfma_f32_16x16x32_bf16 v[168:171], v[60:63], v[84:87], v[168:171]
    ds_read_b128 v[132:135], v9 offset:6144
    v_mfma_f32_16x16x32_bf16 v[172:175], v[64:67], v[76:79], v[172:175]
    ds_read_b128 v[136:139], v9 offset:7168
    v_mfma_f32_16x16x32_bf16 v[176:179], v[64:67], v[80:83], v[176:179]
    ds_read_b128 v[140:143], v9 offset:8192
    v_mfma_f32_16x16x32_bf16 v[180:183], v[64:67], v[84:87], v[180:183]
    ds_read_b64_tr_b16 v[120:121], v5 offset:57344
    v_mfma_f32_16x16x32_bf16 v[184:187], v[68:71], v[76:79], v[184:187]
    ds_read_b64_tr_b16 v[122:123], v5 offset:58368
    v_mfma_f32_16x16x32_bf16 v[188:191], v[68:71], v[80:83], v[188:191]
    ds_read_b64_tr_b16 v[124:125], v6 offset:57344
    v_mfma_f32_16x16x32_bf16 v[192:195], v[68:71], v[84:87], v[192:195]
    ds_read_b64_tr_b16 v[126:127], v6 offset:58368
    v_mfma_f32_16x16x32_bf16 v[196:199], v[72:75], v[76:79], v[196:199]
    ds_read_b64_tr_b16 v[128:129], v7 offset:57344
    v_mfma_f32_16x16x32_bf16 v[200:203], v[72:75], v[80:83], v[200:203]
    ds_read_b64_tr_b16 v[130:131], v7 offset:58368
    v_mfma_f32_16x16x32_bf16 v[204:207], v[72:75], v[84:87], v[204:207]
    s_waitcnt lgkmcnt(15)
    v_mfma_f32_16x16x32_bf16 v[160:163], v[88:91], v[104:107], v[160:163]
    v_mfma_f32_16x16x32_bf16 v[164:167], v[88:91], v[108:111], v[164:167]
    v_mfma_f32_16x16x32_bf16 v[168:171], v[88:91], v[112:115], v[168:171]
    v_mfma_f32_16x16x32_bf16 v[172:175], v[92:95], v[104:107], v[172:175]
    s_waitcnt lgkmcnt(0)
    v_mfma_f32_16x16x32_bf16 v[176:179], v[92:95], v[108:111], v[176:179]
    v_mfma_f32_16x16x32_bf16 v[180:183], v[92:95], v[112:115], v[180:183]
    v_mfma_f32_16x16x32_bf16 v[184:187], v[96:99], v[104:107], v[184:187]
    v_mfma_f32_16x16x32_bf16 v[188:191], v[96:99], v[108:111], v[188:191]
    v_mfma_f32_16x16x32_bf16 v[192:195], v[96:99], v[112:115], v[192:195]
    v_mfma_f32_16x16x32_bf16 v[196:199], v[100:103], v[104:107], v[196:199]
    v_mfma_f32_16x16x32_bf16 v[200:203], v[100:103], v[108:111], v[200:203]
    v_mfma_f32_16x16x32_bf16 v[204:207], v[100:103], v[112:115], v[204:207]
    v_mfma_f32_16x16x32_bf16 v[160:163], v[116:119], v[132:135], v[160:163]
    v_mfma_f32_16x16x32_bf16 v[164:167], v[116:119], v[136:139], v[164:167]
    v_mfma_f32_16x16x32_bf16 v[168:171], v[116:119], v[140:143], v[168:171]
    v_mfma_f32_16x16x32_bf16 v[172:175], v[120:123], v[132:135], v[172:175]
    v_mfma_f32_16x16x32_bf16 v[176:179], v[120:123], v[136:139], v[176:179]
    v_mfma_f32_16x16x32_bf16 v[180:183], v[120:123], v[140:143], v[180:183]
    s_nop 2
    v_pk_add_f32 v[32:33], v[160:161], v[144:145]
    v_pk_add_f32 v[36:37], v[162:163], v[146:147]
    s_nop 0
    v_pk_add_f32 v[40:41], v[172:173], v[148:149]
    v_pk_add_f32 v[44:45], v[174:175], v[150:151]
    v_pk_mul_f32 v[34:35], v[32:33], v[32:33]
    v_mfma_f32_16x16x32_bf16 v[184:187], v[124:127], v[132:135], v[184:187]
    v_pk_mul_f32 v[38:39], v[36:37], v[36:37]
    v_pk_mul_f32 v[42:43], v[40:41], v[40:41]
    v_pk_mul_f32 v[46:47], v[44:45], v[44:45]
    v_pk_fma_f32 v[34:35], v[34:35], s[34:35], v[30:31]
    v_pk_fma_f32 v[38:39], v[38:39], s[34:35], v[30:31]
    v_mfma_f32_16x16x32_bf16 v[188:191], v[124:127], v[136:139], v[188:191]
    v_pk_fma_f32 v[42:43], v[42:43], s[34:35], v[30:31]
    v_pk_fma_f32 v[46:47], v[46:47], s[34:35], v[30:31]
    v_pk_mul_f32 v[34:35], v[34:35], v[32:33]
    v_pk_mul_f32 v[38:39], v[38:39], v[36:37]
    v_pk_mul_f32 v[42:43], v[42:43], v[40:41]
    v_mfma_f32_16x16x32_bf16 v[192:195], v[124:127], v[140:143], v[192:195]
    v_pk_mul_f32 v[46:47], v[46:47], v[44:45]
    v_exp_f32 v34, v34
    v_exp_f32 v35, v35
    v_exp_f32 v38, v38
    v_exp_f32 v39, v39
    v_mfma_f32_16x16x32_bf16 v[196:199], v[128:131], v[132:135], v[196:199]
    v_exp_f32 v42, v42
    v_exp_f32 v43, v43
    v_exp_f32 v46, v46
    v_exp_f32 v47, v47
    v_pk_add_f32 v[34:35], v[34:35], s[36:37]
    v_mfma_f32_16x16x32_bf16 v[200:203], v[128:131], v[136:139], v[200:203]
    v_pk_add_f32 v[38:39], v[38:39], s[36:37]
    v_pk_add_f32 v[42:43], v[42:43], s[36:37]
    v_pk_add_f32 v[46:47], v[46:47], s[36:37]
    v_rcp_f32 v34, v34
    v_rcp_f32 v35, v35
    v_mfma_f32_16x16x32_bf16 v[204:207], v[128:131], v[140:143], v[204:207]
    v_rcp_f32 v38, v38
    v_rcp_f32 v39, v39
    v_rcp_f32 v42, v42
    v_rcp_f32 v43, v43
    v_rcp_f32 v46, v46
    v_rcp_f32 v47, v47
    v_pk_mul_f32 v[32:33], v[32:33], v[34:35]
    v_pk_mul_f32 v[36:37], v[36:37], v[38:39]
    v_pk_mul_f32 v[40:41], v[40:41], v[42:43]
    v_pk_mul_f32 v[44:45], v[44:45], v[46:47]
    v_cvt_pk_bf16_f32 v112, v32, v33
    v_cvt_pk_bf16_f32 v113, v36, v37
    v_cvt_pk_bf16_f32 v114, v40, v41
    v_cvt_pk_bf16_f32 v115, v44, v45
    buffer_store_dwordx4 v[112:115], v28, s[12:15], s38 offen offset:0 sc1
    v_pk_add_f32 v[32:33], v[164:165], v[144:145]
    v_pk_add_f32 v[36:37], v[166:167], v[146:147]
    v_pk_add_f32 v[40:41], v[176:177], v[148:149]
    v_pk_add_f32 v[44:45], v[178:179], v[150:151]
    v_pk_mul_f32 v[34:35], v[32:33], v[32:33]
    v_pk_mul_f32 v[38:39], v[36:37], v[36:37]
    v_pk_mul_f32 v[42:43], v[40:41], v[40:41]
    v_pk_mul_f32 v[46:47], v[44:45], v[44:45]
    v_pk_fma_f32 v[34:35], v[34:35], s[34:35], v[30:31]
    v_pk_fma_f32 v[38:39], v[38:39], s[34:35], v[30:31]
    v_pk_fma_f32 v[42:43], v[42:43], s[34:35], v[30:31]
    v_pk_fma_f32 v[46:47], v[46:47], s[34:35], v[30:31]
    v_pk_mul_f32 v[34:35], v[34:35], v[32:33]
    v_pk_mul_f32 v[38:39], v[38:39], v[36:37]
    v_pk_mul_f32 v[42:43], v[42:43], v[40:41]
    v_pk_mul_f32 v[46:47], v[46:47], v[44:45]
    v_exp_f32 v34, v34
    v_exp_f32 v35, v35
    v_exp_f32 v38, v38
    v_exp_f32 v39, v39
    v_exp_f32 v42, v42
    v_exp_f32 v43, v43
    v_exp_f32 v46, v46
    v_exp_f32 v47, v47
    v_pk_add_f32 v[34:35], v[34:35], s[36:37]
    v_pk_add_f32 v[38:39], v[38:39], s[36:37]
    v_pk_add_f32 v[42:43], v[42:43], s[36:37]
    v_pk_add_f32 v[46:47], v[46:47], s[36:37]
    v_rcp_f32 v34, v34
    v_rcp_f32 v35, v35
    v_rcp_f32 v38, v38
    v_rcp_f32 v39, v39
    v_rcp_f32 v42, v42
    v_rcp_f32 v43, v43
    v_rcp_f32 v46, v46
    v_rcp_f32 v47, v47
    v_pk_mul_f32 v[32:33], v[32:33], v[34:35]
    v_pk_mul_f32 v[36:37], v[36:37], v[38:39]
    v_pk_mul_f32 v[40:41], v[40:41], v[42:43]
    v_pk_mul_f32 v[44:45], v[44:45], v[46:47]
    v_cvt_pk_bf16_f32 v116, v32, v33
    v_cvt_pk_bf16_f32 v117, v36, v37
    v_cvt_pk_bf16_f32 v118, v40, v41
    v_cvt_pk_bf16_f32 v119, v44, v45
    buffer_store_dwordx4 v[116:119], v28, s[12:15], s38 offen offset:128 sc1
    v_pk_add_f32 v[32:33], v[168:169], v[144:145]
    v_pk_add_f32 v[36:37], v[170:171], v[146:147]
    v_pk_add_f32 v[40:41], v[180:181], v[148:149]
    v_pk_add_f32 v[44:45], v[182:183], v[150:151]
    v_pk_mul_f32 v[34:35], v[32:33], v[32:33]
    v_pk_mul_f32 v[38:39], v[36:37], v[36:37]
    v_pk_mul_f32 v[42:43], v[40:41], v[40:41]
    v_pk_mul_f32 v[46:47], v[44:45], v[44:45]
    v_pk_fma_f32 v[34:35], v[34:35], s[34:35], v[30:31]
    v_pk_fma_f32 v[38:39], v[38:39], s[34:35], v[30:31]
    v_pk_fma_f32 v[42:43], v[42:43], s[34:35], v[30:31]
    v_pk_fma_f32 v[46:47], v[46:47], s[34:35], v[30:31]
    v_pk_mul_f32 v[34:35], v[34:35], v[32:33]
    v_pk_mul_f32 v[38:39], v[38:39], v[36:37]
    v_pk_mul_f32 v[42:43], v[42:43], v[40:41]
    v_pk_mul_f32 v[46:47], v[46:47], v[44:45]
    v_exp_f32 v34, v34
    v_exp_f32 v35, v35
    v_exp_f32 v38, v38
    v_exp_f32 v39, v39
    v_exp_f32 v42, v42
    v_exp_f32 v43, v43
    v_exp_f32 v46, v46
    v_exp_f32 v47, v47
    v_pk_add_f32 v[34:35], v[34:35], s[36:37]
    v_pk_add_f32 v[38:39], v[38:39], s[36:37]
    v_pk_add_f32 v[42:43], v[42:43], s[36:37]
    v_pk_add_f32 v[46:47], v[46:47], s[36:37]
    v_rcp_f32 v34, v34
    v_rcp_f32 v35, v35
    v_rcp_f32 v38, v38
    v_rcp_f32 v39, v39
    v_rcp_f32 v42, v42
    v_rcp_f32 v43, v43
    v_rcp_f32 v46, v46
    v_rcp_f32 v47, v47
    v_pk_mul_f32 v[32:33], v[32:33], v[34:35]
    v_pk_mul_f32 v[36:37], v[36:37], v[38:39]
    v_pk_mul_f32 v[40:41], v[40:41], v[42:43]
    v_pk_mul_f32 v[44:45], v[44:45], v[46:47]
    v_cvt_pk_bf16_f32 v112, v32, v33
    v_cvt_pk_bf16_f32 v113, v36, v37
    v_cvt_pk_bf16_f32 v114, v40, v41
    v_cvt_pk_bf16_f32 v115, v44, v45
    buffer_store_dwordx4 v[112:115], v28, s[12:15], s38 offen offset:256 sc1
    v_pk_add_f32 v[32:33], v[184:185], v[152:153]
    v_pk_add_f32 v[36:37], v[186:187], v[154:155]
    v_pk_add_f32 v[40:41], v[196:197], v[156:157]
    v_pk_add_f32 v[44:45], v[198:199], v[158:159]
    v_pk_mul_f32 v[34:35], v[32:33], v[32:33]
    v_pk_mul_f32 v[38:39], v[36:37], v[36:37]
    v_pk_mul_f32 v[42:43], v[40:41], v[40:41]
    v_pk_mul_f32 v[46:47], v[44:45], v[44:45]
    v_pk_fma_f32 v[34:35], v[34:35], s[34:35], v[30:31]
    v_pk_fma_f32 v[38:39], v[38:39], s[34:35], v[30:31]
    v_pk_fma_f32 v[42:43], v[42:43], s[34:35], v[30:31]
    v_pk_fma_f32 v[46:47], v[46:47], s[34:35], v[30:31]
    v_pk_mul_f32 v[34:35], v[34:35], v[32:33]
    v_pk_mul_f32 v[38:39], v[38:39], v[36:37]
    v_pk_mul_f32 v[42:43], v[42:43], v[40:41]
    v_pk_mul_f32 v[46:47], v[46:47], v[44:45]
    v_exp_f32 v34, v34
    v_exp_f32 v35, v35
    v_exp_f32 v38, v38
    v_exp_f32 v39, v39
    v_exp_f32 v42, v42
    v_exp_f32 v43, v43
    v_exp_f32 v46, v46
    v_exp_f32 v47, v47
    v_pk_add_f32 v[34:35], v[34:35], s[36:37]
    v_pk_add_f32 v[38:39], v[38:39], s[36:37]
    v_pk_add_f32 v[42:43], v[42:43], s[36:37]
    v_pk_add_f32 v[46:47], v[46:47], s[36:37]
    v_rcp_f32 v34, v34
    v_rcp_f32 v35, v35
    v_rcp_f32 v38, v38
    v_rcp_f32 v39, v39
    v_rcp_f32 v42, v42
    v_rcp_f32 v43, v43
    v_rcp_f32 v46, v46
    v_rcp_f32 v47, v47
    v_pk_mul_f32 v[32:33], v[32:33], v[34:35]
    v_pk_mul_f32 v[36:37], v[36:37], v[38:39]
    v_pk_mul_f32 v[40:41], v[40:41], v[42:43]
    v_pk_mul_f32 v[44:45], v[44:45], v[46:47]
    v_cvt_pk_bf16_f32 v116, v32, v33
    v_cvt_pk_bf16_f32 v117, v36, v37
    v_cvt_pk_bf16_f32 v118, v40, v41
    v_cvt_pk_bf16_f32 v119, v44, v45
    buffer_store_dwordx4 v[116:119], v28, s[12:15], s39 offen offset:0 sc1
    v_pk_add_f32 v[32:33], v[188:189], v[152:153]
    v_pk_add_f32 v[36:37], v[190:191], v[154:155]
    v_pk_add_f32 v[40:41], v[200:201], v[156:157]
    v_pk_add_f32 v[44:45], v[202:203], v[158:159]
    v_pk_mul_f32 v[34:35], v[32:33], v[32:33]
    v_pk_mul_f32 v[38:39], v[36:37], v[36:37]
    v_pk_mul_f32 v[42:43], v[40:41], v[40:41]
    v_pk_mul_f32 v[46:47], v[44:45], v[44:45]
    v_pk_fma_f32 v[34:35], v[34:35], s[34:35], v[30:31]
    v_pk_fma_f32 v[38:39], v[38:39], s[34:35], v[30:31]
    v_pk_fma_f32 v[42:43], v[42:43], s[34:35], v[30:31]
    v_pk_fma_f32 v[46:47], v[46:47], s[34:35], v[30:31]
    v_pk_mul_f32 v[34:35], v[34:35], v[32:33]
    v_pk_mul_f32 v[38:39], v[38:39], v[36:37]
    v_pk_mul_f32 v[42:43], v[42:43], v[40:41]
    v_pk_mul_f32 v[46:47], v[46:47], v[44:45]
    v_exp_f32 v34, v34
    v_exp_f32 v35, v35
    v_exp_f32 v38, v38
    v_exp_f32 v39, v39
    v_exp_f32 v42, v42
    v_exp_f32 v43, v43
    v_exp_f32 v46, v46
    v_exp_f32 v47, v47
    v_pk_add_f32 v[34:35], v[34:35], s[36:37]
    v_pk_add_f32 v[38:39], v[38:39], s[36:37]
    v_pk_add_f32 v[42:43], v[42:43], s[36:37]
    v_pk_add_f32 v[46:47], v[46:47], s[36:37]
    v_rcp_f32 v34, v34
    v_rcp_f32 v35, v35
    v_rcp_f32 v38, v38
    v_rcp_f32 v39, v39
    v_rcp_f32 v42, v42
    v_rcp_f32 v43, v43
    v_rcp_f32 v46, v46
    v_rcp_f32 v47, v47
    v_pk_mul_f32 v[32:33], v[32:33], v[34:35]
    v_pk_mul_f32 v[36:37], v[36:37], v[38:39]
    v_pk_mul_f32 v[40:41], v[40:41], v[42:43]
    v_pk_mul_f32 v[44:45], v[44:45], v[46:47]
    v_cvt_pk_bf16_f32 v112, v32, v33
    v_cvt_pk_bf16_f32 v113, v36, v37
    v_cvt_pk_bf16_f32 v114, v40, v41
    v_cvt_pk_bf16_f32 v115, v44, v45
    buffer_store_dwordx4 v[112:115], v28, s[12:15], s39 offen offset:128 sc1
    v_pk_add_f32 v[32:33], v[192:193], v[152:153]
    v_pk_add_f32 v[36:37], v[194:195], v[154:155]
    v_pk_add_f32 v[40:41], v[204:205], v[156:157]
    v_pk_add_f32 v[44:45], v[206:207], v[158:159]
    v_pk_mul_f32 v[34:35], v[32:33], v[32:33]
    v_pk_mul_f32 v[38:39], v[36:37], v[36:37]
    v_pk_mul_f32 v[42:43], v[40:41], v[40:41]
    v_pk_mul_f32 v[46:47], v[44:45], v[44:45]
    v_pk_fma_f32 v[34:35], v[34:35], s[34:35], v[30:31]
    v_pk_fma_f32 v[38:39], v[38:39], s[34:35], v[30:31]
    v_pk_fma_f32 v[42:43], v[42:43], s[34:35], v[30:31]
    v_pk_fma_f32 v[46:47], v[46:47], s[34:35], v[30:31]
    v_pk_mul_f32 v[34:35], v[34:35], v[32:33]
    v_pk_mul_f32 v[38:39], v[38:39], v[36:37]
    v_pk_mul_f32 v[42:43], v[42:43], v[40:41]
    v_pk_mul_f32 v[46:47], v[46:47], v[44:45]
    v_exp_f32 v34, v34
    v_exp_f32 v35, v35
    v_exp_f32 v38, v38
    v_exp_f32 v39, v39
    v_exp_f32 v42, v42
    v_exp_f32 v43, v43
    v_exp_f32 v46, v46
    v_exp_f32 v47, v47
    v_pk_add_f32 v[34:35], v[34:35], s[36:37]
    v_pk_add_f32 v[38:39], v[38:39], s[36:37]
    v_pk_add_f32 v[42:43], v[42:43], s[36:37]
    v_pk_add_f32 v[46:47], v[46:47], s[36:37]
    v_rcp_f32 v34, v34
    v_rcp_f32 v35, v35
    v_rcp_f32 v38, v38
    v_rcp_f32 v39, v39
    v_rcp_f32 v42, v42
    v_rcp_f32 v43, v43
    v_rcp_f32 v46, v46
    v_rcp_f32 v47, v47
    v_pk_mul_f32 v[32:33], v[32:33], v[34:35]
    v_pk_mul_f32 v[36:37], v[36:37], v[38:39]
    v_pk_mul_f32 v[40:41], v[40:41], v[42:43]
    v_pk_mul_f32 v[44:45], v[44:45], v[46:47]
    v_cvt_pk_bf16_f32 v116, v32, v33
    v_cvt_pk_bf16_f32 v117, v36, v37
    v_cvt_pk_bf16_f32 v118, v40, v41
    v_cvt_pk_bf16_f32 v119, v44, v45
    buffer_store_dwordx4 v[116:119], v28, s[12:15], s39 offen offset:256
    s_branch K4_END
K4_PROD:
    s_sub_u32 s28, s27, 4
    s_movk_i32 s30, 9216
    s_mul_i32 s32, s4, 256
    s_and_b32 s31, s4, 3
    s_cmp_lg_u32 s31, 1
    s_cbranch_scc1 K4_NOCP
    s_movk_i32 s30, 4608
    s_lshr_b32 s32, s4, 2
    s_lshl_b32 s32, s32, 9
    s_add_u32 s32, s32, 22085632
    s_mov_b32 s8, s6
    s_and_b32 s9, s7, 0xffff
    s_mov_b32 s10, 0x22a0000
    s_mov_b32 s11, 0x00020000
K4_NOCP:
    s_mov_b32 s56, s30
    s_lshl_b32 s57, s30, 6
    v_and_b32 v4, 15, v1
    v_lshrrev_b32 v5, 1, v4
    v_and_b32 v4, 1, v4
    s_lshl_b32 s29, s28, 4
    v_add_u32 v6, s29, v3
    v_mul_lo_u32 v6, v6, s30
    v_lshl_add_u32 v6, v4, 4, v6
    v_or_b32 v7, 0, v3
    v_xor_b32 v7, v7, v5
    v_lshl_add_u32 v10, v7, 5, v6
    v_or_b32 v7, 0, v3
    v_xor_b32 v7, v7, v5
    v_lshl_add_u32 v11, v7, 5, v6
    s_mul_i32 s31, s56, 4
    s_sub_u32 s31, s31, 1024
    v_add_u32 v11, s31, v11
    v_or_b32 v7, 4, v3
    v_xor_b32 v7, v7, v5
    v_lshl_add_u32 v12, v7, 5, v6
    s_mul_i32 s31, s56, 8
    s_sub_u32 s31, s31, 2048
    v_add_u32 v12, s31, v12
    v_or_b32 v7, 4, v3
    v_xor_b32 v7, v7, v5
    v_lshl_add_u32 v13, v7, 5, v6
    s_mul_i32 s31, s56, 12
    s_sub_u32 s31, s31, 3072
    v_add_u32 v13, s31, v13
    v_lshrrev_b32 v16, 3, v1
    v_lshlrev_b32 v16, 10, v16
    v_and_b32 v17, 7, v1
    v_lshl_add_u32 v16, v17, 4, v16
    s_lshr_b32 s30, s28, 1
    s_lshl_b32 s30, s30, 13
    s_and_b32 s31, s28, 1
    s_lshl_b32 s31, s31, 9
    s_add_u32 s30, s30, s31
    s_add_u32 s31, s30, 2048
    v_add_u32 v17, s31, v16
    s_add_u32 s31, s30, 1152
    v_add_u32 v18, s31, v16
    s_add_u32 s31, s30, 256
    v_add_u32 v19, s31, v16
    s_mul_i32 s33, s5, 16384
    s_add_u32 s33, s33, 11859968
    s_mul_i32 s30, s28, 4096
    s_add_u32 s40, s30, 0
    s_mul_i32 s30, s28, 3072
    s_add_u32 s48, s30, 65536
    s_mul_i32 s30, s28, 4096
    s_add_u32 s41, s30, 16384
    s_mul_i32 s30, s28, 3072
    s_add_u32 s49, s30, 77824
    s_mul_i32 s30, s28, 4096
    s_add_u32 s42, s30, 32768
    s_mul_i32 s30, s28, 3072
    s_add_u32 s50, s30, 90112
    s_mul_i32 s30, s28, 4096
    s_add_u32 s43, s30, 49152
    s_mul_i32 s30, s28, 3072
    s_add_u32 s51, s30, 102400
    s_mov_b32 m0, s40
    s_nop 0
    buffer_load_dwordx4 v10, s[8:11], s32 offen offset:0 lds
    buffer_load_dwordx4 v11, s[8:11], s32 offen offset:1024 lds
    buffer_load_dwordx4 v12, s[8:11], s32 offen offset:2048 lds
    buffer_load_dwordx4 v13, s[8:11], s32 offen offset:3072 lds
    s_mov_b32 m0, s48
    s_nop 0
    buffer_load_dwordx4 v17, s[12:15], s33 offen offset:0 lds
    buffer_load_dwordx4 v18, s[12:15], s33 offen offset:1024 lds
    buffer_load_dwordx4 v19, s[12:15], s33 offen offset:2048 lds
    s_add_u32 s32, s32, s57
    s_add_u32 s33, s33, 98304
    s_mov_b32 m0, s41
    s_nop 0
    buffer_load_dwordx4 v10, s[8:11], s32 offen offset:0 lds
    buffer_load_dwordx4 v11, s[8:11], s32 offen offset:1024 lds
    buffer_load_dwordx4 v12, s[8:11], s32 offen offset:2048 lds
    buffer_load_dwordx4 v13, s[8:11], s32 offen offset:3072 lds
    s_mov_b32 m0, s49
    s_nop 0
    buffer_load_dwordx4 v17, s[12:15], s33 offen offset:0 lds
    buffer_load_dwordx4 v18, s[12:15], s33 offen offset:1024 lds
    buffer_load_dwordx4 v19, s[12:15], s33 offen offset:2048 lds
    s_add_u32 s32, s32, s57
    s_add_u32 s33, s33, 98304
    s_waitcnt vmcnt(7)
    s_barrier
    s_mov_b32 m0, s42
    s_nop 0
    buffer_load_dwordx4 v10, s[8:11], s32 offen offset:0 lds
    buffer_load_dwordx4 v11, s[8:11], s32 offen offset:1024 lds
    buffer_load_dwordx4 v12, s[8:11], s32 offen offset:2048 lds
    buffer_load_dwordx4 v13, s[8:11], s32 offen offset:3072 lds
    s_mov_b32 m0, s50
    s_nop 0
    buffer_load_dwordx4 v17, s[12:15], s33 offen offset:0 lds
    buffer_load_dwordx4 v18, s[12:15], s33 offen offset:1024 lds
    buffer_load_dwordx4 v19, s[12:15], s33 offen offset:2048 lds
    s_add_u32 s32, s32, s57
    s_add_u32 s33, s33, 98304
    s_mov_b32 m0, s43
    s_nop 0
    buffer_load_dwordx4 v10, s[8:11], s32 offen offset:0 lds
    buffer_load_dwordx4 v11, s[8:11], s32 offen offset:1024 lds
    buffer_load_dwordx4 v12, s[8:11], s32 offen offset:2048 lds
    buffer_load_dwordx4 v13, s[8:11], s32 offen offset:3072 lds
    s_mov_b32 m0, s51
    s_nop 0
    buffer_load_dwordx4 v17, s[12:15], s33 offen offset:0 lds
    buffer_load_dwordx4 v18, s[12:15], s33 offen offset:1024 lds
    buffer_load_dwordx4 v19, s[12:15], s33 offen offset:2048 lds
    s_add_u32 s32, s32, s57
    s_add_u32 s33, s33, 98304
    s_movk_i32 s31, 7
K4_PLOOP:
    s_waitcnt vmcnt(14)
    s_barrier
    s_mov_b32 m0, s40
    s_nop 0
    buffer_load_dwordx4 v10, s[8:11], s32 offen offset:0 lds
    buffer_load_dwordx4 v11, s[8:11], s32 offen offset:1024 lds
    buffer_load_dwordx4 v12, s[8:11], s32 offen offset:2048 lds
    buffer_load_dwordx4 v13, s[8:11], s32 offen offset:3072 lds
    s_mov_b32 m0, s48
    s_nop 0
    buffer_load_dwordx4 v17, s[12:15], s33 offen offset:0 lds
    buffer_load_dwordx4 v18, s[12:15], s33 offen offset:1024 lds
    buffer_load_dwordx4 v19, s[12:15], s33 offen offset:2048 lds
    s_add_u32 s32, s32, s57
    s_add_u32 s33, s33, 98304
    s_waitcnt vmcnt(14)
    s_barrier
    s_mov_b32 m0, s41
    s_nop 0
    buffer_load_dwordx4 v10, s[8:11], s32 offen offset:0 lds
    buffer_load_dwordx4 v11, s[8:11], s32 offen offset:1024 lds
    buffer_load_dwordx4 v12, s[8:11], s32 offen offset:2048 lds
    buffer_load_dwordx4 v13, s[8:11], s32 offen offset:3072 lds
    s_mov_b32 m0, s49
    s_nop 0
    buffer_load_dwordx4 v17, s[12:15], s33 offen offset:0 lds
    buffer_load_dwordx4 v18, s[12:15], s33 offen offset:1024 lds
    buffer_load_dwordx4 v19, s[12:15], s33 offen offset:2048 lds
    s_add_u32 s32, s32, s57
    s_add_u32 s33, s33, 98304
    s_waitcnt vmcnt(14)
    s_barrier
    s_mov_b32 m0, s42
    s_nop 0
    buffer_load_dwordx4 v10, s[8:11], s32 offen offset:0 lds
    buffer_load_dwordx4 v11, s[8:11], s32 offen offset:1024 lds
    buffer_load_dwordx4 v12, s[8:11], s32 offen offset:2048 lds
    buffer_load_dwordx4 v13, s[8:11], s32 offen offset:3072 lds
    s_mov_b32 m0, s50
    s_nop 0
    buffer_load_dwordx4 v17, s[12:15], s33 offen offset:0 lds
    buffer_load_dwordx4 v18, s[12:15], s33 offen offset:1024 lds
    buffer_load_dwordx4 v19, s[12:15], s33 offen offset:2048 lds
    s_add_u32 s32, s32, s57
    s_add_u32 s33, s33, 98304
    s_waitcnt vmcnt(14)
    s_barrier
    s_mov_b32 m0, s43
    s_nop 0
    buffer_load_dwordx4 v10, s[8:11], s32 offen offset:0 lds
    buffer_load_dwordx4 v11, s[8:11], s32 offen offset:1024 lds
    buffer_load_dwordx4 v12, s[8:11], s32 offen offset:2048 lds
    buffer_load_dwordx4 v13, s[8:11], s32 offen offset:3072 lds
    s_mov_b32 m0, s51
    s_nop 0
    buffer_load_dwordx4 v17, s[12:15], s33 offen offset:0 lds
    buffer_load_dwordx4 v18, s[12:15], s33 offen offset:1024 lds
    buffer_load_dwordx4 v19, s[12:15], s33 offen offset:2048 lds
    s_add_u32 s32, s32, s57
    s_add_u32 s33, s33, 98304
    s_sub_u32 s31, s31, 1
    s_cmp_lg_u32 s31, 0
    s_cbranch_scc1 K4_PLOOP
    s_waitcnt vmcnt(14)
    s_barrier
    s_waitcnt vmcnt(7)
    s_barrier
    s_waitcnt vmcnt(0)
    s_barrier
    s_branch K4_END
K4_PREF:
    s_cmp_ge_u32 s2, 256
    s_cbranch_scc1 K4_END
    s_load_dwordx2 s[16:17], s[0:1], 64
    s_load_dwordx2 s[18:19], s[0:1], 80
    v_and_b32 v1, 63, v0
    v_lshrrev_b32 v2, 6, v0
    s_nop 0
    v_readfirstlane_b32 s27, v2
    s_sub_u32 s3, s2, 216
    s_lshr_b32 s3, s3, 3
    s_mul_i32 s3, s3, 8
    s_add_u32 s3, s3, s27
    s_and_b32 s4, s2, 7
    s_waitcnt lgkmcnt(0)
    v_lshlrev_b32 v70, 16, v1
    s_sub_u32 s50, s3, 0
    s_cmp_ge_u32 s50, 1
    s_cbranch_scc1 PF_TL_1
    s_load_dwordx2 s[48:49], s[0:1], 96
    s_mov_b32 s51, 0
    s_mov_b32 s52, 2359292
    v_min_u32 v71, s52, v70
    s_waitcnt lgkmcnt(0)
    s_mov_b32 s44, s48
    s_and_b32 s45, s49, 0xffff
    s_mov_b32 s46, 0x240000
    s_mov_b32 s47, 0x00020000
    buffer_load_dword v72, v71, s[44:47], s51 offen
PF_TL_1:
    s_sub_u32 s50, s3, 1
    s_cmp_ge_u32 s50, 6
    s_cbranch_scc1 PF_TL_2
    s_load_dwordx2 s[48:49], s[0:1], 112
    s_mov_b32 s51, 76546048
    s_mov_b32 s52, 131068
    s_cmp_eq_u32 s50, 1
    s_cselect_b32 s51, 77594624, s51
    s_cselect_b32 s52, 4194300, s52
    s_cmp_eq_u32 s50, 2
    s_cselect_b32 s51, 81788928, s51
    s_cselect_b32 s52, 4194300, s52
    s_cmp_eq_u32 s50, 3
    s_cselect_b32 s51, 85983232, s51
    s_cselect_b32 s52, 4194300, s52
    s_cmp_eq_u32 s50, 4
    s_cselect_b32 s51, 90177536, s51
    s_cselect_b32 s52, 4194300, s52
    s_cmp_eq_u32 s50, 5
    s_cselect_b32 s51, 94371840, s51
    s_cselect_b32 s52, 2097148, s52
    v_min_u32 v71, s52, v70
    s_waitcnt lgkmcnt(0)
    s_mov_b32 s44, s48
    s_and_b32 s45, s49, 0xffff
    s_mov_b32 s46, 0x6e00000
    s_mov_b32 s47, 0x00020000
    buffer_load_dword v72, v71, s[44:47], s51 offen
PF_TL_2:
    s_sub_u32 s50, s3, 7
    s_cmp_ge_u32 s50, 5
    s_cbranch_scc1 PF_TL_3
    s_load_dwordx2 s[48:49], s[0:1], 80
    s_mov_b32 s51, 0
    s_mov_b32 s52, 4194300
    s_cmp_eq_u32 s50, 1
    s_cselect_b32 s51, 4194304, s51
    s_cselect_b32 s52, 4194300, s52
    s_cmp_eq_u32 s50, 2
    s_cselect_b32 s51, 8388608, s51
    s_cselect_b32 s52, 4194300, s52
    s_cmp_eq_u32 s50, 3
    s_cselect_b32 s51, 12582912, s51
    s_cselect_b32 s52, 4194300, s52
    s_cmp_eq_u32 s50, 4
    s_cselect_b32 s51, 16777216, s51
    s_cselect_b32 s52, 2097148, s52
    v_min_u32 v71, s52, v70
    s_waitcnt lgkmcnt(0)
    s_mov_b32 s44, s48
    s_and_b32 s45, s49, 0xffff
    s_mov_b32 s46, 0x1200000
    s_mov_b32 s47, 0x00020000
    buffer_load_dword v72, v71, s[44:47], s51 offen
PF_TL_3:
    s_load_dwordx2 s[6:7], s[0:1], 112
    s_sub_u32 s21, s2, 216
    s_mul_i32 s21, s21, 8
    s_add_u32 s21, s21, s27
    s_waitcnt lgkmcnt(0)
    s_cmp_ge_u32 s21, 16
    s_cbranch_scc1 PF_ZF_4
    s_mov_b32 s28, s6
    s_and_b32 s29, s7, 0xffff
    s_mov_b32 s30, 0x6e00000
    s_mov_b32 s31, 0x00020000
    v_lshlrev_b32 v4, 7, v1
    v_mov_b32 v5, 0
    s_lshl_b32 s21, s21, 13
    s_add_u32 s21, s21, 76546048
    buffer_store_dword v5, v4, s[28:31], s21 offen
PF_ZF_4:
    s_mov_b32 s8, s16
    s_and_b32 s9, s17, 0xffff
    s_mov_b32 s10, 0x1200000
    s_mov_b32 s11, 0x00020000
    s_lshr_b32 s34, s4, 1
    s_lshl_b32 s34, s34, 4
    s_mov_b32 s35, 0x33214320
    s_cmp_ge_u32 s34, 32
    s_cselect_b32 s35, 0x43104210, s35
    s_and_b32 s34, s34, 16
    s_lshr_b32 s35, s35, s34
    v_bfe_u32 v5, v1, 1, 2
    v_lshlrev_b32 v5, 2, v5
    v_lshrrev_b32 v5, v5, s35
    v_and_b32 v5, 15, v5
    s_mul_i32 s34, s4, 4617
    s_lshr_b32 s34, s34, 10
    v_add_u32 v5, s34, v5
    v_lshrrev_b32 v4, 3, v1
    v_mul_u32_u24 v4, 9216, v4
    v_lshl_add_u32 v4, v5, 8, v4
    v_and_b32 v5, 1, v1
    v_lshl_add_u32 v4, v5, 7, v4
    s_mul_i32 s20, s3, 73728
    s_add_u32 s20, s20, 8257536
    s_cmp_ge_u32 s20, 18874368
    s_cbranch_scc1 PF_SK4_5
    buffer_load_dword v60, v4, s[8:11], s20 offen
PF_SK4_5:
    s_add_u32 s20, s20, 2949120
    s_cmp_ge_u32 s20, 18874368
    s_cbranch_scc1 PF_SK4_6
    buffer_load_dword v61, v4, s[8:11], s20 offen
PF_SK4_6:
    s_add_u32 s20, s20, 2949120
    s_cmp_ge_u32 s20, 18874368
    s_cbranch_scc1 PF_SK4_7
    buffer_load_dword v62, v4, s[8:11], s20 offen
PF_SK4_7:
    s_add_u32 s20, s20, 2949120
    s_cmp_ge_u32 s20, 18874368
    s_cbranch_scc1 PF_SK4_8
    buffer_load_dword v63, v4, s[8:11], s20 offen
PF_SK4_8:
    s_mov_b32 s8, s18
    s_and_b32 s9, s19, 0xffff
    s_mov_b32 s10, 0x1200000
    s_mov_b32 s11, 0x00020000
    v_lshrrev_b32 v4, 3, v1
    v_and_b32 v5, 7, v1
    s_and_b32 s34, s4, 3
    s_lshr_b32 s35, s4, 2
    v_and_b32 v3, 6, v5
    v_or_b32 v3, s35, v3
    s_lshl_b32 s36, s34, 10
    v_lshlrev_b32 v5, 7, v5
    v_add_u32 v5, s36, v5
    v_lshlrev_b32 v3, 7, v3
    v_add_u32 v3, s36, v3
    s_mul_i32 s34, s34, 9
    s_sub_u32 s36, s34, 4
    s_max_i32 s36, s36, 0
    s_cmp_eq_u32 s35, 0
    s_cselect_b32 s34, s34, s36
    s_cselect_b32 s37, 0, 2560
    s_lshl_b32 s34, s34, 6
    s_mul_i32 s20, s3, 8
    s_add_u32 s20, s20, 0
    s_cmp_ge_u32 s20, 400
    s_cbranch_scc1 PF_SK4_9
    v_add_u32 v6, s20, v4
    v_min_u32 v6, 399, v6
    v_add_u32 v7, s34, v6
    v_subrev_u32 v8, 2048, v7
    v_min_u32 v7, v7, v8
    v_add_u32 v7, s37, v7
    v_cmp_le_u32 vcc, 2048, v6
    s_nop 1
    v_cndmask_b32 v7, v7, v6, vcc
    v_cndmask_b32 v9, v5, v3, vcc
    v_lshl_add_u32 v7, v7, 12, v9
    buffer_load_dword v60, v7, s[8:11], 0 offen
PF_SK4_9:
    s_add_u32 s20, s20, 320
    s_cmp_ge_u32 s20, 400
    s_cbranch_scc1 PF_SK4_10
    v_add_u32 v6, s20, v4
    v_min_u32 v6, 399, v6
    v_add_u32 v7, s34, v6
    v_subrev_u32 v8, 2048, v7
    v_min_u32 v7, v7, v8
    v_add_u32 v7, s37, v7
    v_cmp_le_u32 vcc, 2048, v6
    s_nop 1
    v_cndmask_b32 v7, v7, v6, vcc
    v_cndmask_b32 v9, v5, v3, vcc
    v_lshl_add_u32 v7, v7, 12, v9
    buffer_load_dword v61, v7, s[8:11], 0 offen
PF_SK4_10:
    s_cmp_lg_u32 s27, 0
    s_cbranch_scc1 PF_CP_11
    s_getpc_b64 s[40:41]
CPF_C:
    s_add_u32 s40, s40, k5_kernel-CPF_C
    s_addc_u32 s41, s41, 0
    v_lshlrev_b32 v90, 7, v1
    v_min_u32 v91, K5_END-k5_kernel-4, v90
    global_load_dword v92, v91, s[40:41]
    v_add_u32 v91, 8192, v90
    v_min_u32 v91, K5_END-k5_kernel-4, v91
    global_load_dword v93, v91, s[40:41]
    v_add_u32 v91, 16384, v90
    v_min_u32 v91, K5_END-k5_kernel-4, v91
    global_load_dword v94, v91, s[40:41]
PF_CP_11:
    s_branch K4_END
K4_END:
    s_endpgm
.globl k5_kernel
.p2align 8
.type k5_kernel,@function
k5_kernel:
    s_cmp_ge_u32 s2, 256
    s_cbranch_scc1 K5_END
    s_cmp_ge_u32 s2, 192
    s_cbranch_scc1 K5_PREF
    s_load_dwordx2 s[6:7], s[0:1], 112
    s_load_dwordx4 s[16:19], s[0:1], 80
    s_load_dwordx2 s[20:21], s[0:1], 96
    v_lshrrev_b32 v2, 6, v0
    s_nop 0
    v_readfirstlane_b32 s27, v2
    v_and_b32 v1, 63, v0
    v_lshrrev_b32 v3, 4, v1
    s_and_b32 s22, s2, 7
    s_lshr_b32 s23, s2, 3
    s_lshr_b32 s24, s22, 2
    s_and_b32 s25, s22, 3
    s_mul_i32 s4, s23, 43
    s_lshr_b32 s4, s4, 8
    s_mul_i32 s5, s4, 6
    s_sub_u32 s5, s23, s5
    s_lshl_b32 s26, s25, 2
    s_add_u32 s4, s4, s26
    s_cmp_lt_u32 s27, 4
    s_cbranch_scc1 K5_CONS
K5_PROD:
    s_sub_u32 s28, s27, 4
    v_and_b32 v4, 15, v1
    s_lshl_b32 s29, s28, 4
    v_lshrrev_b32 v5, 1, v4
    v_add_u32 v6, s29, v3
    v_and_b32 v4, 1, v4
    v_lshlrev_b32 v6, 12, v6
    v_xor_b32 v7, v3, v5
    v_lshl_add_u32 v6, v4, 4, v6
    s_mul_i32 s59, s25, 9
    v_lshl_add_u32 v10, v7, 5, v6
    s_sub_u32 s60, s59, 4
    v_xor_b32 v7, 4, v7
    s_max_i32 s60, s60, 0
    v_lshl_add_u32 v11, v7, 5, v6
    s_cmp_eq_u32 s24, 0
    s_cselect_b32 s59, s59, s60
    s_cselect_b32 s58, 0, 40
    s_add_u32 s58, s58, s59
    s_lshl_b32 s32, s4, 8
    v_lshrrev_b32 v16, 3, v1
    s_lshl_b32 s60, s58, 18
    v_add_u32 v11, 15360, v11
    s_add_u32 s61, s32, s60
    v_lshlrev_b32 v16, 10, v16
    s_mul_i32 s33, s58, 98304
    v_and_b32 v17, 7, v1
    s_add_u32 s33, s33, 15003648
    v_lshl_add_u32 v16, v17, 4, v16
    s_and_b32 s35, s28, 1
    v_add_u32 v12, 30720, v10
    s_lshl_b32 s35, s35, 9
    v_add_u32 v13, 30720, v11
    s_lshr_b32 s36, s28, 1
    s_lshl_b32 s37, s5, 1
    s_add_u32 s37, s37, s36
    s_lshl_b32 s37, s37, 13
    s_add_u32 s35, s35, s37
    s_add_u32 s35, s35, 4096
    v_add_u32 v17, s35, v16
    s_sub_u32 s58, 32, s59
    v_subrev_u32 v18, 896, v17
    s_mov_b32 s57, 0x40000
    v_subrev_u32 v19, 1792, v17
    s_mov_b32 s63, 8388608
    s_lshl_b32 s40, s28, 12
    s_mul_i32 s46, s28, 3072
    s_add_u32 s46, s46, 65536
    s_add_u32 s41, s40, 16384
    s_add_u32 s47, s46, 12288
    s_lshl_b32 s62, s24, 7
    s_add_u32 s62, s62, s32
    s_add_u32 s62, s62, 8388608
    s_mov_b32 s32, s61
    s_waitcnt lgkmcnt(0)
    s_mov_b32 s8, s16
    s_and_b32 s9, s17, 0xffff
    s_mov_b32 s10, 0x1200000
    s_mov_b32 s11, 0x00020000
    s_mov_b32 s12, s6
    s_and_b32 s13, s7, 0xffff
    s_mov_b32 s14, 0x6e00000
    s_mov_b32 s15, 0x00020000
    s_mov_b32 m0, s40
    s_nop 0
    buffer_load_dwordx4 v10, s[8:11], s32 offen offset:0 lds
    buffer_load_dwordx4 v11, s[8:11], s32 offen offset:1024 lds
    buffer_load_dwordx4 v12, s[8:11], s32 offen offset:2048 lds
    buffer_load_dwordx4 v13, s[8:11], s32 offen offset:3072 lds
    s_mov_b32 m0, s46
    s_nop 0
    buffer_load_dwordx4 v17, s[12:15], s33 offen offset:0 lds
    buffer_load_dwordx4 v18, s[12:15], s33 offen offset:1024 lds
    buffer_load_dwordx4 v19, s[12:15], s33 offen offset:2048 lds
    s_add_u32 s32, s32, s57
    s_add_u32 s33, s33, 98304
    s_sub_u32 s58, s58, 1
    s_cmp_eq_u32 s58, 0
    s_cselect_b32 s59, s63, 0
    s_cselect_b32 s64, 3145728, 0
    s_sub_u32 s32, s32, s59
    s_sub_u32 s33, s33, s64
    s_mov_b32 m0, s41
    s_nop 0
    buffer_load_dwordx4 v10, s[8:11], s32 offen offset:0 lds
    buffer_load_dwordx4 v11, s[8:11], s32 offen offset:1024 lds
    buffer_load_dwordx4 v12, s[8:11], s32 offen offset:2048 lds
    buffer_load_dwordx4 v13, s[8:11], s32 offen offset:3072 lds
    s_mov_b32 m0, s47
    s_nop 0
    buffer_load_dwordx4 v17, s[12:15], s33 offen offset:0 lds
    buffer_load_dwordx4 v18, s[12:15], s33 offen offset:1024 lds
    buffer_load_dwordx4 v19, s[12:15], s33 offen offset:2048 lds
    s_add_u32 s32, s32, s57
    s_add_u32 s33, s33, 98304
    s_sub_u32 s58, s58, 1
    s_cmp_eq_u32 s58, 0
    s_cselect_b32 s59, s63, 0
    s_cselect_b32 s64, 3145728, 0
    s_sub_u32 s32, s32, s59
    s_sub_u32 s33, s33, s64
    s_add_u32 s42, s40, 32768
    s_add_u32 s48, s46, 24576
    s_add_u32 s43, s40, 49152
    s_add_u32 s49, s46, 36864
    s_lshl_b32 s50, s28, 11
    s_add_u32 s51, s50, 16384
    s_add_u32 s52, s50, 32768
    s_add_u32 s53, s50, 49152
    v_lshrrev_b32 v20, 3, v1
    v_add_u32 v20, s29, v20
    v_lshlrev_b32 v20, 12, v20
    v_lshl_add_u32 v20, v4, 4, v20
    v_bfe_u32 v21, v1, 1, 2
    v_xor_b32 v21, v3, v21
    v_lshl_add_u32 v14, v21, 5, v20
    v_add_u32 v15, 31744, v14
    s_waitcnt vmcnt(7)
    s_barrier
    s_mov_b32 m0, s42
    s_nop 0
    buffer_load_dwordx4 v10, s[8:11], s32 offen offset:0 lds
    buffer_load_dwordx4 v11, s[8:11], s32 offen offset:1024 lds
    buffer_load_dwordx4 v12, s[8:11], s32 offen offset:2048 lds
    buffer_load_dwordx4 v13, s[8:11], s32 offen offset:3072 lds
    s_mov_b32 m0, s48
    s_nop 0
    buffer_load_dwordx4 v17, s[12:15], s33 offen offset:0 lds
    buffer_load_dwordx4 v18, s[12:15], s33 offen offset:1024 lds
    buffer_load_dwordx4 v19, s[12:15], s33 offen offset:2048 lds
    s_add_u32 s32, s32, s57
    s_add_u32 s33, s33, 98304
    s_sub_u32 s58, s58, 1
    s_cmp_eq_u32 s58, 0
    s_cselect_b32 s59, s63, 0
    s_cselect_b32 s64, 3145728, 0
    s_sub_u32 s32, s32, s59
    s_sub_u32 s33, s33, s64
    s_mov_b32 m0, s43
    s_nop 0
    buffer_load_dwordx4 v10, s[8:11], s32 offen offset:0 lds
    buffer_load_dwordx4 v11, s[8:11], s32 offen offset:1024 lds
    buffer_load_dwordx4 v12, s[8:11], s32 offen offset:2048 lds
    buffer_load_dwordx4 v13, s[8:11], s32 offen offset:3072 lds
    s_mov_b32 m0, s49
    s_nop 0
    buffer_load_dwordx4 v17, s[12:15], s33 offen offset:0 lds
    buffer_load_dwordx4 v18, s[12:15], s33 offen offset:1024 lds
    buffer_load_dwordx4 v19, s[12:15], s33 offen offset:2048 lds
    s_add_u32 s32, s32, s57
    s_add_u32 s33, s33, 98304
    s_sub_u32 s58, s58, 1
    s_cmp_eq_u32 s58, 0
    s_cselect_b32 s59, s63, 0
    s_cselect_b32 s64, 3145728, 0
    s_sub_u32 s32, s32, s59
    s_sub_u32 s33, s33, s64
    s_waitcnt vmcnt(14)
    s_barrier
    s_mov_b32 m0, s40
    s_nop 0
    buffer_load_dwordx4 v10, s[8:11], s32 offen offset:0 lds
    buffer_load_dwordx4 v11, s[8:11], s32 offen offset:1024 lds
    buffer_load_dwordx4 v12, s[8:11], s32 offen offset:2048 lds
    buffer_load_dwordx4 v13, s[8:11], s32 offen offset:3072 lds
    s_mov_b32 m0, s46
    s_nop 0
    buffer_load_dwordx4 v17, s[12:15], s33 offen offset:0 lds
    buffer_load_dwordx4 v18, s[12:15], s33 offen offset:1024 lds
    buffer_load_dwordx4 v19, s[12:15], s33 offen offset:2048 lds
    s_add_u32 s32, s32, s57
    s_add_u32 s33, s33, 98304
    s_sub_u32 s58, s58, 1
    s_cmp_eq_u32 s58, 0
    s_cselect_b32 s59, s63, 0
    s_cselect_b32 s64, 3145728, 0
    s_sub_u32 s32, s32, s59
    s_sub_u32 s33, s33, s64
    s_waitcnt vmcnt(14)
    s_barrier
    s_mov_b32 m0, s41
    s_nop 0
    buffer_load_dwordx4 v10, s[8:11], s32 offen offset:0 lds
    buffer_load_dwordx4 v11, s[8:11], s32 offen offset:1024 lds
    buffer_load_dwordx4 v12, s[8:11], s32 offen offset:2048 lds
    buffer_load_dwordx4 v13, s[8:11], s32 offen offset:3072 lds
    s_mov_b32 m0, s47
    s_nop 0
    buffer_load_dwordx4 v17, s[12:15], s33 offen offset:0 lds
    buffer_load_dwordx4 v18, s[12:15], s33 offen offset:1024 lds
    buffer_load_dwordx4 v19, s[12:15], s33 offen offset:2048 lds
    s_add_u32 s32, s32, s57
    s_add_u32 s33, s33, 98304
    s_sub_u32 s58, s58, 1
    s_cmp_eq_u32 s58, 0
    s_cselect_b32 s59, s63, 0
    s_cselect_b32 s64, 3145728, 0
    s_sub_u32 s32, s32, s59
    s_sub_u32 s33, s33, s64
    s_waitcnt vmcnt(14)
    s_barrier
    s_mov_b32 m0, s42
    s_nop 0
    buffer_load_dwordx4 v10, s[8:11], s32 offen offset:0 lds
    buffer_load_dwordx4 v11, s[8:11], s32 offen offset:1024 lds
    buffer_load_dwordx4 v12, s[8:11], s32 offen offset:2048 lds
    buffer_load_dwordx4 v13, s[8:11], s32 offen offset:3072 lds
    s_mov_b32 m0, s48
    s_nop 0
    buffer_load_dwordx4 v17, s[12:15], s33 offen offset:0 lds
    buffer_load_dwordx4 v18, s[12:15], s33 offen offset:1024 lds
    buffer_load_dwordx4 v19, s[12:15], s33 offen offset:2048 lds
    s_add_u32 s32, s32, s57
    s_add_u32 s33, s33, 98304
    s_sub_u32 s58, s58, 1
    s_cmp_eq_u32 s58, 0
    s_cselect_b32 s59, s63, 0
    s_cselect_b32 s64, 3145728, 0
    s_sub_u32 s32, s32, s59
    s_sub_u32 s33, s33, s64
    s_waitcnt vmcnt(14)
    s_barrier
    s_mov_b32 m0, s43
    s_nop 0
    buffer_load_dwordx4 v10, s[8:11], s32 offen offset:0 lds
    buffer_load_dwordx4 v11, s[8:11], s32 offen offset:1024 lds
    buffer_load_dwordx4 v12, s[8:11], s32 offen offset:2048 lds
    buffer_load_dwordx4 v13, s[8:11], s32 offen offset:3072 lds
    s_mov_b32 m0, s49
    s_nop 0
    buffer_load_dwordx4 v17, s[12:15], s33 offen offset:0 lds
    buffer_load_dwordx4 v18, s[12:15], s33 offen offset:1024 lds
    buffer_load_dwordx4 v19, s[12:15], s33 offen offset:2048 lds
    s_add_u32 s32, s32, s57
    s_add_u32 s33, s33, 98304
    s_sub_u32 s58, s58, 1
    s_cmp_eq_u32 s58, 0
    s_cselect_b32 s59, s63, 0
    s_cselect_b32 s64, 3145728, 0
    s_sub_u32 s32, s32, s59
    s_sub_u32 s33, s33, s64
    s_waitcnt vmcnt(14)
    s_barrier
    s_mov_b32 m0, s40
    s_nop 0
    buffer_load_dwordx4 v10, s[8:11], s32 offen offset:0 lds
    buffer_load_dwordx4 v11, s[8:11], s32 offen offset:1024 lds
    buffer_load_dwordx4 v12, s[8:11], s32 offen offset:2048 lds
    buffer_load_dwordx4 v13, s[8:11], s32 offen offset:3072 lds
    s_mov_b32 m0, s46
    s_nop 0
    buffer_load_dwordx4 v17, s[12:15], s33 offen offset:0 lds
    buffer_load_dwordx4 v18, s[12:15], s33 offen offset:1024 lds
    buffer_load_dwordx4 v19, s[12:15], s33 offen offset:2048 lds
    s_add_u32 s32, s32, s57
    s_add_u32 s33, s33, 98304
    s_sub_u32 s58, s58, 1
    s_cmp_eq_u32 s58, 0
    s_cselect_b32 s59, s63, 0
    s_cselect_b32 s64, 3145728, 0
    s_sub_u32 s32, s32, s59
    s_sub_u32 s33, s33, s64
    s_waitcnt vmcnt(14)
    s_barrier
    s_mov_b32 m0, s41
    s_nop 0
    buffer_load_dwordx4 v10, s[8:11], s32 offen offset:0 lds
    buffer_load_dwordx4 v11, s[8:11], s32 offen offset:1024 lds
    buffer_load_dwordx4 v12, s[8:11], s32 offen offset:2048 lds
    buffer_load_dwordx4 v13, s[8:11], s32 offen offset:3072 lds
    s_mov_b32 m0, s47
    s_nop 0
    buffer_load_dwordx4 v17, s[12:15], s33 offen offset:0 lds
    buffer_load_dwordx4 v18, s[12:15], s33 offen offset:1024 lds
    buffer_load_dwordx4 v19, s[12:15], s33 offen offset:2048 lds
    s_add_u32 s32, s32, s57
    s_add_u32 s33, s33, 98304
    s_sub_u32 s58, s58, 1
    s_cmp_eq_u32 s58, 0
    s_cselect_b32 s59, s63, 0
    s_cselect_b32 s64, 3145728, 0
    s_sub_u32 s32, s32, s59
    s_sub_u32 s33, s33, s64
    s_waitcnt vmcnt(14)
    s_barrier
    s_mov_b32 m0, s42
    s_nop 0
    buffer_load_dwordx4 v10, s[8:11], s32 offen offset:0 lds
    buffer_load_dwordx4 v11, s[8:11], s32 offen offset:1024 lds
    buffer_load_dwordx4 v12, s[8:11], s32 offen offset:2048 lds
    buffer_load_dwordx4 v13, s[8:11], s32 offen offset:3072 lds
    s_mov_b32 m0, s48
    s_nop 0
    buffer_load_dwordx4 v17, s[12:15], s33 offen offset:0 lds
    buffer_load_dwordx4 v18, s[12:15], s33 offen offset:1024 lds
    buffer_load_dwordx4 v19, s[12:15], s33 offen offset:2048 lds
    s_add_u32 s32, s32, s57
    s_add_u32 s33, s33, 98304
    s_sub_u32 s58, s58, 1
    s_cmp_eq_u32 s58, 0
    s_cselect_b32 s59, s63, 0
    s_cselect_b32 s64, 3145728, 0
    s_sub_u32 s32, s32, s59
    s_sub_u32 s33, s33, s64
    s_waitcnt vmcnt(14)
    s_barrier
    s_mov_b32 m0, s43
    s_nop 0
    buffer_load_dwordx4 v10, s[8:11], s32 offen offset:0 lds
    buffer_load_dwordx4 v11, s[8:11], s32 offen offset:1024 lds
    buffer_load_dwordx4 v12, s[8:11], s32 offen offset:2048 lds
    buffer_load_dwordx4 v13, s[8:11], s32 offen offset:3072 lds
    s_mov_b32 m0, s49
    s_nop 0
    buffer_load_dwordx4 v17, s[12:15], s33 offen offset:0 lds
    buffer_load_dwordx4 v18, s[12:15], s33 offen offset:1024 lds
    buffer_load_dwordx4 v19, s[12:15], s33 offen offset:2048 lds
    s_add_u32 s32, s32, s57
    s_add_u32 s33, s33, 98304
    s_sub_u32 s58, s58, 1
    s_cmp_eq_u32 s58, 0
    s_cselect_b32 s59, s63, 0
    s_cselect_b32 s64, 3145728, 0
    s_sub_u32 s32, s32, s59
    s_sub_u32 s33, s33, s64
    s_waitcnt vmcnt(14)
    s_barrier
    s_mov_b32 m0, s40
    s_nop 0
    buffer_load_dwordx4 v10, s[8:11], s32 offen offset:0 lds
    buffer_load_dwordx4 v11, s[8:11], s32 offen offset:1024 lds
    buffer_load_dwordx4 v12, s[8:11], s32 offen offset:2048 lds
    buffer_load_dwordx4 v13, s[8:11], s32 offen offset:3072 lds
    s_mov_b32 m0, s46
    s_nop 0
    buffer_load_dwordx4 v17, s[12:15], s33 offen offset:0 lds
    buffer_load_dwordx4 v18, s[12:15], s33 offen offset:1024 lds
    buffer_load_dwordx4 v19, s[12:15], s33 offen offset:2048 lds
    s_add_u32 s32, s32, s57
    s_add_u32 s33, s33, 98304
    s_sub_u32 s58, s58, 1
    s_cmp_eq_u32 s58, 0
    s_cselect_b32 s59, s63, 0
    s_cselect_b32 s64, 3145728, 0
    s_sub_u32 s32, s32, s59
    s_sub_u32 s33, s33, s64
    s_waitcnt vmcnt(14)
    s_barrier
    s_mov_b32 m0, s41
    s_nop 0
    buffer_load_dwordx4 v10, s[8:11], s32 offen offset:0 lds
    buffer_load_dwordx4 v11, s[8:11], s32 offen offset:1024 lds
    buffer_load_dwordx4 v12, s[8:11], s32 offen offset:2048 lds
    buffer_load_dwordx4 v13, s[8:11], s32 offen offset:3072 lds
    s_mov_b32 m0, s47
    s_nop 0
    buffer_load_dwordx4 v17, s[12:15], s33 offen offset:0 lds
    buffer_load_dwordx4 v18, s[12:15], s33 offen offset:1024 lds
    buffer_load_dwordx4 v19, s[12:15], s33 offen offset:2048 lds
    s_add_u32 s32, s32, s57
    s_add_u32 s33, s33, 98304
    s_sub_u32 s58, s58, 1
    s_cmp_eq_u32 s58, 0
    s_cselect_b32 s59, s63, 0
    s_cselect_b32 s64, 3145728, 0
    s_sub_u32 s32, s32, s59
    s_sub_u32 s33, s33, s64
    s_waitcnt vmcnt(14)
    s_barrier
    s_mov_b32 m0, s42
    s_nop 0
    buffer_load_dwordx4 v10, s[8:11], s32 offen offset:0 lds
    buffer_load_dwordx4 v11, s[8:11], s32 offen offset:1024 lds
    buffer_load_dwordx4 v12, s[8:11], s32 offen offset:2048 lds
    buffer_load_dwordx4 v13, s[8:11], s32 offen offset:3072 lds
    s_mov_b32 m0, s48
    s_nop 0
    buffer_load_dwordx4 v17, s[12:15], s33 offen offset:0 lds
    buffer_load_dwordx4 v18, s[12:15], s33 offen offset:1024 lds
    buffer_load_dwordx4 v19, s[12:15], s33 offen offset:2048 lds
    s_add_u32 s32, s32, s57
    s_add_u32 s33, s33, 98304
    s_sub_u32 s58, s58, 1
    s_cmp_eq_u32 s58, 0
    s_cselect_b32 s59, s63, 0
    s_cselect_b32 s64, 3145728, 0
    s_sub_u32 s32, s32, s59
    s_sub_u32 s33, s33, s64
    s_waitcnt vmcnt(14)
    s_barrier
    s_mov_b32 m0, s43
    s_nop 0
    buffer_load_dwordx4 v10, s[8:11], s32 offen offset:0 lds
    buffer_load_dwordx4 v11, s[8:11], s32 offen offset:1024 lds
    buffer_load_dwordx4 v12, s[8:11], s32 offen offset:2048 lds
    buffer_load_dwordx4 v13, s[8:11], s32 offen offset:3072 lds
    s_mov_b32 m0, s49
    s_nop 0
    buffer_load_dwordx4 v17, s[12:15], s33 offen offset:0 lds
    buffer_load_dwordx4 v18, s[12:15], s33 offen offset:1024 lds
    buffer_load_dwordx4 v19, s[12:15], s33 offen offset:2048 lds
    s_add_u32 s32, s32, s57
    s_add_u32 s33, s33, 98304
    s_sub_u32 s58, s58, 1
    s_cmp_eq_u32 s58, 0
    s_cselect_b32 s59, s63, 0
    s_cselect_b32 s64, 3145728, 0
    s_sub_u32 s32, s32, s59
    s_sub_u32 s33, s33, s64
    s_waitcnt vmcnt(14)
    s_barrier
    s_mov_b32 m0, s40
    s_nop 0
    buffer_load_dwordx4 v10, s[8:11], s32 offen offset:0 lds
    buffer_load_dwordx4 v11, s[8:11], s32 offen offset:1024 lds
    buffer_load_dwordx4 v12, s[8:11], s32 offen offset:2048 lds
    buffer_load_dwordx4 v13, s[8:11], s32 offen offset:3072 lds
    s_mov_b32 m0, s46
    s_nop 0
    buffer_load_dwordx4 v17, s[12:15], s33 offen offset:0 lds
    buffer_load_dwordx4 v18, s[12:15], s33 offen offset:1024 lds
    buffer_load_dwordx4 v19, s[12:15], s33 offen offset:2048 lds
    s_add_u32 s32, s32, s57
    s_add_u32 s33, s33, 98304
    s_sub_u32 s58, s58, 1
    s_cmp_eq_u32 s58, 0
    s_cselect_b32 s59, s63, 0
    s_cselect_b32 s64, 3145728, 0
    s_sub_u32 s32, s32, s59
    s_sub_u32 s33, s33, s64
    s_waitcnt vmcnt(14)
    s_barrier
    s_mov_b32 m0, s41
    s_nop 0
    buffer_load_dwordx4 v10, s[8:11], s32 offen offset:0 lds
    buffer_load_dwordx4 v11, s[8:11], s32 offen offset:1024 lds
    buffer_load_dwordx4 v12, s[8:11], s32 offen offset:2048 lds
    buffer_load_dwordx4 v13, s[8:11], s32 offen offset:3072 lds
    s_mov_b32 m0, s47
    s_nop 0
    buffer_load_dwordx4 v17, s[12:15], s33 offen offset:0 lds
    buffer_load_dwordx4 v18, s[12:15], s33 offen offset:1024 lds
    buffer_load_dwordx4 v19, s[12:15], s33 offen offset:2048 lds
    s_add_u32 s32, s32, s57
    s_add_u32 s33, s33, 98304
    s_sub_u32 s58, s58, 1
    s_cmp_eq_u32 s58, 0
    s_cselect_b32 s59, s63, 0
    s_cselect_b32 s64, 3145728, 0
    s_sub_u32 s32, s32, s59
    s_sub_u32 s33, s33, s64
    s_waitcnt vmcnt(14)
    s_barrier
    s_mov_b32 m0, s42
    s_nop 0
    buffer_load_dwordx4 v10, s[8:11], s32 offen offset:0 lds
    buffer_load_dwordx4 v11, s[8:11], s32 offen offset:1024 lds
    buffer_load_dwordx4 v12, s[8:11], s32 offen offset:2048 lds
    buffer_load_dwordx4 v13, s[8:11], s32 offen offset:3072 lds
    s_mov_b32 m0, s48
    s_nop 0
    buffer_load_dwordx4 v17, s[12:15], s33 offen offset:0 lds
    buffer_load_dwordx4 v18, s[12:15], s33 offen offset:1024 lds
    buffer_load_dwordx4 v19, s[12:15], s33 offen offset:2048 lds
    s_add_u32 s32, s32, s57
    s_add_u32 s33, s33, 98304
    s_sub_u32 s58, s58, 1
    s_cmp_eq_u32 s58, 0
    s_cselect_b32 s59, s63, 0
    s_cselect_b32 s64, 3145728, 0
    s_sub_u32 s32, s32, s59
    s_sub_u32 s33, s33, s64
    s_waitcnt vmcnt(14)
    s_barrier
    s_mov_b32 m0, s43
    s_nop 0
    buffer_load_dwordx4 v10, s[8:11], s32 offen offset:0 lds
    buffer_load_dwordx4 v11, s[8:11], s32 offen offset:1024 lds
    buffer_load_dwordx4 v12, s[8:11], s32 offen offset:2048 lds
    buffer_load_dwordx4 v13, s[8:11], s32 offen offset:3072 lds
    s_mov_b32 m0, s49
    s_nop 0
    buffer_load_dwordx4 v17, s[12:15], s33 offen offset:0 lds
    buffer_load_dwordx4 v18, s[12:15], s33 offen offset:1024 lds
    buffer_load_dwordx4 v19, s[12:15], s33 offen offset:2048 lds
    s_add_u32 s32, s32, s57
    s_add_u32 s33, s33, 98304
    s_sub_u32 s58, s58, 1
    s_cmp_eq_u32 s58, 0
    s_cselect_b32 s59, s63, 0
    s_cselect_b32 s64, 3145728, 0
    s_sub_u32 s32, s32, s59
    s_sub_u32 s33, s33, s64
    s_waitcnt vmcnt(14)
    s_barrier
    s_mov_b32 m0, s40
    s_nop 0
    buffer_load_dwordx4 v10, s[8:11], s32 offen offset:0 lds
    buffer_load_dwordx4 v11, s[8:11], s32 offen offset:1024 lds
    buffer_load_dwordx4 v12, s[8:11], s32 offen offset:2048 lds
    buffer_load_dwordx4 v13, s[8:11], s32 offen offset:3072 lds
    s_mov_b32 m0, s46
    s_nop 0
    buffer_load_dwordx4 v17, s[12:15], s33 offen offset:0 lds
    buffer_load_dwordx4 v18, s[12:15], s33 offen offset:1024 lds
    buffer_load_dwordx4 v19, s[12:15], s33 offen offset:2048 lds
    s_add_u32 s32, s32, s57
    s_add_u32 s33, s33, 98304
    s_sub_u32 s58, s58, 1
    s_cmp_eq_u32 s58, 0
    s_cselect_b32 s59, s63, 0
    s_cselect_b32 s64, 3145728, 0
    s_sub_u32 s32, s32, s59
    s_sub_u32 s33, s33, s64
    s_waitcnt vmcnt(14)
    s_barrier
    s_mov_b32 m0, s41
    s_nop 0
    buffer_load_dwordx4 v10, s[8:11], s32 offen offset:0 lds
    buffer_load_dwordx4 v11, s[8:11], s32 offen offset:1024 lds
    buffer_load_dwordx4 v12, s[8:11], s32 offen offset:2048 lds
    buffer_load_dwordx4 v13, s[8:11], s32 offen offset:3072 lds
    s_mov_b32 m0, s47
    s_nop 0
    buffer_load_dwordx4 v17, s[12:15], s33 offen offset:0 lds
    buffer_load_dwordx4 v18, s[12:15], s33 offen offset:1024 lds
    buffer_load_dwordx4 v19, s[12:15], s33 offen offset:2048 lds
    s_add_u32 s32, s32, s57
    s_add_u32 s33, s33, 98304
    s_sub_u32 s58, s58, 1
    s_cmp_eq_u32 s58, 0
    s_cselect_b32 s59, s63, 0
    s_cselect_b32 s64, 3145728, 0
    s_sub_u32 s32, s32, s59
    s_sub_u32 s33, s33, s64
    s_waitcnt vmcnt(14)
    s_barrier
    s_mov_b32 m0, s42
    s_nop 0
    buffer_load_dwordx4 v10, s[8:11], s32 offen offset:0 lds
    buffer_load_dwordx4 v11, s[8:11], s32 offen offset:1024 lds
    buffer_load_dwordx4 v12, s[8:11], s32 offen offset:2048 lds
    buffer_load_dwordx4 v13, s[8:11], s32 offen offset:3072 lds
    s_mov_b32 m0, s48
    s_nop 0
    buffer_load_dwordx4 v17, s[12:15], s33 offen offset:0 lds
    buffer_load_dwordx4 v18, s[12:15], s33 offen offset:1024 lds
    buffer_load_dwordx4 v19, s[12:15], s33 offen offset:2048 lds
    s_add_u32 s32, s32, s57
    s_add_u32 s33, s33, 98304
    s_sub_u32 s58, s58, 1
    s_cmp_eq_u32 s58, 0
    s_cselect_b32 s59, s63, 0
    s_cselect_b32 s64, 3145728, 0
    s_sub_u32 s32, s32, s59
    s_sub_u32 s33, s33, s64
    s_waitcnt vmcnt(14)
    s_barrier
    s_mov_b32 m0, s43
    s_nop 0
    buffer_load_dwordx4 v10, s[8:11], s32 offen offset:0 lds
    buffer_load_dwordx4 v11, s[8:11], s32 offen offset:1024 lds
    buffer_load_dwordx4 v12, s[8:11], s32 offen offset:2048 lds
    buffer_load_dwordx4 v13, s[8:11], s32 offen offset:3072 lds
    s_mov_b32 m0, s49
    s_nop 0
    buffer_load_dwordx4 v17, s[12:15], s33 offen offset:0 lds
    buffer_load_dwordx4 v18, s[12:15], s33 offen offset:1024 lds
    buffer_load_dwordx4 v19, s[12:15], s33 offen offset:2048 lds
    s_add_u32 s32, s32, s57
    s_add_u32 s33, s33, 98304
    s_sub_u32 s58, s58, 1
    s_cmp_eq_u32 s58, 0
    s_cselect_b32 s59, s63, 0
    s_cselect_b32 s64, 3145728, 0
    s_sub_u32 s32, s32, s59
    s_sub_u32 s33, s33, s64
    s_waitcnt vmcnt(14)
    s_barrier
    s_mov_b32 m0, s40
    s_nop 0
    buffer_load_dwordx4 v10, s[8:11], s32 offen offset:0 lds
    buffer_load_dwordx4 v11, s[8:11], s32 offen offset:1024 lds
    buffer_load_dwordx4 v12, s[8:11], s32 offen offset:2048 lds
    buffer_load_dwordx4 v13, s[8:11], s32 offen offset:3072 lds
    s_mov_b32 m0, s46
    s_nop 0
    buffer_load_dwordx4 v17, s[12:15], s33 offen offset:0 lds
    buffer_load_dwordx4 v18, s[12:15], s33 offen offset:1024 lds
    buffer_load_dwordx4 v19, s[12:15], s33 offen offset:2048 lds
    s_add_u32 s32, s32, s57
    s_add_u32 s33, s33, 98304
    s_sub_u32 s58, s58, 1
    s_cmp_eq_u32 s58, 0
    s_cselect_b32 s59, s63, 0
    s_cselect_b32 s64, 3145728, 0
    s_sub_u32 s32, s32, s59
    s_sub_u32 s33, s33, s64
    s_waitcnt vmcnt(14)
    s_barrier
    s_mov_b32 m0, s41
    s_nop 0
    buffer_load_dwordx4 v10, s[8:11], s32 offen offset:0 lds
    buffer_load_dwordx4 v11, s[8:11], s32 offen offset:1024 lds
    buffer_load_dwordx4 v12, s[8:11], s32 offen offset:2048 lds
    buffer_load_dwordx4 v13, s[8:11], s32 offen offset:3072 lds
    s_mov_b32 m0, s47
    s_nop 0
    buffer_load_dwordx4 v17, s[12:15], s33 offen offset:0 lds
    buffer_load_dwordx4 v18, s[12:15], s33 offen offset:1024 lds
    buffer_load_dwordx4 v19, s[12:15], s33 offen offset:2048 lds
    s_add_u32 s32, s32, s57
    s_add_u32 s33, s33, 98304
    s_sub_u32 s58, s58, 1
    s_cmp_eq_u32 s58, 0
    s_cselect_b32 s59, s63, 0
    s_cselect_b32 s64, 3145728, 0
    s_sub_u32 s32, s32, s59
    s_sub_u32 s33, s33, s64
    s_waitcnt vmcnt(14)
    s_barrier
    s_mov_b32 m0, s42
    s_nop 0
    buffer_load_dwordx4 v10, s[8:11], s32 offen offset:0 lds
    buffer_load_dwordx4 v11, s[8:11], s32 offen offset:1024 lds
    buffer_load_dwordx4 v12, s[8:11], s32 offen offset:2048 lds
    buffer_load_dwordx4 v13, s[8:11], s32 offen offset:3072 lds
    s_mov_b32 m0, s48
    s_nop 0
    buffer_load_dwordx4 v17, s[12:15], s33 offen offset:0 lds
    buffer_load_dwordx4 v18, s[12:15], s33 offen offset:1024 lds
    buffer_load_dwordx4 v19, s[12:15], s33 offen offset:2048 lds
    s_add_u32 s32, s32, s57
    s_add_u32 s33, s33, 98304
    s_sub_u32 s58, s58, 1
    s_cmp_eq_u32 s58, 0
    s_cselect_b32 s59, s63, 0
    s_cselect_b32 s64, 3145728, 0
    s_sub_u32 s32, s32, s59
    s_sub_u32 s33, s33, s64
    s_waitcnt vmcnt(14)
    s_barrier
    s_mov_b32 m0, s43
    s_nop 0
    buffer_load_dwordx4 v10, s[8:11], s32 offen offset:0 lds
    buffer_load_dwordx4 v11, s[8:11], s32 offen offset:1024 lds
    buffer_load_dwordx4 v12, s[8:11], s32 offen offset:2048 lds
    buffer_load_dwordx4 v13, s[8:11], s32 offen offset:3072 lds
    s_mov_b32 m0, s49
    s_nop 0
    buffer_load_dwordx4 v17, s[12:15], s33 offen offset:0 lds
    buffer_load_dwordx4 v18, s[12:15], s33 offen offset:1024 lds
    buffer_load_dwordx4 v19, s[12:15], s33 offen offset:2048 lds
    s_add_u32 s32, s32, s57
    s_add_u32 s33, s33, 98304
    s_sub_u32 s58, s58, 1
    s_cmp_eq_u32 s58, 0
    s_cselect_b32 s59, s63, 0
    s_cselect_b32 s64, 3145728, 0
    s_sub_u32 s32, s32, s59
    s_sub_u32 s33, s33, s64
    s_waitcnt vmcnt(14)
    s_barrier
    s_mov_b32 m0, s40
    s_nop 0
    buffer_load_dwordx4 v10, s[8:11], s32 offen offset:0 lds
    buffer_load_dwordx4 v11, s[8:11], s32 offen offset:1024 lds
    buffer_load_dwordx4 v12, s[8:11], s32 offen offset:2048 lds
    buffer_load_dwordx4 v13, s[8:11], s32 offen offset:3072 lds
    s_mov_b32 m0, s46
    s_nop 0
    buffer_load_dwordx4 v17, s[12:15], s33 offen offset:0 lds
    buffer_load_dwordx4 v18, s[12:15], s33 offen offset:1024 lds
    buffer_load_dwordx4 v19, s[12:15], s33 offen offset:2048 lds
    s_add_u32 s32, s32, s57
    s_add_u32 s33, s33, 98304
    s_sub_u32 s58, s58, 1
    s_cmp_eq_u32 s58, 0
    s_cselect_b32 s59, s63, 0
    s_cselect_b32 s64, 3145728, 0
    s_sub_u32 s32, s32, s59
    s_sub_u32 s33, s33, s64
    s_waitcnt vmcnt(14)
    s_barrier
    s_mov_b32 m0, s41
    s_nop 0
    buffer_load_dwordx4 v10, s[8:11], s32 offen offset:0 lds
    buffer_load_dwordx4 v11, s[8:11], s32 offen offset:1024 lds
    buffer_load_dwordx4 v12, s[8:11], s32 offen offset:2048 lds
    buffer_load_dwordx4 v13, s[8:11], s32 offen offset:3072 lds
    s_mov_b32 m0, s47
    s_nop 0
    buffer_load_dwordx4 v17, s[12:15], s33 offen offset:0 lds
    buffer_load_dwordx4 v18, s[12:15], s33 offen offset:1024 lds
    buffer_load_dwordx4 v19, s[12:15], s33 offen offset:2048 lds
    s_add_u32 s32, s32, s57
    s_add_u32 s33, s33, 98304
    s_sub_u32 s58, s58, 1
    s_cmp_eq_u32 s58, 0
    s_cselect_b32 s59, s63, 0
    s_cselect_b32 s64, 3145728, 0
    s_sub_u32 s32, s32, s59
    s_sub_u32 s33, s33, s64
    s_waitcnt vmcnt(14)
    s_barrier
    s_mov_b32 m0, s42
    s_nop 0
    buffer_load_dwordx4 v10, s[8:11], s32 offen offset:0 lds
    buffer_load_dwordx4 v11, s[8:11], s32 offen offset:1024 lds
    buffer_load_dwordx4 v12, s[8:11], s32 offen offset:2048 lds
    buffer_load_dwordx4 v13, s[8:11], s32 offen offset:3072 lds
    s_mov_b32 m0, s48
    s_nop 0
    buffer_load_dwordx4 v17, s[12:15], s33 offen offset:0 lds
    buffer_load_dwordx4 v18, s[12:15], s33 offen offset:1024 lds
    buffer_load_dwordx4 v19, s[12:15], s33 offen offset:2048 lds
    s_add_u32 s32, s32, s57
    s_add_u32 s33, s33, 98304
    s_sub_u32 s58, s58, 1
    s_cmp_eq_u32 s58, 0
    s_cselect_b32 s59, s63, 0
    s_cselect_b32 s64, 3145728, 0
    s_sub_u32 s32, s32, s59
    s_sub_u32 s33, s33, s64
    s_waitcnt vmcnt(14)
    s_barrier
    s_mov_b32 m0, s43
    s_nop 0
    buffer_load_dwordx4 v10, s[8:11], s32 offen offset:0 lds
    buffer_load_dwordx4 v11, s[8:11], s32 offen offset:1024 lds
    buffer_load_dwordx4 v12, s[8:11], s32 offen offset:2048 lds
    buffer_load_dwordx4 v13, s[8:11], s32 offen offset:3072 lds
    s_mov_b32 m0, s49
    s_nop 0
    buffer_load_dwordx4 v17, s[12:15], s33 offen offset:0 lds
    buffer_load_dwordx4 v18, s[12:15], s33 offen offset:1024 lds
    buffer_load_dwordx4 v19, s[12:15], s33 offen offset:2048 lds
    s_add_u32 s32, s32, s57
    s_add_u32 s33, s33, 98304
    s_waitcnt vmcnt(14)
    s_barrier
    s_mov_b32 s32, s62
    s_mov_b32 s33, 18149376
    s_mov_b32 m0, s50
    s_nop 0
    buffer_load_dwordx4 v14, s[8:11], s32 offen offset:0 lds
    buffer_load_dwordx4 v15, s[8:11], s32 offen offset:1024 lds
    s_mov_b32 m0, s46
    s_nop 0
    buffer_load_dwordx4 v17, s[12:15], s33 offen offset:0 lds
    buffer_load_dwordx4 v18, s[12:15], s33 offen offset:1024 lds
    buffer_load_dwordx4 v19, s[12:15], s33 offen offset:2048 lds
    s_add_u32 s32, s32, s57
    s_add_u32 s33, s33, 98304
    s_waitcnt vmcnt(12)
    s_barrier
    s_mov_b32 m0, s51
    s_nop 0
    buffer_load_dwordx4 v14, s[8:11], s32 offen offset:0 lds
    buffer_load_dwordx4 v15, s[8:11], s32 offen offset:1024 lds
    s_mov_b32 m0, s47
    s_nop 0
    buffer_load_dwordx4 v17, s[12:15], s33 offen offset:0 lds
    buffer_load_dwordx4 v18, s[12:15], s33 offen offset:1024 lds
    buffer_load_dwordx4 v19, s[12:15], s33 offen offset:2048 lds
    s_add_u32 s32, s32, s57
    s_add_u32 s33, s33, 98304
    s_waitcnt vmcnt(10)
    s_barrier
    s_mov_b32 m0, s52
    s_nop 0
    buffer_load_dwordx4 v14, s[8:11], s32 offen offset:0 lds
    buffer_load_dwordx4 v15, s[8:11], s32 offen offset:1024 lds
    s_mov_b32 m0, s48
    s_nop 0
    buffer_load_dwordx4 v17, s[12:15], s33 offen offset:0 lds
    buffer_load_dwordx4 v18, s[12:15], s33 offen offset:1024 lds
    buffer_load_dwordx4 v19, s[12:15], s33 offen offset:2048 lds
    s_add_u32 s32, s32, s57
    s_add_u32 s33, s33, 98304
    s_waitcnt vmcnt(10)
    s_barrier
    s_mov_b32 m0, s53
    s_nop 0
    buffer_load_dwordx4 v14, s[8:11], s32 offen offset:0 lds
    buffer_load_dwordx4 v15, s[8:11], s32 offen offset:1024 lds
    s_mov_b32 m0, s49
    s_nop 0
    buffer_load_dwordx4 v17, s[12:15], s33 offen offset:0 lds
    buffer_load_dwordx4 v18, s[12:15], s33 offen offset:1024 lds
    buffer_load_dwordx4 v19, s[12:15], s33 offen offset:2048 lds
    s_add_u32 s32, s32, s57
    s_add_u32 s33, s33, 98304
    s_waitcnt vmcnt(10)
    s_barrier
    s_mov_b32 m0, s50
    s_nop 0
    buffer_load_dwordx4 v14, s[8:11], s32 offen offset:0 lds
    buffer_load_dwordx4 v15, s[8:11], s32 offen offset:1024 lds
    s_mov_b32 m0, s46
    s_nop 0
    buffer_load_dwordx4 v17, s[12:15], s33 offen offset:0 lds
    buffer_load_dwordx4 v18, s[12:15], s33 offen offset:1024 lds
    buffer_load_dwordx4 v19, s[12:15], s33 offen offset:2048 lds
    s_add_u32 s32, s32, s57
    s_add_u32 s33, s33, 98304
    s_waitcnt vmcnt(10)
    s_barrier
    s_mov_b32 m0, s51
    s_nop 0
    buffer_load_dwordx4 v14, s[8:11], s32 offen offset:0 lds
    buffer_load_dwordx4 v15, s[8:11], s32 offen offset:1024 lds
    s_mov_b32 m0, s47
    s_nop 0
    buffer_load_dwordx4 v17, s[12:15], s33 offen offset:0 lds
    buffer_load_dwordx4 v18, s[12:15], s33 offen offset:1024 lds
    buffer_load_dwordx4 v19, s[12:15], s33 offen offset:2048 lds
    s_add_u32 s32, s32, s57
    s_add_u32 s33, s33, 98304
    s_waitcnt vmcnt(10)
    s_barrier
    s_mov_b32 m0, s52
    s_nop 0
    buffer_load_dwordx4 v14, s[8:11], s32 offen offset:0 lds
    buffer_load_dwordx4 v15, s[8:11], s32 offen offset:1024 lds
    s_mov_b32 m0, s48
    s_nop 0
    buffer_load_dwordx4 v17, s[12:15], s33 offen offset:0 lds
    buffer_load_dwordx4 v18, s[12:15], s33 offen offset:1024 lds
    buffer_load_dwordx4 v19, s[12:15], s33 offen offset:2048 lds
    s_add_u32 s32, s32, s57
    s_add_u32 s33, s33, 98304
    s_waitcnt vmcnt(10)
    s_barrier
    s_mov_b32 m0, s53
    s_nop 0
    buffer_load_dwordx4 v14, s[8:11], s32 offen offset:0 lds
    buffer_load_dwordx4 v15, s[8:11], s32 offen offset:1024 lds
    s_mov_b32 m0, s49
    s_nop 0
    buffer_load_dwordx4 v17, s[12:15], s33 offen offset:0 lds
    buffer_load_dwordx4 v18, s[12:15], s33 offen offset:1024 lds
    buffer_load_dwordx4 v19, s[12:15], s33 offen offset:2048 lds
    s_waitcnt vmcnt(10)
    s_barrier
    s_waitcnt vmcnt(5)
    s_barrier
    s_waitcnt vmcnt(0)
    s_barrier
    s_branch K5_END
K5_CONS:
    s_mul_i32 s3, s4, 6
    s_add_u32 s3, s3, s5
    v_bfe_u32 v8, v1, 2, 2
    v_and_b32 v9, 3, v1
    v_and_b32 v10, 1, v3
    v_lshl_add_u32 v10, v10, 2, v8
    v_lshl_add_u32 v11, v3, 2, v8
    v_xor_b32 v10, s27, v10
    v_lshlrev_b32 v12, 8, v11
    v_lshl_add_u32 v12, v9, 3, v12
    v_lshl_add_u32 v4, v10, 5, v12
    v_xor_b32 v10, 4, v10
    v_lshl_add_u32 v5, v10, 5, v12
    v_bfe_u32 v10, v11, 1, 2
    v_xor_b32 v10, s27, v10
    v_lshlrev_b32 v12, 7, v11
    v_lshl_add_u32 v12, v9, 3, v12
    v_lshl_add_u32 v6, v10, 5, v12
    v_lshlrev_b32 v8, 4, v1
    v_add_u32 v8, 65536, v8
    v_add_u32 v9, 24576, v8
    v_mov_b32 v96, 0
    v_mov_b32 v97, 0
    v_mov_b32 v98, 0
    v_mov_b32 v99, 0
    v_mov_b32 v100, 0
    v_mov_b32 v101, 0
    v_mov_b32 v102, 0
    v_mov_b32 v103, 0
    v_mov_b32 v104, 0
    v_mov_b32 v105, 0
    v_mov_b32 v106, 0
    v_mov_b32 v107, 0
    v_mov_b32 v108, 0
    v_mov_b32 v109, 0
    v_mov_b32 v110, 0
    v_mov_b32 v111, 0
    v_mov_b32 v112, 0
    v_mov_b32 v113, 0
    v_mov_b32 v114, 0
    v_mov_b32 v115, 0
    v_mov_b32 v116, 0
    v_mov_b32 v117, 0
    v_mov_b32 v118, 0
    v_mov_b32 v119, 0
    v_mov_b32 v120, 0
    v_mov_b32 v121, 0
    v_mov_b32 v122, 0
    v_mov_b32 v123, 0
    v_mov_b32 v124, 0
    v_mov_b32 v125, 0
    v_mov_b32 v126, 0
    v_mov_b32 v127, 0
    v_mov_b32 v128, 0
    v_mov_b32 v129, 0
    v_mov_b32 v130, 0
    v_mov_b32 v131, 0
    v_mov_b32 v132, 0
    v_mov_b32 v133, 0
    v_mov_b32 v134, 0
    v_mov_b32 v135, 0
    v_mov_b32 v136, 0
    v_mov_b32 v137, 0
    v_mov_b32 v138, 0
    v_mov_b32 v139, 0
    v_mov_b32 v140, 0
    v_mov_b32 v141, 0
    v_mov_b32 v142, 0
    v_mov_b32 v143, 0
    s_waitcnt lgkmcnt(0)
    s_mov_b32 s12, s6
    s_and_b32 s13, s7, 0xffff
    s_mov_b32 s14, 0x6e00000
    s_mov_b32 s15, 0x00020000
    s_barrier
    ds_read_b64_tr_b16 v[56:57], v4 offset:0
    ds_read_b64_tr_b16 v[58:59], v4 offset:4096
    ds_read_b128 v[32:35], v8 offset:0
    ds_read_b64_tr_b16 v[60:61], v5 offset:0
    ds_read_b64_tr_b16 v[62:63], v5 offset:4096
    ds_read_b128 v[36:39], v8 offset:1024
    ds_read_b128 v[40:43], v8 offset:2048
    ds_read_b128 v[44:47], v8 offset:3072
    ds_read_b128 v[48:51], v8 offset:4096
    ds_read_b128 v[52:55], v8 offset:5120
    v_and_b32 v10, 15, v1
    v_lshlrev_b32 v10, 1, v10
    v_lshl_add_u32 v11, v3, 15, v10
    s_lshl_b32 s30, s4, 7
    s_lshl_b32 s31, s27, 4
    s_add_u32 s30, s30, s31
    s_lshl_b32 s31, s24, 6
    s_add_u32 s30, s30, s31
    s_mov_b32 s38, s30
    s_lshl_b32 s30, s30, 1
    s_mov_b32 s16, s18
    s_and_b32 s17, s19, 0xffff
    s_mov_b32 s18, 0x1000
    s_mov_b32 s19, 0x00020000
    buffer_load_ushort v168, v10, s[16:19], s30 offen
    s_mul_i32 s31, s5, 96
    s_mov_b32 s39, s31
    s_lshl_b32 s31, s31, 13
    s_lshr_b32 s33, s30, 9
    s_lshl_b32 s33, s33, 10
    s_and_b32 s30, s30, 511
    s_add_u32 s30, s30, s33
    s_add_u32 s30, s30, s31
    s_add_u32 s30, s30, 4719104
    buffer_load_ushort v144, v11, s[12:15], s30 offen
    s_add_u32 s30, s30, 8192
    buffer_load_ushort v145, v11, s[12:15], s30 offen
    s_add_u32 s30, s30, 8192
    buffer_load_ushort v146, v11, s[12:15], s30 offen
    s_add_u32 s30, s30, 8192
    buffer_load_ushort v147, v11, s[12:15], s30 offen
    s_add_u32 s30, s30, 106496
    buffer_load_ushort v148, v11, s[12:15], s30 offen
    s_add_u32 s30, s30, 8192
    buffer_load_ushort v149, v11, s[12:15], s30 offen
    s_add_u32 s30, s30, 8192
    buffer_load_ushort v150, v11, s[12:15], s30 offen
    s_add_u32 s30, s30, 8192
    buffer_load_ushort v151, v11, s[12:15], s30 offen
    s_add_u32 s30, s30, 106496
    buffer_load_ushort v152, v11, s[12:15], s30 offen
    s_add_u32 s30, s30, 8192
    buffer_load_ushort v153, v11, s[12:15], s30 offen
    s_add_u32 s30, s30, 8192
    buffer_load_ushort v154, v11, s[12:15], s30 offen
    s_add_u32 s30, s30, 8192
    buffer_load_ushort v155, v11, s[12:15], s30 offen
    s_add_u32 s30, s30, 106496
    buffer_load_ushort v156, v11, s[12:15], s30 offen
    s_add_u32 s30, s30, 8192
    buffer_load_ushort v157, v11, s[12:15], s30 offen
    s_add_u32 s30, s30, 8192
    buffer_load_ushort v158, v11, s[12:15], s30 offen
    s_add_u32 s30, s30, 8192
    buffer_load_ushort v159, v11, s[12:15], s30 offen
    s_add_u32 s30, s30, 106496
    buffer_load_ushort v160, v11, s[12:15], s30 offen
    s_add_u32 s30, s30, 8192
    buffer_load_ushort v161, v11, s[12:15], s30 offen
    s_add_u32 s30, s30, 8192
    buffer_load_ushort v162, v11, s[12:15], s30 offen
    s_add_u32 s30, s30, 8192
    buffer_load_ushort v163, v11, s[12:15], s30 offen
    s_add_u32 s30, s30, 106496
    buffer_load_ushort v164, v11, s[12:15], s30 offen
    s_add_u32 s30, s30, 8192
    buffer_load_ushort v165, v11, s[12:15], s30 offen
    s_add_u32 s30, s30, 8192
    buffer_load_ushort v166, v11, s[12:15], s30 offen
    s_add_u32 s30, s30, 8192
    buffer_load_ushort v167, v11, s[12:15], s30 offen
    v_lshrrev_b32 v10, 3, v1
    v_cmp_le_u32 vcc, 3, v10
    s_nop 1
    v_addc_co_u32 v10, vcc, 0, v10, vcc
    v_and_b32 v11, 7, v1
    v_lshlrev_b32 v11, 4, v11
    v_lshl_add_u32 v10, v10, 7, v11
    s_mul_i32 s30, s3, 8
    s_add_u32 s30, s30, s27
    s_lshl_b32 s34, s30, 7
    s_add_u32 s34, s34, 76546048
    s_mul_i32 s30, s30, 24576
    s_add_u32 s30, s30, 77594624
    v_and_b32 v15, 15, v1
    v_lshlrev_b32 v12, 9, v15
    v_mul_u32_u24 v15, 1152, v15
    v_lshl_add_u32 v15, v3, 3, v15
    s_mul_i32 s38, s38, 1152
    s_lshl_b32 s39, s39, 1
    s_add_u32 s38, s38, s39
    v_mov_b32 v14, 0
    s_movk_i32 s31, 7
K5_CLOOP:
    s_waitcnt lgkmcnt(7)
    v_mfma_f32_16x16x32_bf16 v[96:99], v[32:35], v[56:59], v[96:99]
    ds_read_b64_tr_b16 v[88:89], v4 offset:8192
    s_waitcnt lgkmcnt(6)
    v_mfma_f32_16x16x32_bf16 v[100:103], v[32:35], v[60:63], v[100:103]
    ds_read_b64_tr_b16 v[90:91], v4 offset:12288
    s_waitcnt lgkmcnt(6)
    v_mfma_f32_16x16x32_bf16 v[104:107], v[36:39], v[56:59], v[104:107]
    ds_read_b128 v[64:67], v8 offset:6144
    v_mfma_f32_16x16x32_bf16 v[108:111], v[36:39], v[60:63], v[108:111]
    ds_read_b64_tr_b16 v[92:93], v5 offset:8192
    s_waitcnt lgkmcnt(7)
    v_mfma_f32_16x16x32_bf16 v[112:115], v[40:43], v[56:59], v[112:115]
    ds_read_b64_tr_b16 v[94:95], v5 offset:12288
    v_mfma_f32_16x16x32_bf16 v[116:119], v[40:43], v[60:63], v[116:119]
    ds_read_b128 v[68:71], v8 offset:7168
    s_waitcnt lgkmcnt(8)
    v_mfma_f32_16x16x32_bf16 v[120:123], v[44:47], v[56:59], v[120:123]
    ds_read_b128 v[72:75], v8 offset:8192
    v_mfma_f32_16x16x32_bf16 v[124:127], v[44:47], v[60:63], v[124:127]
    ds_read_b128 v[76:79], v8 offset:9216
    s_waitcnt lgkmcnt(9)
    v_mfma_f32_16x16x32_bf16 v[128:131], v[48:51], v[56:59], v[128:131]
    ds_read_b128 v[80:83], v8 offset:10240
    v_mfma_f32_16x16x32_bf16 v[132:135], v[48:51], v[60:63], v[132:135]
    ds_read_b128 v[84:87], v8 offset:11264
    s_waitcnt lgkmcnt(10)
    v_mfma_f32_16x16x32_bf16 v[136:139], v[52:55], v[56:59], v[136:139]
    v_mfma_f32_16x16x32_bf16 v[140:143], v[52:55], v[60:63], v[140:143]
    s_waitcnt lgkmcnt(7)
    v_mfma_f32_16x16x32_bf16 v[96:99], v[64:67], v[88:91], v[96:99]
    s_waitcnt lgkmcnt(5)
    v_mfma_f32_16x16x32_bf16 v[100:103], v[64:67], v[92:95], v[100:103]
    s_waitcnt lgkmcnt(0)
    s_barrier
    v_mfma_f32_16x16x32_bf16 v[104:107], v[68:71], v[88:91], v[104:107]
    ds_read_b64_tr_b16 v[56:57], v4 offset:16384
    v_mfma_f32_16x16x32_bf16 v[108:111], v[68:71], v[92:95], v[108:111]
    ds_read_b64_tr_b16 v[58:59], v4 offset:20480
    v_mfma_f32_16x16x32_bf16 v[112:115], v[72:75], v[88:91], v[112:115]
    ds_read_b128 v[32:35], v8 offset:12288
    v_mfma_f32_16x16x32_bf16 v[116:119], v[72:75], v[92:95], v[116:119]
    ds_read_b64_tr_b16 v[60:61], v5 offset:16384
    v_mfma_f32_16x16x32_bf16 v[120:123], v[76:79], v[88:91], v[120:123]
    ds_read_b64_tr_b16 v[62:63], v5 offset:20480
    v_mfma_f32_16x16x32_bf16 v[124:127], v[76:79], v[92:95], v[124:127]
    ds_read_b128 v[36:39], v8 offset:13312
    v_mfma_f32_16x16x32_bf16 v[128:131], v[80:83], v[88:91], v[128:131]
    ds_read_b128 v[40:43], v8 offset:14336
    v_mfma_f32_16x16x32_bf16 v[132:135], v[80:83], v[92:95], v[132:135]
    ds_read_b128 v[44:47], v8 offset:15360
    v_mfma_f32_16x16x32_bf16 v[136:139], v[84:87], v[88:91], v[136:139]
    ds_read_b128 v[48:51], v8 offset:16384
    v_mfma_f32_16x16x32_bf16 v[140:143], v[84:87], v[92:95], v[140:143]
    ds_read_b128 v[52:55], v8 offset:17408
    s_waitcnt lgkmcnt(7)
    v_mfma_f32_16x16x32_bf16 v[96:99], v[32:35], v[56:59], v[96:99]
    ds_read_b64_tr_b16 v[88:89], v4 offset:24576
    s_waitcnt lgkmcnt(6)
    v_mfma_f32_16x16x32_bf16 v[100:103], v[32:35], v[60:63], v[100:103]
    ds_read_b64_tr_b16 v[90:91], v4 offset:28672
    s_waitcnt lgkmcnt(6)
    v_mfma_f32_16x16x32_bf16 v[104:107], v[36:39], v[56:59], v[104:107]
    ds_read_b128 v[64:67], v8 offset:18432
    v_mfma_f32_16x16x32_bf16 v[108:111], v[36:39], v[60:63], v[108:111]
    ds_read_b64_tr_b16 v[92:93], v5 offset:24576
    s_waitcnt lgkmcnt(7)
    v_mfma_f32_16x16x32_bf16 v[112:115], v[40:43], v[56:59], v[112:115]
    ds_read_b64_tr_b16 v[94:95], v5 offset:28672
    v_mfma_f32_16x16x32_bf16 v[116:119], v[40:43], v[60:63], v[116:119]
    ds_read_b128 v[68:71], v8 offset:19456
    s_waitcnt lgkmcnt(8)
    v_mfma_f32_16x16x32_bf16 v[120:123], v[44:47], v[56:59], v[120:123]
    ds_read_b128 v[72:75], v8 offset:20480
    v_mfma_f32_16x16x32_bf16 v[124:127], v[44:47], v[60:63], v[124:127]
    ds_read_b128 v[76:79], v8 offset:21504
    s_waitcnt lgkmcnt(9)
    v_mfma_f32_16x16x32_bf16 v[128:131], v[48:51], v[56:59], v[128:131]
    ds_read_b128 v[80:83], v8 offset:22528
    v_mfma_f32_16x16x32_bf16 v[132:135], v[48:51], v[60:63], v[132:135]
    ds_read_b128 v[84:87], v8 offset:23552
    s_waitcnt lgkmcnt(10)
    v_mfma_f32_16x16x32_bf16 v[136:139], v[52:55], v[56:59], v[136:139]
    v_mfma_f32_16x16x32_bf16 v[140:143], v[52:55], v[60:63], v[140:143]
    s_waitcnt lgkmcnt(7)
    v_mfma_f32_16x16x32_bf16 v[96:99], v[64:67], v[88:91], v[96:99]
    s_waitcnt lgkmcnt(5)
    v_mfma_f32_16x16x32_bf16 v[100:103], v[64:67], v[92:95], v[100:103]
    s_waitcnt lgkmcnt(0)
    s_barrier
    v_mfma_f32_16x16x32_bf16 v[104:107], v[68:71], v[88:91], v[104:107]
    ds_read_b64_tr_b16 v[56:57], v4 offset:32768
    v_mfma_f32_16x16x32_bf16 v[108:111], v[68:71], v[92:95], v[108:111]
    ds_read_b64_tr_b16 v[58:59], v4 offset:36864
    v_mfma_f32_16x16x32_bf16 v[112:115], v[72:75], v[88:91], v[112:115]
    ds_read_b128 v[32:35], v9 offset:0
    v_mfma_f32_16x16x32_bf16 v[116:119], v[72:75], v[92:95], v[116:119]
    ds_read_b64_tr_b16 v[60:61], v5 offset:32768
    v_mfma_f32_16x16x32_bf16 v[120:123], v[76:79], v[88:91], v[120:123]
    ds_read_b64_tr_b16 v[62:63], v5 offset:36864
    v_mfma_f32_16x16x32_bf16 v[124:127], v[76:79], v[92:95], v[124:127]
    ds_read_b128 v[36:39], v9 offset:1024
    v_mfma_f32_16x16x32_bf16 v[128:131], v[80:83], v[88:91], v[128:131]
    ds_read_b128 v[40:43], v9 offset:2048
    v_mfma_f32_16x16x32_bf16 v[132:135], v[80:83], v[92:95], v[132:135]
    ds_read_b128 v[44:47], v9 offset:3072
    v_mfma_f32_16x16x32_bf16 v[136:139], v[84:87], v[88:91], v[136:139]
    ds_read_b128 v[48:51], v9 offset:4096
    v_mfma_f32_16x16x32_bf16 v[140:143], v[84:87], v[92:95], v[140:143]
    ds_read_b128 v[52:55], v9 offset:5120
    s_waitcnt lgkmcnt(7)
    v_mfma_f32_16x16x32_bf16 v[96:99], v[32:35], v[56:59], v[96:99]
    ds_read_b64_tr_b16 v[88:89], v4 offset:40960
    s_waitcnt lgkmcnt(6)
    v_mfma_f32_16x16x32_bf16 v[100:103], v[32:35], v[60:63], v[100:103]
    ds_read_b64_tr_b16 v[90:91], v4 offset:45056
    s_waitcnt lgkmcnt(6)
    v_mfma_f32_16x16x32_bf16 v[104:107], v[36:39], v[56:59], v[104:107]
    ds_read_b128 v[64:67], v9 offset:6144
    v_mfma_f32_16x16x32_bf16 v[108:111], v[36:39], v[60:63], v[108:111]
    ds_read_b64_tr_b16 v[92:93], v5 offset:40960
    s_waitcnt lgkmcnt(7)
    v_mfma_f32_16x16x32_bf16 v[112:115], v[40:43], v[56:59], v[112:115]
    ds_read_b64_tr_b16 v[94:95], v5 offset:45056
    v_mfma_f32_16x16x32_bf16 v[116:119], v[40:43], v[60:63], v[116:119]
    ds_read_b128 v[68:71], v9 offset:7168
    s_waitcnt lgkmcnt(8)
    v_mfma_f32_16x16x32_bf16 v[120:123], v[44:47], v[56:59], v[120:123]
    ds_read_b128 v[72:75], v9 offset:8192
    v_mfma_f32_16x16x32_bf16 v[124:127], v[44:47], v[60:63], v[124:127]
    ds_read_b128 v[76:79], v9 offset:9216
    s_waitcnt lgkmcnt(9)
    v_mfma_f32_16x16x32_bf16 v[128:131], v[48:51], v[56:59], v[128:131]
    ds_read_b128 v[80:83], v9 offset:10240
    v_mfma_f32_16x16x32_bf16 v[132:135], v[48:51], v[60:63], v[132:135]
    ds_read_b128 v[84:87], v9 offset:11264
    s_waitcnt lgkmcnt(10)
    v_mfma_f32_16x16x32_bf16 v[136:139], v[52:55], v[56:59], v[136:139]
    v_mfma_f32_16x16x32_bf16 v[140:143], v[52:55], v[60:63], v[140:143]
    s_waitcnt lgkmcnt(7)
    v_mfma_f32_16x16x32_bf16 v[96:99], v[64:67], v[88:91], v[96:99]
    s_waitcnt lgkmcnt(5)
    v_mfma_f32_16x16x32_bf16 v[100:103], v[64:67], v[92:95], v[100:103]
    s_waitcnt lgkmcnt(0)
    s_barrier
    v_mfma_f32_16x16x32_bf16 v[104:107], v[68:71], v[88:91], v[104:107]
    ds_read_b64_tr_b16 v[56:57], v4 offset:49152
    v_mfma_f32_16x16x32_bf16 v[108:111], v[68:71], v[92:95], v[108:111]
    ds_read_b64_tr_b16 v[58:59], v4 offset:53248
    v_mfma_f32_16x16x32_bf16 v[112:115], v[72:75], v[88:91], v[112:115]
    ds_read_b128 v[32:35], v9 offset:12288
    v_mfma_f32_16x16x32_bf16 v[116:119], v[72:75], v[92:95], v[116:119]
    ds_read_b64_tr_b16 v[60:61], v5 offset:49152
    v_mfma_f32_16x16x32_bf16 v[120:123], v[76:79], v[88:91], v[120:123]
    ds_read_b64_tr_b16 v[62:63], v5 offset:53248
    v_mfma_f32_16x16x32_bf16 v[124:127], v[76:79], v[92:95], v[124:127]
    ds_read_b128 v[36:39], v9 offset:13312
    v_mfma_f32_16x16x32_bf16 v[128:131], v[80:83], v[88:91], v[128:131]
    ds_read_b128 v[40:43], v9 offset:14336
    v_mfma_f32_16x16x32_bf16 v[132:135], v[80:83], v[92:95], v[132:135]
    ds_read_b128 v[44:47], v9 offset:15360
    v_mfma_f32_16x16x32_bf16 v[136:139], v[84:87], v[88:91], v[136:139]
    ds_read_b128 v[48:51], v9 offset:16384
    v_mfma_f32_16x16x32_bf16 v[140:143], v[84:87], v[92:95], v[140:143]
    ds_read_b128 v[52:55], v9 offset:17408
    s_waitcnt lgkmcnt(7)
    v_mfma_f32_16x16x32_bf16 v[96:99], v[32:35], v[56:59], v[96:99]
    ds_read_b64_tr_b16 v[88:89], v4 offset:57344
    s_waitcnt lgkmcnt(6)
    v_mfma_f32_16x16x32_bf16 v[100:103], v[32:35], v[60:63], v[100:103]
    ds_read_b64_tr_b16 v[90:91], v4 offset:61440
    s_waitcnt lgkmcnt(6)
    v_mfma_f32_16x16x32_bf16 v[104:107], v[36:39], v[56:59], v[104:107]
    ds_read_b128 v[64:67], v9 offset:18432
    v_mfma_f32_16x16x32_bf16 v[108:111], v[36:39], v[60:63], v[108:111]
    ds_read_b64_tr_b16 v[92:93], v5 offset:57344
    s_waitcnt lgkmcnt(7)
    v_mfma_f32_16x16x32_bf16 v[112:115], v[40:43], v[56:59], v[112:115]
    ds_read_b64_tr_b16 v[94:95], v5 offset:61440
    v_mfma_f32_16x16x32_bf16 v[116:119], v[40:43], v[60:63], v[116:119]
    ds_read_b128 v[68:71], v9 offset:19456
    s_waitcnt lgkmcnt(8)
    v_mfma_f32_16x16x32_bf16 v[120:123], v[44:47], v[56:59], v[120:123]
    ds_read_b128 v[72:75], v9 offset:20480
    v_mfma_f32_16x16x32_bf16 v[124:127], v[44:47], v[60:63], v[124:127]
    ds_read_b128 v[76:79], v9 offset:21504
    s_waitcnt lgkmcnt(9)
    v_mfma_f32_16x16x32_bf16 v[128:131], v[48:51], v[56:59], v[128:131]
    ds_read_b128 v[80:83], v9 offset:22528
    v_mfma_f32_16x16x32_bf16 v[132:135], v[48:51], v[60:63], v[132:135]
    ds_read_b128 v[84:87], v9 offset:23552
    s_waitcnt lgkmcnt(10)
    v_mfma_f32_16x16x32_bf16 v[136:139], v[52:55], v[56:59], v[136:139]
    v_mfma_f32_16x16x32_bf16 v[140:143], v[52:55], v[60:63], v[140:143]
    s_waitcnt lgkmcnt(7)
    v_mfma_f32_16x16x32_bf16 v[96:99], v[64:67], v[88:91], v[96:99]
    s_waitcnt lgkmcnt(5)
    v_mfma_f32_16x16x32_bf16 v[100:103], v[64:67], v[92:95], v[100:103]
    s_waitcnt lgkmcnt(0)
    s_barrier
    v_mfma_f32_16x16x32_bf16 v[104:107], v[68:71], v[88:91], v[104:107]
    ds_read_b64_tr_b16 v[56:57], v4 offset:0
    v_mfma_f32_16x16x32_bf16 v[108:111], v[68:71], v[92:95], v[108:111]
    ds_read_b64_tr_b16 v[58:59], v4 offset:4096
    v_mfma_f32_16x16x32_bf16 v[112:115], v[72:75], v[88:91], v[112:115]
    ds_read_b128 v[32:35], v8 offset:0
    v_mfma_f32_16x16x32_bf16 v[116:119], v[72:75], v[92:95], v[116:119]
    ds_read_b64_tr_b16 v[60:61], v5 offset:0
    v_mfma_f32_16x16x32_bf16 v[120:123], v[76:79], v[88:91], v[120:123]
    ds_read_b64_tr_b16 v[62:63], v5 offset:4096
    v_mfma_f32_16x16x32_bf16 v[124:127], v[76:79], v[92:95], v[124:127]
    ds_read_b128 v[36:39], v8 offset:1024
    v_mfma_f32_16x16x32_bf16 v[128:131], v[80:83], v[88:91], v[128:131]
    ds_read_b128 v[40:43], v8 offset:2048
    v_mfma_f32_16x16x32_bf16 v[132:135], v[80:83], v[92:95], v[132:135]
    ds_read_b128 v[44:47], v8 offset:3072
    v_mfma_f32_16x16x32_bf16 v[136:139], v[84:87], v[88:91], v[136:139]
    ds_read_b128 v[48:51], v8 offset:4096
    v_mfma_f32_16x16x32_bf16 v[140:143], v[84:87], v[92:95], v[140:143]
    ds_read_b128 v[52:55], v8 offset:5120
    s_sub_u32 s31, s31, 1
    s_cmp_lg_u32 s31, 0
    s_cbranch_scc1 K5_CLOOP
    s_waitcnt lgkmcnt(7)
    v_mfma_f32_16x16x32_bf16 v[96:99], v[32:35], v[56:59], v[96:99]
    ds_read_b64_tr_b16 v[88:89], v4 offset:8192
    s_waitcnt lgkmcnt(6)
    v_mfma_f32_16x16x32_bf16 v[100:103], v[32:35], v[60:63], v[100:103]
    ds_read_b64_tr_b16 v[90:91], v4 offset:12288
    s_waitcnt lgkmcnt(6)
    v_mfma_f32_16x16x32_bf16 v[104:107], v[36:39], v[56:59], v[104:107]
    ds_read_b128 v[64:67], v8 offset:6144
    v_mfma_f32_16x16x32_bf16 v[108:111], v[36:39], v[60:63], v[108:111]
    ds_read_b64_tr_b16 v[92:93], v5 offset:8192
    s_waitcnt lgkmcnt(7)
    v_mfma_f32_16x16x32_bf16 v[112:115], v[40:43], v[56:59], v[112:115]
    ds_read_b64_tr_b16 v[94:95], v5 offset:12288
    v_mfma_f32_16x16x32_bf16 v[116:119], v[40:43], v[60:63], v[116:119]
    ds_read_b128 v[68:71], v8 offset:7168
    s_waitcnt lgkmcnt(8)
    v_mfma_f32_16x16x32_bf16 v[120:123], v[44:47], v[56:59], v[120:123]
    ds_read_b128 v[72:75], v8 offset:8192
    v_mfma_f32_16x16x32_bf16 v[124:127], v[44:47], v[60:63], v[124:127]
    ds_read_b128 v[76:79], v8 offset:9216
    s_waitcnt lgkmcnt(9)
    v_mfma_f32_16x16x32_bf16 v[128:131], v[48:51], v[56:59], v[128:131]
    ds_read_b128 v[80:83], v8 offset:10240
    v_mfma_f32_16x16x32_bf16 v[132:135], v[48:51], v[60:63], v[132:135]
    ds_read_b128 v[84:87], v8 offset:11264
    s_waitcnt lgkmcnt(10)
    v_mfma_f32_16x16x32_bf16 v[136:139], v[52:55], v[56:59], v[136:139]
    v_mfma_f32_16x16x32_bf16 v[140:143], v[52:55], v[60:63], v[140:143]
    s_waitcnt lgkmcnt(7)
    v_mfma_f32_16x16x32_bf16 v[96:99], v[64:67], v[88:91], v[96:99]
    s_waitcnt lgkmcnt(5)
    v_mfma_f32_16x16x32_bf16 v[100:103], v[64:67], v[92:95], v[100:103]
    s_waitcnt lgkmcnt(0)
    s_barrier
    v_mfma_f32_16x16x32_bf16 v[104:107], v[68:71], v[88:91], v[104:107]
    ds_read_b64_tr_b16 v[56:57], v4 offset:16384
    v_mfma_f32_16x16x32_bf16 v[108:111], v[68:71], v[92:95], v[108:111]
    ds_read_b64_tr_b16 v[58:59], v4 offset:20480
    v_mfma_f32_16x16x32_bf16 v[112:115], v[72:75], v[88:91], v[112:115]
    ds_read_b128 v[32:35], v8 offset:12288
    v_mfma_f32_16x16x32_bf16 v[116:119], v[72:75], v[92:95], v[116:119]
    ds_read_b64_tr_b16 v[60:61], v5 offset:16384
    v_mfma_f32_16x16x32_bf16 v[120:123], v[76:79], v[88:91], v[120:123]
    ds_read_b64_tr_b16 v[62:63], v5 offset:20480
    v_mfma_f32_16x16x32_bf16 v[124:127], v[76:79], v[92:95], v[124:127]
    ds_read_b128 v[36:39], v8 offset:13312
    v_mfma_f32_16x16x32_bf16 v[128:131], v[80:83], v[88:91], v[128:131]
    ds_read_b128 v[40:43], v8 offset:14336
    v_mfma_f32_16x16x32_bf16 v[132:135], v[80:83], v[92:95], v[132:135]
    ds_read_b128 v[44:47], v8 offset:15360
    v_mfma_f32_16x16x32_bf16 v[136:139], v[84:87], v[88:91], v[136:139]
    ds_read_b128 v[48:51], v8 offset:16384
    v_mfma_f32_16x16x32_bf16 v[140:143], v[84:87], v[92:95], v[140:143]
    ds_read_b128 v[52:55], v8 offset:17408
    s_waitcnt lgkmcnt(7)
    v_mfma_f32_16x16x32_bf16 v[96:99], v[32:35], v[56:59], v[96:99]
    ds_read_b64_tr_b16 v[88:89], v4 offset:24576
    s_waitcnt lgkmcnt(6)
    v_mfma_f32_16x16x32_bf16 v[100:103], v[32:35], v[60:63], v[100:103]
    ds_read_b64_tr_b16 v[90:91], v4 offset:28672
    s_waitcnt lgkmcnt(6)
    v_mfma_f32_16x16x32_bf16 v[104:107], v[36:39], v[56:59], v[104:107]
    ds_read_b128 v[64:67], v8 offset:18432
    v_mfma_f32_16x16x32_bf16 v[108:111], v[36:39], v[60:63], v[108:111]
    ds_read_b64_tr_b16 v[92:93], v5 offset:24576
    s_waitcnt lgkmcnt(7)
    v_mfma_f32_16x16x32_bf16 v[112:115], v[40:43], v[56:59], v[112:115]
    ds_read_b64_tr_b16 v[94:95], v5 offset:28672
    v_mfma_f32_16x16x32_bf16 v[116:119], v[40:43], v[60:63], v[116:119]
    ds_read_b128 v[68:71], v8 offset:19456
    s_waitcnt lgkmcnt(8)
    v_mfma_f32_16x16x32_bf16 v[120:123], v[44:47], v[56:59], v[120:123]
    ds_read_b128 v[72:75], v8 offset:20480
    v_mfma_f32_16x16x32_bf16 v[124:127], v[44:47], v[60:63], v[124:127]
    ds_read_b128 v[76:79], v8 offset:21504
    s_waitcnt lgkmcnt(9)
    v_mfma_f32_16x16x32_bf16 v[128:131], v[48:51], v[56:59], v[128:131]
    ds_read_b128 v[80:83], v8 offset:22528
    v_mfma_f32_16x16x32_bf16 v[132:135], v[48:51], v[60:63], v[132:135]
    ds_read_b128 v[84:87], v8 offset:23552
    s_waitcnt lgkmcnt(10)
    v_mfma_f32_16x16x32_bf16 v[136:139], v[52:55], v[56:59], v[136:139]
    v_mfma_f32_16x16x32_bf16 v[140:143], v[52:55], v[60:63], v[140:143]
    s_waitcnt lgkmcnt(7)
    v_mfma_f32_16x16x32_bf16 v[96:99], v[64:67], v[88:91], v[96:99]
    s_waitcnt lgkmcnt(5)
    v_mfma_f32_16x16x32_bf16 v[100:103], v[64:67], v[92:95], v[100:103]
    s_waitcnt lgkmcnt(0)
    s_barrier
    v_mfma_f32_16x16x32_bf16 v[104:107], v[68:71], v[88:91], v[104:107]
    ds_read_b64_tr_b16 v[56:57], v4 offset:32768
    v_mfma_f32_16x16x32_bf16 v[108:111], v[68:71], v[92:95], v[108:111]
    ds_read_b64_tr_b16 v[58:59], v4 offset:36864
    v_mfma_f32_16x16x32_bf16 v[112:115], v[72:75], v[88:91], v[112:115]
    ds_read_b128 v[32:35], v9 offset:0
    v_mfma_f32_16x16x32_bf16 v[116:119], v[72:75], v[92:95], v[116:119]
    ds_read_b64_tr_b16 v[60:61], v5 offset:32768
    v_mfma_f32_16x16x32_bf16 v[120:123], v[76:79], v[88:91], v[120:123]
    ds_read_b64_tr_b16 v[62:63], v5 offset:36864
    v_mfma_f32_16x16x32_bf16 v[124:127], v[76:79], v[92:95], v[124:127]
    ds_read_b128 v[36:39], v9 offset:1024
    v_mfma_f32_16x16x32_bf16 v[128:131], v[80:83], v[88:91], v[128:131]
    ds_read_b128 v[40:43], v9 offset:2048
    v_mfma_f32_16x16x32_bf16 v[132:135], v[80:83], v[92:95], v[132:135]
    ds_read_b128 v[44:47], v9 offset:3072
    v_mfma_f32_16x16x32_bf16 v[136:139], v[84:87], v[88:91], v[136:139]
    ds_read_b128 v[48:51], v9 offset:4096
    v_mfma_f32_16x16x32_bf16 v[140:143], v[84:87], v[92:95], v[140:143]
    ds_read_b128 v[52:55], v9 offset:5120
    s_waitcnt lgkmcnt(7)
    v_mfma_f32_16x16x32_bf16 v[96:99], v[32:35], v[56:59], v[96:99]
    ds_read_b64_tr_b16 v[88:89], v4 offset:40960
    s_waitcnt lgkmcnt(6)
    v_mfma_f32_16x16x32_bf16 v[100:103], v[32:35], v[60:63], v[100:103]
    ds_read_b64_tr_b16 v[90:91], v4 offset:45056
    s_waitcnt lgkmcnt(6)
    v_mfma_f32_16x16x32_bf16 v[104:107], v[36:39], v[56:59], v[104:107]
    ds_read_b128 v[64:67], v9 offset:6144
    v_mfma_f32_16x16x32_bf16 v[108:111], v[36:39], v[60:63], v[108:111]
    ds_read_b64_tr_b16 v[92:93], v5 offset:40960
    s_waitcnt lgkmcnt(7)
    v_mfma_f32_16x16x32_bf16 v[112:115], v[40:43], v[56:59], v[112:115]
    ds_read_b64_tr_b16 v[94:95], v5 offset:45056
    v_mfma_f32_16x16x32_bf16 v[116:119], v[40:43], v[60:63], v[116:119]
    ds_read_b128 v[68:71], v9 offset:7168
    s_waitcnt lgkmcnt(8)
    v_mfma_f32_16x16x32_bf16 v[120:123], v[44:47], v[56:59], v[120:123]
    ds_read_b128 v[72:75], v9 offset:8192
    v_mfma_f32_16x16x32_bf16 v[124:127], v[44:47], v[60:63], v[124:127]
    ds_read_b128 v[76:79], v9 offset:9216
    s_waitcnt lgkmcnt(9)
    v_mfma_f32_16x16x32_bf16 v[128:131], v[48:51], v[56:59], v[128:131]
    ds_read_b128 v[80:83], v9 offset:10240
    v_mfma_f32_16x16x32_bf16 v[132:135], v[48:51], v[60:63], v[132:135]
    ds_read_b128 v[84:87], v9 offset:11264
    s_waitcnt lgkmcnt(10)
    v_mfma_f32_16x16x32_bf16 v[136:139], v[52:55], v[56:59], v[136:139]
    v_mfma_f32_16x16x32_bf16 v[140:143], v[52:55], v[60:63], v[140:143]
    s_waitcnt lgkmcnt(7)
    v_mfma_f32_16x16x32_bf16 v[96:99], v[64:67], v[88:91], v[96:99]
    s_waitcnt lgkmcnt(5)
    v_mfma_f32_16x16x32_bf16 v[100:103], v[64:67], v[92:95], v[100:103]
    s_waitcnt lgkmcnt(0)
    s_barrier
    v_mfma_f32_16x16x32_bf16 v[104:107], v[68:71], v[88:91], v[104:107]
    ds_read_b64_tr_b16 v[56:57], v4 offset:49152
    v_mfma_f32_16x16x32_bf16 v[108:111], v[68:71], v[92:95], v[108:111]
    ds_read_b64_tr_b16 v[58:59], v4 offset:53248
    v_mfma_f32_16x16x32_bf16 v[112:115], v[72:75], v[88:91], v[112:115]
    ds_read_b128 v[32:35], v9 offset:12288
    v_mfma_f32_16x16x32_bf16 v[116:119], v[72:75], v[92:95], v[116:119]
    ds_read_b64_tr_b16 v[60:61], v5 offset:49152
    v_mfma_f32_16x16x32_bf16 v[120:123], v[76:79], v[88:91], v[120:123]
    ds_read_b64_tr_b16 v[62:63], v5 offset:53248
    v_mfma_f32_16x16x32_bf16 v[124:127], v[76:79], v[92:95], v[124:127]
    ds_read_b128 v[36:39], v9 offset:13312
    v_mfma_f32_16x16x32_bf16 v[128:131], v[80:83], v[88:91], v[128:131]
    ds_read_b128 v[40:43], v9 offset:14336
    v_mfma_f32_16x16x32_bf16 v[132:135], v[80:83], v[92:95], v[132:135]
    ds_read_b128 v[44:47], v9 offset:15360
    v_mfma_f32_16x16x32_bf16 v[136:139], v[84:87], v[88:91], v[136:139]
    ds_read_b128 v[48:51], v9 offset:16384
    v_mfma_f32_16x16x32_bf16 v[140:143], v[84:87], v[92:95], v[140:143]
    ds_read_b128 v[52:55], v9 offset:17408
    s_waitcnt lgkmcnt(7)
    v_mfma_f32_16x16x32_bf16 v[96:99], v[32:35], v[56:59], v[96:99]
    ds_read_b64_tr_b16 v[88:89], v4 offset:57344
    s_waitcnt lgkmcnt(6)
    v_mfma_f32_16x16x32_bf16 v[100:103], v[32:35], v[60:63], v[100:103]
    ds_read_b64_tr_b16 v[90:91], v4 offset:61440
    s_waitcnt lgkmcnt(6)
    v_mfma_f32_16x16x32_bf16 v[104:107], v[36:39], v[56:59], v[104:107]
    ds_read_b128 v[64:67], v9 offset:18432
    v_mfma_f32_16x16x32_bf16 v[108:111], v[36:39], v[60:63], v[108:111]
    ds_read_b64_tr_b16 v[92:93], v5 offset:57344
    s_waitcnt lgkmcnt(7)
    v_mfma_f32_16x16x32_bf16 v[112:115], v[40:43], v[56:59], v[112:115]
    ds_read_b64_tr_b16 v[94:95], v5 offset:61440
    v_mfma_f32_16x16x32_bf16 v[116:119], v[40:43], v[60:63], v[116:119]
    ds_read_b128 v[68:71], v9 offset:19456
    s_waitcnt lgkmcnt(8)
    v_mfma_f32_16x16x32_bf16 v[120:123], v[44:47], v[56:59], v[120:123]
    ds_read_b128 v[72:75], v9 offset:20480
    v_mfma_f32_16x16x32_bf16 v[124:127], v[44:47], v[60:63], v[124:127]
    ds_read_b128 v[76:79], v9 offset:21504
    s_waitcnt lgkmcnt(9)
    v_mfma_f32_16x16x32_bf16 v[128:131], v[48:51], v[56:59], v[128:131]
    ds_read_b128 v[80:83], v9 offset:22528
    v_mfma_f32_16x16x32_bf16 v[132:135], v[48:51], v[60:63], v[132:135]
    ds_read_b128 v[84:87], v9 offset:23552
    s_waitcnt lgkmcnt(10)
    v_mfma_f32_16x16x32_bf16 v[136:139], v[52:55], v[56:59], v[136:139]
    v_mfma_f32_16x16x32_bf16 v[140:143], v[52:55], v[60:63], v[140:143]
    s_waitcnt lgkmcnt(7)
    v_mfma_f32_16x16x32_bf16 v[96:99], v[64:67], v[88:91], v[96:99]
    s_waitcnt lgkmcnt(5)
    v_mfma_f32_16x16x32_bf16 v[100:103], v[64:67], v[92:95], v[100:103]
    s_waitcnt lgkmcnt(0)
    s_barrier
    v_mfma_f32_16x16x32_bf16 v[104:107], v[68:71], v[88:91], v[104:107]
    ds_read_b64_tr_b16 v[56:57], v6 offset:0
    v_mfma_f32_16x16x32_bf16 v[108:111], v[68:71], v[92:95], v[108:111]
    ds_read_b64_tr_b16 v[58:59], v6 offset:2048
    v_mfma_f32_16x16x32_bf16 v[112:115], v[72:75], v[88:91], v[112:115]
    ds_read_b128 v[32:35], v8 offset:0
    v_mfma_f32_16x16x32_bf16 v[116:119], v[72:75], v[92:95], v[116:119]
    ds_read_b128 v[36:39], v8 offset:1024
    v_mfma_f32_16x16x32_bf16 v[120:123], v[76:79], v[88:91], v[120:123]
    ds_read_b128 v[40:43], v8 offset:2048
    v_mfma_f32_16x16x32_bf16 v[124:127], v[76:79], v[92:95], v[124:127]
    ds_read_b128 v[44:47], v8 offset:3072
    v_mfma_f32_16x16x32_bf16 v[128:131], v[80:83], v[88:91], v[128:131]
    ds_read_b128 v[48:51], v8 offset:4096
    v_mfma_f32_16x16x32_bf16 v[132:135], v[80:83], v[92:95], v[132:135]
    ds_read_b128 v[52:55], v8 offset:5120
    v_mfma_f32_16x16x32_bf16 v[136:139], v[84:87], v[88:91], v[136:139]
    v_mfma_f32_16x16x32_bf16 v[140:143], v[84:87], v[92:95], v[140:143]
    s_cmp_lg_u32 s24, 0
    s_cbranch_scc1 K5_X1
    s_nop 7
    s_nop 7
    s_add_u32 s31, s30, 0
    buffer_store_dwordx4 v[100:103], v10, s[12:15], s31 offen offset:2048 sc1
    s_add_u32 s31, s31, 4096
    buffer_store_dwordx4 v[108:111], v10, s[12:15], s31 offen offset:2048 sc1
    s_add_u32 s31, s31, 4096
    buffer_store_dwordx4 v[116:119], v10, s[12:15], s31 offen offset:2048 sc1
    s_add_u32 s31, s31, 4096
    buffer_store_dwordx4 v[124:127], v10, s[12:15], s31 offen offset:2048 sc1
    s_add_u32 s31, s31, 4096
    buffer_store_dwordx4 v[132:135], v10, s[12:15], s31 offen offset:2048 sc1
    s_add_u32 s31, s31, 4096
    buffer_store_dwordx4 v[140:143], v10, s[12:15], s31 offen offset:2048 sc1
    s_mov_b32 s37, 0
    s_waitcnt lgkmcnt(5)
    v_mfma_f32_16x16x32_bf16 v[96:99], v[32:35], v[56:59], v[96:99]
    ds_read_b64_tr_b16 v[88:89], v6 offset:4096
    ds_read_b64_tr_b16 v[90:91], v6 offset:6144
    ds_read_b128 v[64:67], v8 offset:6144
    s_waitcnt lgkmcnt(7)
    v_mfma_f32_16x16x32_bf16 v[104:107], v[36:39], v[56:59], v[104:107]
    ds_read_b128 v[68:71], v8 offset:7168
    s_waitcnt lgkmcnt(7)
    v_mfma_f32_16x16x32_bf16 v[112:115], v[40:43], v[56:59], v[112:115]
    ds_read_b128 v[72:75], v8 offset:8192
    s_waitcnt lgkmcnt(7)
    v_mfma_f32_16x16x32_bf16 v[120:123], v[44:47], v[56:59], v[120:123]
    ds_read_b128 v[76:79], v8 offset:9216
    s_waitcnt lgkmcnt(7)
    v_mfma_f32_16x16x32_bf16 v[128:131], v[48:51], v[56:59], v[128:131]
    ds_read_b128 v[80:83], v8 offset:10240
    s_waitcnt lgkmcnt(7)
    v_mfma_f32_16x16x32_bf16 v[136:139], v[52:55], v[56:59], v[136:139]
    ds_read_b128 v[84:87], v8 offset:11264
    s_waitcnt lgkmcnt(5)
    v_mfma_f32_16x16x32_bf16 v[96:99], v[64:67], v[88:91], v[96:99]
    s_waitcnt lgkmcnt(0)
    s_barrier
    v_mfma_f32_16x16x32_bf16 v[104:107], v[68:71], v[88:91], v[104:107]
    ds_read_b64_tr_b16 v[56:57], v6 offset:16384
    ds_read_b64_tr_b16 v[58:59], v6 offset:18432
    ds_read_b128 v[32:35], v8 offset:12288
    ds_read_b128 v[36:39], v8 offset:13312
    v_mfma_f32_16x16x32_bf16 v[112:115], v[72:75], v[88:91], v[112:115]
    ds_read_b128 v[40:43], v8 offset:14336
    v_mfma_f32_16x16x32_bf16 v[120:123], v[76:79], v[88:91], v[120:123]
    ds_read_b128 v[44:47], v8 offset:15360
    v_mfma_f32_16x16x32_bf16 v[128:131], v[80:83], v[88:91], v[128:131]
    ds_read_b128 v[48:51], v8 offset:16384
    v_mfma_f32_16x16x32_bf16 v[136:139], v[84:87], v[88:91], v[136:139]
    ds_read_b128 v[52:55], v8 offset:17408
    s_waitcnt lgkmcnt(5)
    v_mfma_f32_16x16x32_bf16 v[96:99], v[32:35], v[56:59], v[96:99]
    ds_read_b64_tr_b16 v[88:89], v6 offset:20480
    ds_read_b64_tr_b16 v[90:91], v6 offset:22528
    ds_read_b128 v[64:67], v8 offset:18432
    s_waitcnt lgkmcnt(7)
    v_mfma_f32_16x16x32_bf16 v[104:107], v[36:39], v[56:59], v[104:107]
    ds_read_b128 v[68:71], v8 offset:19456
    s_waitcnt lgkmcnt(7)
    v_mfma_f32_16x16x32_bf16 v[112:115], v[40:43], v[56:59], v[112:115]
    ds_read_b128 v[72:75], v8 offset:20480
    s_waitcnt lgkmcnt(7)
    v_mfma_f32_16x16x32_bf16 v[120:123], v[44:47], v[56:59], v[120:123]
    ds_read_b128 v[76:79], v8 offset:21504
    s_waitcnt lgkmcnt(7)
    v_mfma_f32_16x16x32_bf16 v[128:131], v[48:51], v[56:59], v[128:131]
    ds_read_b128 v[80:83], v8 offset:22528
    s_waitcnt lgkmcnt(7)
    v_mfma_f32_16x16x32_bf16 v[136:139], v[52:55], v[56:59], v[136:139]
    ds_read_b128 v[84:87], v8 offset:23552
    s_waitcnt lgkmcnt(5)
    v_mfma_f32_16x16x32_bf16 v[96:99], v[64:67], v[88:91], v[96:99]
    s_waitcnt lgkmcnt(0)
    s_barrier
    v_mfma_f32_16x16x32_bf16 v[104:107], v[68:71], v[88:91], v[104:107]
    ds_read_b64_tr_b16 v[56:57], v6 offset:32768
    ds_read_b64_tr_b16 v[58:59], v6 offset:34816
    ds_read_b128 v[32:35], v9 offset:0
    ds_read_b128 v[36:39], v9 offset:1024
    v_mfma_f32_16x16x32_bf16 v[112:115], v[72:75], v[88:91], v[112:115]
    ds_read_b128 v[40:43], v9 offset:2048
    v_mfma_f32_16x16x32_bf16 v[120:123], v[76:79], v[88:91], v[120:123]
    ds_read_b128 v[44:47], v9 offset:3072
    v_mfma_f32_16x16x32_bf16 v[128:131], v[80:83], v[88:91], v[128:131]
    ds_read_b128 v[48:51], v9 offset:4096
    v_mfma_f32_16x16x32_bf16 v[136:139], v[84:87], v[88:91], v[136:139]
    ds_read_b128 v[52:55], v9 offset:5120
    s_waitcnt lgkmcnt(5)
    v_mfma_f32_16x16x32_bf16 v[96:99], v[32:35], v[56:59], v[96:99]
    ds_read_b64_tr_b16 v[88:89], v6 offset:36864
    ds_read_b64_tr_b16 v[90:91], v6 offset:38912
    ds_read_b128 v[64:67], v9 offset:6144
    s_waitcnt lgkmcnt(7)
    v_mfma_f32_16x16x32_bf16 v[104:107], v[36:39], v[56:59], v[104:107]
    ds_read_b128 v[68:71], v9 offset:7168
    s_waitcnt lgkmcnt(7)
    v_mfma_f32_16x16x32_bf16 v[112:115], v[40:43], v[56:59], v[112:115]
    ds_read_b128 v[72:75], v9 offset:8192
    s_waitcnt lgkmcnt(7)
    v_mfma_f32_16x16x32_bf16 v[120:123], v[44:47], v[56:59], v[120:123]
    ds_read_b128 v[76:79], v9 offset:9216
    s_waitcnt lgkmcnt(7)
    v_mfma_f32_16x16x32_bf16 v[128:131], v[48:51], v[56:59], v[128:131]
    ds_read_b128 v[80:83], v9 offset:10240
    s_waitcnt lgkmcnt(7)
    v_mfma_f32_16x16x32_bf16 v[136:139], v[52:55], v[56:59], v[136:139]
    ds_read_b128 v[84:87], v9 offset:11264
    s_waitcnt lgkmcnt(5)
    v_mfma_f32_16x16x32_bf16 v[96:99], v[64:67], v[88:91], v[96:99]
    s_waitcnt lgkmcnt(0)
    s_barrier
    v_mfma_f32_16x16x32_bf16 v[104:107], v[68:71], v[88:91], v[104:107]
    ds_read_b64_tr_b16 v[56:57], v6 offset:49152
    ds_read_b64_tr_b16 v[58:59], v6 offset:51200
    ds_read_b128 v[32:35], v9 offset:12288
    ds_read_b128 v[36:39], v9 offset:13312
    v_mfma_f32_16x16x32_bf16 v[112:115], v[72:75], v[88:91], v[112:115]
    ds_read_b128 v[40:43], v9 offset:14336
    v_mfma_f32_16x16x32_bf16 v[120:123], v[76:79], v[88:91], v[120:123]
    ds_read_b128 v[44:47], v9 offset:15360
    v_mfma_f32_16x16x32_bf16 v[128:131], v[80:83], v[88:91], v[128:131]
    ds_read_b128 v[48:51], v9 offset:16384
    v_mfma_f32_16x16x32_bf16 v[136:139], v[84:87], v[88:91], v[136:139]
    ds_read_b128 v[52:55], v9 offset:17408
    s_waitcnt vmcnt(0)
    v_mov_b32 v13, 1
    s_add_u32 s31, s34, 0
    s_mov_b64 exec, 1
    buffer_store_dword v13, v14, s[12:15], s31 offen sc1
    s_mov_b64 exec, -1
    v_lshlrev_b32 v168, 16, v168
    v_lshlrev_b32 v144, 16, v144
    v_lshlrev_b32 v145, 16, v145
    v_lshlrev_b32 v146, 16, v146
    v_lshlrev_b32 v147, 16, v147
    v_lshlrev_b32 v148, 16, v148
    v_lshlrev_b32 v149, 16, v149
    v_lshlrev_b32 v150, 16, v150
    v_lshlrev_b32 v151, 16, v151
    v_lshlrev_b32 v152, 16, v152
    v_lshlrev_b32 v153, 16, v153
    v_lshlrev_b32 v154, 16, v154
    v_lshlrev_b32 v155, 16, v155
    v_lshlrev_b32 v156, 16, v156
    v_lshlrev_b32 v157, 16, v157
    v_lshlrev_b32 v158, 16, v158
    v_lshlrev_b32 v159, 16, v159
    v_lshlrev_b32 v160, 16, v160
    v_lshlrev_b32 v161, 16, v161
    v_lshlrev_b32 v162, 16, v162
    v_lshlrev_b32 v163, 16, v163
    v_lshlrev_b32 v164, 16, v164
    v_lshlrev_b32 v165, 16, v165
    v_lshlrev_b32 v166, 16, v166
    v_lshlrev_b32 v167, 16, v167
    v_add_f32 v144, v144, v168
    v_add_f32 v145, v145, v168
    v_add_f32 v146, v146, v168
    v_add_f32 v147, v147, v168
    v_add_f32 v148, v148, v168
    v_add_f32 v149, v149, v168
    v_add_f32 v150, v150, v168
    v_add_f32 v151, v151, v168
    v_add_f32 v152, v152, v168
    v_add_f32 v153, v153, v168
    v_add_f32 v154, v154, v168
    v_add_f32 v155, v155, v168
    v_add_f32 v156, v156, v168
    v_add_f32 v157, v157, v168
    v_add_f32 v158, v158, v168
    v_add_f32 v159, v159, v168
    v_add_f32 v160, v160, v168
    v_add_f32 v161, v161, v168
    v_add_f32 v162, v162, v168
    v_add_f32 v163, v163, v168
    v_add_f32 v164, v164, v168
    v_add_f32 v165, v165, v168
    v_add_f32 v166, v166, v168
    v_add_f32 v167, v167, v168
    s_waitcnt lgkmcnt(5)
    v_mfma_f32_16x16x32_bf16 v[96:99], v[32:35], v[56:59], v[96:99]
    ds_read_b64_tr_b16 v[88:89], v6 offset:53248
    ds_read_b64_tr_b16 v[90:91], v6 offset:55296
    ds_read_b128 v[64:67], v9 offset:18432
    s_waitcnt lgkmcnt(7)
    v_mfma_f32_16x16x32_bf16 v[104:107], v[36:39], v[56:59], v[104:107]
    ds_read_b128 v[68:71], v9 offset:19456
    s_waitcnt lgkmcnt(7)
    v_mfma_f32_16x16x32_bf16 v[112:115], v[40:43], v[56:59], v[112:115]
    ds_read_b128 v[72:75], v9 offset:20480
    s_waitcnt lgkmcnt(7)
    v_mfma_f32_16x16x32_bf16 v[120:123], v[44:47], v[56:59], v[120:123]
    ds_read_b128 v[76:79], v9 offset:21504
    s_waitcnt lgkmcnt(7)
    v_mfma_f32_16x16x32_bf16 v[128:131], v[48:51], v[56:59], v[128:131]
    ds_read_b128 v[80:83], v9 offset:22528
    s_waitcnt lgkmcnt(7)
    v_mfma_f32_16x16x32_bf16 v[136:139], v[52:55], v[56:59], v[136:139]
    ds_read_b128 v[84:87], v9 offset:23552
    s_waitcnt lgkmcnt(5)
    v_mfma_f32_16x16x32_bf16 v[96:99], v[64:67], v[88:91], v[96:99]
    s_waitcnt lgkmcnt(0)
    s_barrier
    v_mfma_f32_16x16x32_bf16 v[104:107], v[68:71], v[88:91], v[104:107]
    ds_read_b64_tr_b16 v[56:57], v6 offset:0
    ds_read_b64_tr_b16 v[58:59], v6 offset:2048
    ds_read_b128 v[32:35], v8 offset:0
    ds_read_b128 v[36:39], v8 offset:1024
    v_mfma_f32_16x16x32_bf16 v[112:115], v[72:75], v[88:91], v[112:115]
    ds_read_b128 v[40:43], v8 offset:2048
    v_mfma_f32_16x16x32_bf16 v[120:123], v[76:79], v[88:91], v[120:123]
    ds_read_b128 v[44:47], v8 offset:3072
    v_mfma_f32_16x16x32_bf16 v[128:131], v[80:83], v[88:91], v[128:131]
    ds_read_b128 v[48:51], v8 offset:4096
    v_mfma_f32_16x16x32_bf16 v[136:139], v[84:87], v[88:91], v[136:139]
    ds_read_b128 v[52:55], v8 offset:5120
    s_waitcnt lgkmcnt(5)
    v_mfma_f32_16x16x32_bf16 v[96:99], v[32:35], v[56:59], v[96:99]
    ds_read_b64_tr_b16 v[88:89], v6 offset:4096
    ds_read_b64_tr_b16 v[90:91], v6 offset:6144
    ds_read_b128 v[64:67], v8 offset:6144
    s_waitcnt lgkmcnt(7)
    v_mfma_f32_16x16x32_bf16 v[104:107], v[36:39], v[56:59], v[104:107]
    ds_read_b128 v[68:71], v8 offset:7168
    s_waitcnt lgkmcnt(7)
    v_mfma_f32_16x16x32_bf16 v[112:115], v[40:43], v[56:59], v[112:115]
    ds_read_b128 v[72:75], v8 offset:8192
    s_waitcnt lgkmcnt(7)
    v_mfma_f32_16x16x32_bf16 v[120:123], v[44:47], v[56:59], v[120:123]
    ds_read_b128 v[76:79], v8 offset:9216
    s_waitcnt lgkmcnt(7)
    v_mfma_f32_16x16x32_bf16 v[128:131], v[48:51], v[56:59], v[128:131]
    ds_read_b128 v[80:83], v8 offset:10240
    s_waitcnt lgkmcnt(7)
    v_mfma_f32_16x16x32_bf16 v[136:139], v[52:55], v[56:59], v[136:139]
    ds_read_b128 v[84:87], v8 offset:11264
    s_waitcnt lgkmcnt(5)
    v_mfma_f32_16x16x32_bf16 v[96:99], v[64:67], v[88:91], v[96:99]
    s_waitcnt lgkmcnt(0)
    s_barrier
    v_mfma_f32_16x16x32_bf16 v[104:107], v[68:71], v[88:91], v[104:107]
    ds_read_b64_tr_b16 v[56:57], v6 offset:16384
    ds_read_b64_tr_b16 v[58:59], v6 offset:18432
    ds_read_b128 v[32:35], v8 offset:12288
    ds_read_b128 v[36:39], v8 offset:13312
    v_mfma_f32_16x16x32_bf16 v[112:115], v[72:75], v[88:91], v[112:115]
    ds_read_b128 v[40:43], v8 offset:14336
    v_mfma_f32_16x16x32_bf16 v[120:123], v[76:79], v[88:91], v[120:123]
    ds_read_b128 v[44:47], v8 offset:15360
    v_mfma_f32_16x16x32_bf16 v[128:131], v[80:83], v[88:91], v[128:131]
    ds_read_b128 v[48:51], v8 offset:16384
    v_mfma_f32_16x16x32_bf16 v[136:139], v[84:87], v[88:91], v[136:139]
    ds_read_b128 v[52:55], v8 offset:17408
    s_mov_b64 exec, 3
    buffer_load_dword v16, v12, s[12:15], s34 offen sc1
    s_mov_b64 exec, -1
    s_waitcnt lgkmcnt(5)
    v_mfma_f32_16x16x32_bf16 v[96:99], v[32:35], v[56:59], v[96:99]
    ds_read_b64_tr_b16 v[88:89], v6 offset:20480
    ds_read_b64_tr_b16 v[90:91], v6 offset:22528
    ds_read_b128 v[64:67], v8 offset:18432
    s_waitcnt lgkmcnt(7)
    v_mfma_f32_16x16x32_bf16 v[104:107], v[36:39], v[56:59], v[104:107]
    ds_read_b128 v[68:71], v8 offset:19456
    s_waitcnt lgkmcnt(7)
    v_mfma_f32_16x16x32_bf16 v[112:115], v[40:43], v[56:59], v[112:115]
    ds_read_b128 v[72:75], v8 offset:20480
    s_waitcnt lgkmcnt(7)
    v_mfma_f32_16x16x32_bf16 v[120:123], v[44:47], v[56:59], v[120:123]
    ds_read_b128 v[76:79], v8 offset:21504
    s_waitcnt lgkmcnt(7)
    v_mfma_f32_16x16x32_bf16 v[128:131], v[48:51], v[56:59], v[128:131]
    ds_read_b128 v[80:83], v8 offset:22528
    s_waitcnt lgkmcnt(7)
    v_mfma_f32_16x16x32_bf16 v[136:139], v[52:55], v[56:59], v[136:139]
    ds_read_b128 v[84:87], v8 offset:23552
    s_waitcnt lgkmcnt(5)
    v_mfma_f32_16x16x32_bf16 v[96:99], v[64:67], v[88:91], v[96:99]
    s_waitcnt lgkmcnt(0)
    s_barrier
    v_mfma_f32_16x16x32_bf16 v[104:107], v[68:71], v[88:91], v[104:107]
    ds_read_b64_tr_b16 v[56:57], v6 offset:32768
    ds_read_b64_tr_b16 v[58:59], v6 offset:34816
    ds_read_b128 v[32:35], v9 offset:0
    ds_read_b128 v[36:39], v9 offset:1024
    v_mfma_f32_16x16x32_bf16 v[112:115], v[72:75], v[88:91], v[112:115]
    ds_read_b128 v[40:43], v9 offset:2048
    v_mfma_f32_16x16x32_bf16 v[120:123], v[76:79], v[88:91], v[120:123]
    ds_read_b128 v[44:47], v9 offset:3072
    v_mfma_f32_16x16x32_bf16 v[128:131], v[80:83], v[88:91], v[128:131]
    ds_read_b128 v[48:51], v9 offset:4096
    v_mfma_f32_16x16x32_bf16 v[136:139], v[84:87], v[88:91], v[136:139]
    ds_read_b128 v[52:55], v9 offset:5120
    s_waitcnt lgkmcnt(5)
    v_mfma_f32_16x16x32_bf16 v[96:99], v[32:35], v[56:59], v[96:99]
    ds_read_b64_tr_b16 v[88:89], v6 offset:36864
    ds_read_b64_tr_b16 v[90:91], v6 offset:38912
    ds_read_b128 v[64:67], v9 offset:6144
    s_waitcnt lgkmcnt(7)
    v_mfma_f32_16x16x32_bf16 v[104:107], v[36:39], v[56:59], v[104:107]
    ds_read_b128 v[68:71], v9 offset:7168
    s_waitcnt lgkmcnt(7)
    v_mfma_f32_16x16x32_bf16 v[112:115], v[40:43], v[56:59], v[112:115]
    ds_read_b128 v[72:75], v9 offset:8192
    s_waitcnt lgkmcnt(7)
    v_mfma_f32_16x16x32_bf16 v[120:123], v[44:47], v[56:59], v[120:123]
    ds_read_b128 v[76:79], v9 offset:9216
    s_waitcnt lgkmcnt(7)
    v_mfma_f32_16x16x32_bf16 v[128:131], v[48:51], v[56:59], v[128:131]
    ds_read_b128 v[80:83], v9 offset:10240
    s_waitcnt lgkmcnt(7)
    v_mfma_f32_16x16x32_bf16 v[136:139], v[52:55], v[56:59], v[136:139]
    ds_read_b128 v[84:87], v9 offset:11264
    s_waitcnt lgkmcnt(5)
    v_mfma_f32_16x16x32_bf16 v[96:99], v[64:67], v[88:91], v[96:99]
    s_waitcnt lgkmcnt(0)
    s_barrier
    v_mfma_f32_16x16x32_bf16 v[104:107], v[68:71], v[88:91], v[104:107]
    ds_read_b64_tr_b16 v[56:57], v6 offset:49152
    ds_read_b64_tr_b16 v[58:59], v6 offset:51200
    ds_read_b128 v[32:35], v9 offset:12288
    ds_read_b128 v[36:39], v9 offset:13312
    v_mfma_f32_16x16x32_bf16 v[112:115], v[72:75], v[88:91], v[112:115]
    ds_read_b128 v[40:43], v9 offset:14336
    v_mfma_f32_16x16x32_bf16 v[120:123], v[76:79], v[88:91], v[120:123]
    ds_read_b128 v[44:47], v9 offset:15360
    v_mfma_f32_16x16x32_bf16 v[128:131], v[80:83], v[88:91], v[128:131]
    ds_read_b128 v[48:51], v9 offset:16384
    v_mfma_f32_16x16x32_bf16 v[136:139], v[84:87], v[88:91], v[136:139]
    ds_read_b128 v[52:55], v9 offset:17408
    s_waitcnt vmcnt(0)
    s_mov_b64 exec, 3
    v_cmp_ne_u32 vcc, 0, v16
    s_mov_b64 exec, -1
    s_and_b32 s35, vcc_lo, 2
    s_cmp_eq_u32 s35, 0
    s_cbranch_scc1 K5_NR0
    s_mov_b32 s37, 1
    s_add_u32 s31, s30, 98304
    buffer_load_dwordx4 v[100:103], v10, s[12:15], s31 offen sc1
    s_add_u32 s31, s30, 102400
    buffer_load_dwordx4 v[108:111], v10, s[12:15], s31 offen sc1
    s_add_u32 s31, s30, 106496
    buffer_load_dwordx4 v[116:119], v10, s[12:15], s31 offen sc1
    s_add_u32 s31, s30, 110592
    buffer_load_dwordx4 v[124:127], v10, s[12:15], s31 offen sc1
    s_add_u32 s31, s30, 114688
    buffer_load_dwordx4 v[132:135], v10, s[12:15], s31 offen sc1
    s_add_u32 s31, s30, 118784
    buffer_load_dwordx4 v[140:143], v10, s[12:15], s31 offen sc1
K5_NR0:
    s_waitcnt lgkmcnt(5)
    v_mfma_f32_16x16x32_bf16 v[96:99], v[32:35], v[56:59], v[96:99]
    ds_read_b64_tr_b16 v[88:89], v6 offset:53248
    ds_read_b64_tr_b16 v[90:91], v6 offset:55296
    ds_read_b128 v[64:67], v9 offset:18432
    s_waitcnt lgkmcnt(7)
    v_mfma_f32_16x16x32_bf16 v[104:107], v[36:39], v[56:59], v[104:107]
    ds_read_b128 v[68:71], v9 offset:19456
    s_waitcnt lgkmcnt(7)
    v_mfma_f32_16x16x32_bf16 v[112:115], v[40:43], v[56:59], v[112:115]
    ds_read_b128 v[72:75], v9 offset:20480
    s_waitcnt lgkmcnt(7)
    v_mfma_f32_16x16x32_bf16 v[120:123], v[44:47], v[56:59], v[120:123]
    ds_read_b128 v[76:79], v9 offset:21504
    s_waitcnt lgkmcnt(7)
    v_mfma_f32_16x16x32_bf16 v[128:131], v[48:51], v[56:59], v[128:131]
    ds_read_b128 v[80:83], v9 offset:22528
    s_waitcnt lgkmcnt(7)
    v_mfma_f32_16x16x32_bf16 v[136:139], v[52:55], v[56:59], v[136:139]
    ds_read_b128 v[84:87], v9 offset:23552
    s_waitcnt lgkmcnt(5)
    v_mfma_f32_16x16x32_bf16 v[96:99], v[64:67], v[88:91], v[96:99]
    s_waitcnt lgkmcnt(4)
    v_mfma_f32_16x16x32_bf16 v[104:107], v[68:71], v[88:91], v[104:107]
    s_waitcnt lgkmcnt(3)
    v_mfma_f32_16x16x32_bf16 v[112:115], v[72:75], v[88:91], v[112:115]
    s_waitcnt lgkmcnt(2)
    v_mfma_f32_16x16x32_bf16 v[120:123], v[76:79], v[88:91], v[120:123]
    s_waitcnt lgkmcnt(1)
    v_mfma_f32_16x16x32_bf16 v[128:131], v[80:83], v[88:91], v[128:131]
    s_waitcnt lgkmcnt(0)
    v_mfma_f32_16x16x32_bf16 v[136:139], v[84:87], v[88:91], v[136:139]
    s_cmp_lg_u32 s37, 0
    s_cbranch_scc1 K5_R0
    s_mov_b64 exec, 3
    s_mov_b32 s36, 0x100000
K5_P0:
    s_sub_u32 s36, s36, 1
    s_cmp_eq_u32 s36, 0
    s_cbranch_scc1 K5_G0
    buffer_load_dword v16, v12, s[12:15], s34 offen sc1
    s_waitcnt vmcnt(0)
    v_cmp_ne_u32 vcc, 0, v16
    s_nop 0
    s_and_b32 s35, vcc_lo, 2
    s_cmp_lg_u32 s35, 0
    s_cbranch_scc1 K5_G0
    s_sleep 1
    s_branch K5_P0
K5_G0:
    s_mov_b64 exec, -1
    s_add_u32 s31, s30, 98304
    buffer_load_dwordx4 v[100:103], v10, s[12:15], s31 offen sc1
    s_add_u32 s31, s30, 102400
    buffer_load_dwordx4 v[108:111], v10, s[12:15], s31 offen sc1
    s_add_u32 s31, s30, 106496
    buffer_load_dwordx4 v[116:119], v10, s[12:15], s31 offen sc1
    s_add_u32 s31, s30, 110592
    buffer_load_dwordx4 v[124:127], v10, s[12:15], s31 offen sc1
    s_add_u32 s31, s30, 114688
    buffer_load_dwordx4 v[132:135], v10, s[12:15], s31 offen sc1
    s_add_u32 s31, s30, 118784
    buffer_load_dwordx4 v[140:143], v10, s[12:15], s31 offen sc1
K5_R0:
    s_mov_b32 s16, s20
    s_and_b32 s17, s21, 0xffff
    s_mov_b32 s18, 0x240000
    s_mov_b32 s19, 0x00020000
    s_nop 7
    s_nop 7
    v_pk_add_f32 v[96:97], v[96:97], v[144:145]
    v_pk_add_f32 v[98:99], v[98:99], v[146:147]
    v_pk_add_f32 v[104:105], v[104:105], v[148:149]
    v_pk_add_f32 v[106:107], v[106:107], v[150:151]
    v_pk_add_f32 v[112:113], v[112:113], v[152:153]
    v_pk_add_f32 v[114:115], v[114:115], v[154:155]
    v_pk_add_f32 v[120:121], v[120:121], v[156:157]
    v_pk_add_f32 v[122:123], v[122:123], v[158:159]
    v_pk_add_f32 v[128:129], v[128:129], v[160:161]
    v_pk_add_f32 v[130:131], v[130:131], v[162:163]
    v_pk_add_f32 v[136:137], v[136:137], v[164:165]
    v_pk_add_f32 v[138:139], v[138:139], v[166:167]
    s_waitcnt vmcnt(0)
    v_pk_add_f32 v[96:97], v[96:97], v[100:101]
    v_pk_add_f32 v[98:99], v[98:99], v[102:103]
    v_cvt_pk_bf16_f32 v24, v96, v97
    v_cvt_pk_bf16_f32 v25, v98, v99
    buffer_store_dwordx2 v[24:25], v15, s[16:19], s38 offen offset:0
    v_pk_add_f32 v[104:105], v[104:105], v[108:109]
    v_pk_add_f32 v[106:107], v[106:107], v[110:111]
    v_cvt_pk_bf16_f32 v26, v104, v105
    v_cvt_pk_bf16_f32 v27, v106, v107
    buffer_store_dwordx2 v[26:27], v15, s[16:19], s38 offen offset:32
    v_pk_add_f32 v[112:113], v[112:113], v[116:117]
    v_pk_add_f32 v[114:115], v[114:115], v[118:119]
    v_cvt_pk_bf16_f32 v28, v112, v113
    v_cvt_pk_bf16_f32 v29, v114, v115
    buffer_store_dwordx2 v[28:29], v15, s[16:19], s38 offen offset:64
    v_pk_add_f32 v[120:121], v[120:121], v[124:125]
    v_pk_add_f32 v[122:123], v[122:123], v[126:127]
    v_cvt_pk_bf16_f32 v30, v120, v121
    v_cvt_pk_bf16_f32 v31, v122, v123
    buffer_store_dwordx2 v[30:31], v15, s[16:19], s38 offen offset:96
    v_pk_add_f32 v[128:129], v[128:129], v[132:133]
    v_pk_add_f32 v[130:131], v[130:131], v[134:135]
    v_cvt_pk_bf16_f32 v32, v128, v129
    v_cvt_pk_bf16_f32 v33, v130, v131
    buffer_store_dwordx2 v[32:33], v15, s[16:19], s38 offen offset:128
    v_pk_add_f32 v[136:137], v[136:137], v[140:141]
    v_pk_add_f32 v[138:139], v[138:139], v[142:143]
    v_cvt_pk_bf16_f32 v34, v136, v137
    v_cvt_pk_bf16_f32 v35, v138, v139
    buffer_store_dwordx2 v[34:35], v15, s[16:19], s38 offen offset:160
    s_branch K5_END
K5_X1:
    s_nop 7
    s_nop 7
    s_add_u32 s31, s30, 98304
    buffer_store_dwordx4 v[96:99], v10, s[12:15], s31 offen offset:0 sc1
    s_add_u32 s31, s31, 4096
    buffer_store_dwordx4 v[104:107], v10, s[12:15], s31 offen offset:0 sc1
    s_add_u32 s31, s31, 4096
    buffer_store_dwordx4 v[112:115], v10, s[12:15], s31 offen offset:0 sc1
    s_add_u32 s31, s31, 4096
    buffer_store_dwordx4 v[120:123], v10, s[12:15], s31 offen offset:0 sc1
    s_add_u32 s31, s31, 4096
    buffer_store_dwordx4 v[128:131], v10, s[12:15], s31 offen offset:0 sc1
    s_add_u32 s31, s31, 4096
    buffer_store_dwordx4 v[136:139], v10, s[12:15], s31 offen offset:0 sc1
    s_mov_b32 s37, 0
    s_waitcnt lgkmcnt(5)
    v_mfma_f32_16x16x32_bf16 v[100:103], v[32:35], v[56:59], v[100:103]
    ds_read_b64_tr_b16 v[88:89], v6 offset:4096
    ds_read_b64_tr_b16 v[90:91], v6 offset:6144
    ds_read_b128 v[64:67], v8 offset:6144
    s_waitcnt lgkmcnt(7)
    v_mfma_f32_16x16x32_bf16 v[108:111], v[36:39], v[56:59], v[108:111]
    ds_read_b128 v[68:71], v8 offset:7168
    s_waitcnt lgkmcnt(7)
    v_mfma_f32_16x16x32_bf16 v[116:119], v[40:43], v[56:59], v[116:119]
    ds_read_b128 v[72:75], v8 offset:8192
    s_waitcnt lgkmcnt(7)
    v_mfma_f32_16x16x32_bf16 v[124:127], v[44:47], v[56:59], v[124:127]
    ds_read_b128 v[76:79], v8 offset:9216
    s_waitcnt lgkmcnt(7)
    v_mfma_f32_16x16x32_bf16 v[132:135], v[48:51], v[56:59], v[132:135]
    ds_read_b128 v[80:83], v8 offset:10240
    s_waitcnt lgkmcnt(7)
    v_mfma_f32_16x16x32_bf16 v[140:143], v[52:55], v[56:59], v[140:143]
    ds_read_b128 v[84:87], v8 offset:11264
    s_waitcnt lgkmcnt(5)
    v_mfma_f32_16x16x32_bf16 v[100:103], v[64:67], v[88:91], v[100:103]
    s_waitcnt lgkmcnt(0)
    s_barrier
    v_mfma_f32_16x16x32_bf16 v[108:111], v[68:71], v[88:91], v[108:111]
    ds_read_b64_tr_b16 v[56:57], v6 offset:16384
    ds_read_b64_tr_b16 v[58:59], v6 offset:18432
    ds_read_b128 v[32:35], v8 offset:12288
    ds_read_b128 v[36:39], v8 offset:13312
    v_mfma_f32_16x16x32_bf16 v[116:119], v[72:75], v[88:91], v[116:119]
    ds_read_b128 v[40:43], v8 offset:14336
    v_mfma_f32_16x16x32_bf16 v[124:127], v[76:79], v[88:91], v[124:127]
    ds_read_b128 v[44:47], v8 offset:15360
    v_mfma_f32_16x16x32_bf16 v[132:135], v[80:83], v[88:91], v[132:135]
    ds_read_b128 v[48:51], v8 offset:16384
    v_mfma_f32_16x16x32_bf16 v[140:143], v[84:87], v[88:91], v[140:143]
    ds_read_b128 v[52:55], v8 offset:17408
    s_waitcnt lgkmcnt(5)
    v_mfma_f32_16x16x32_bf16 v[100:103], v[32:35], v[56:59], v[100:103]
    ds_read_b64_tr_b16 v[88:89], v6 offset:20480
    ds_read_b64_tr_b16 v[90:91], v6 offset:22528
    ds_read_b128 v[64:67], v8 offset:18432
    s_waitcnt lgkmcnt(7)
    v_mfma_f32_16x16x32_bf16 v[108:111], v[36:39], v[56:59], v[108:111]
    ds_read_b128 v[68:71], v8 offset:19456
    s_waitcnt lgkmcnt(7)
    v_mfma_f32_16x16x32_bf16 v[116:119], v[40:43], v[56:59], v[116:119]
    ds_read_b128 v[72:75], v8 offset:20480
    s_waitcnt lgkmcnt(7)
    v_mfma_f32_16x16x32_bf16 v[124:127], v[44:47], v[56:59], v[124:127]
    ds_read_b128 v[76:79], v8 offset:21504
    s_waitcnt lgkmcnt(7)
    v_mfma_f32_16x16x32_bf16 v[132:135], v[48:51], v[56:59], v[132:135]
    ds_read_b128 v[80:83], v8 offset:22528
    s_waitcnt lgkmcnt(7)
    v_mfma_f32_16x16x32_bf16 v[140:143], v[52:55], v[56:59], v[140:143]
    ds_read_b128 v[84:87], v8 offset:23552
    s_waitcnt lgkmcnt(5)
    v_mfma_f32_16x16x32_bf16 v[100:103], v[64:67], v[88:91], v[100:103]
    s_waitcnt lgkmcnt(0)
    s_barrier
    v_mfma_f32_16x16x32_bf16 v[108:111], v[68:71], v[88:91], v[108:111]
    ds_read_b64_tr_b16 v[56:57], v6 offset:32768
    ds_read_b64_tr_b16 v[58:59], v6 offset:34816
    ds_read_b128 v[32:35], v9 offset:0
    ds_read_b128 v[36:39], v9 offset:1024
    v_mfma_f32_16x16x32_bf16 v[116:119], v[72:75], v[88:91], v[116:119]
    ds_read_b128 v[40:43], v9 offset:2048
    v_mfma_f32_16x16x32_bf16 v[124:127], v[76:79], v[88:91], v[124:127]
    ds_read_b128 v[44:47], v9 offset:3072
    v_mfma_f32_16x16x32_bf16 v[132:135], v[80:83], v[88:91], v[132:135]
    ds_read_b128 v[48:51], v9 offset:4096
    v_mfma_f32_16x16x32_bf16 v[140:143], v[84:87], v[88:91], v[140:143]
    ds_read_b128 v[52:55], v9 offset:5120
    s_waitcnt lgkmcnt(5)
    v_mfma_f32_16x16x32_bf16 v[100:103], v[32:35], v[56:59], v[100:103]
    ds_read_b64_tr_b16 v[88:89], v6 offset:36864
    ds_read_b64_tr_b16 v[90:91], v6 offset:38912
    ds_read_b128 v[64:67], v9 offset:6144
    s_waitcnt lgkmcnt(7)
    v_mfma_f32_16x16x32_bf16 v[108:111], v[36:39], v[56:59], v[108:111]
    ds_read_b128 v[68:71], v9 offset:7168
    s_waitcnt lgkmcnt(7)
    v_mfma_f32_16x16x32_bf16 v[116:119], v[40:43], v[56:59], v[116:119]
    ds_read_b128 v[72:75], v9 offset:8192
    s_waitcnt lgkmcnt(7)
    v_mfma_f32_16x16x32_bf16 v[124:127], v[44:47], v[56:59], v[124:127]
    ds_read_b128 v[76:79], v9 offset:9216
    s_waitcnt lgkmcnt(7)
    v_mfma_f32_16x16x32_bf16 v[132:135], v[48:51], v[56:59], v[132:135]
    ds_read_b128 v[80:83], v9 offset:10240
    s_waitcnt lgkmcnt(7)
    v_mfma_f32_16x16x32_bf16 v[140:143], v[52:55], v[56:59], v[140:143]
    ds_read_b128 v[84:87], v9 offset:11264
    s_waitcnt lgkmcnt(5)
    v_mfma_f32_16x16x32_bf16 v[100:103], v[64:67], v[88:91], v[100:103]
    s_waitcnt lgkmcnt(0)
    s_barrier
    v_mfma_f32_16x16x32_bf16 v[108:111], v[68:71], v[88:91], v[108:111]
    ds_read_b64_tr_b16 v[56:57], v6 offset:49152
    ds_read_b64_tr_b16 v[58:59], v6 offset:51200
    ds_read_b128 v[32:35], v9 offset:12288
    ds_read_b128 v[36:39], v9 offset:13312
    v_mfma_f32_16x16x32_bf16 v[116:119], v[72:75], v[88:91], v[116:119]
    ds_read_b128 v[40:43], v9 offset:14336
    v_mfma_f32_16x16x32_bf16 v[124:127], v[76:79], v[88:91], v[124:127]
    ds_read_b128 v[44:47], v9 offset:15360
    v_mfma_f32_16x16x32_bf16 v[132:135], v[80:83], v[88:91], v[132:135]
    ds_read_b128 v[48:51], v9 offset:16384
    v_mfma_f32_16x16x32_bf16 v[140:143], v[84:87], v[88:91], v[140:143]
    ds_read_b128 v[52:55], v9 offset:17408
    s_waitcnt vmcnt(0)
    v_mov_b32 v13, 1
    s_add_u32 s31, s34, 512
    s_mov_b64 exec, 1
    buffer_store_dword v13, v14, s[12:15], s31 offen sc1
    s_mov_b64 exec, -1
    v_lshlrev_b32 v168, 16, v168
    v_lshlrev_b32 v144, 16, v144
    v_lshlrev_b32 v145, 16, v145
    v_lshlrev_b32 v146, 16, v146
    v_lshlrev_b32 v147, 16, v147
    v_lshlrev_b32 v148, 16, v148
    v_lshlrev_b32 v149, 16, v149
    v_lshlrev_b32 v150, 16, v150
    v_lshlrev_b32 v151, 16, v151
    v_lshlrev_b32 v152, 16, v152
    v_lshlrev_b32 v153, 16, v153
    v_lshlrev_b32 v154, 16, v154
    v_lshlrev_b32 v155, 16, v155
    v_lshlrev_b32 v156, 16, v156
    v_lshlrev_b32 v157, 16, v157
    v_lshlrev_b32 v158, 16, v158
    v_lshlrev_b32 v159, 16, v159
    v_lshlrev_b32 v160, 16, v160
    v_lshlrev_b32 v161, 16, v161
    v_lshlrev_b32 v162, 16, v162
    v_lshlrev_b32 v163, 16, v163
    v_lshlrev_b32 v164, 16, v164
    v_lshlrev_b32 v165, 16, v165
    v_lshlrev_b32 v166, 16, v166
    v_lshlrev_b32 v167, 16, v167
    v_add_f32 v144, v144, v168
    v_add_f32 v145, v145, v168
    v_add_f32 v146, v146, v168
    v_add_f32 v147, v147, v168
    v_add_f32 v148, v148, v168
    v_add_f32 v149, v149, v168
    v_add_f32 v150, v150, v168
    v_add_f32 v151, v151, v168
    v_add_f32 v152, v152, v168
    v_add_f32 v153, v153, v168
    v_add_f32 v154, v154, v168
    v_add_f32 v155, v155, v168
    v_add_f32 v156, v156, v168
    v_add_f32 v157, v157, v168
    v_add_f32 v158, v158, v168
    v_add_f32 v159, v159, v168
    v_add_f32 v160, v160, v168
    v_add_f32 v161, v161, v168
    v_add_f32 v162, v162, v168
    v_add_f32 v163, v163, v168
    v_add_f32 v164, v164, v168
    v_add_f32 v165, v165, v168
    v_add_f32 v166, v166, v168
    v_add_f32 v167, v167, v168
    s_waitcnt lgkmcnt(5)
    v_mfma_f32_16x16x32_bf16 v[100:103], v[32:35], v[56:59], v[100:103]
    ds_read_b64_tr_b16 v[88:89], v6 offset:53248
    ds_read_b64_tr_b16 v[90:91], v6 offset:55296
    ds_read_b128 v[64:67], v9 offset:18432
    s_waitcnt lgkmcnt(7)
    v_mfma_f32_16x16x32_bf16 v[108:111], v[36:39], v[56:59], v[108:111]
    ds_read_b128 v[68:71], v9 offset:19456
    s_waitcnt lgkmcnt(7)
    v_mfma_f32_16x16x32_bf16 v[116:119], v[40:43], v[56:59], v[116:119]
    ds_read_b128 v[72:75], v9 offset:20480
    s_waitcnt lgkmcnt(7)
    v_mfma_f32_16x16x32_bf16 v[124:127], v[44:47], v[56:59], v[124:127]
    ds_read_b128 v[76:79], v9 offset:21504
    s_waitcnt lgkmcnt(7)
    v_mfma_f32_16x16x32_bf16 v[132:135], v[48:51], v[56:59], v[132:135]
    ds_read_b128 v[80:83], v9 offset:22528
    s_waitcnt lgkmcnt(7)
    v_mfma_f32_16x16x32_bf16 v[140:143], v[52:55], v[56:59], v[140:143]
    ds_read_b128 v[84:87], v9 offset:23552
    s_waitcnt lgkmcnt(5)
    v_mfma_f32_16x16x32_bf16 v[100:103], v[64:67], v[88:91], v[100:103]
    s_waitcnt lgkmcnt(0)
    s_barrier
    v_mfma_f32_16x16x32_bf16 v[108:111], v[68:71], v[88:91], v[108:111]
    ds_read_b64_tr_b16 v[56:57], v6 offset:0
    ds_read_b64_tr_b16 v[58:59], v6 offset:2048
    ds_read_b128 v[32:35], v8 offset:0
    ds_read_b128 v[36:39], v8 offset:1024
    v_mfma_f32_16x16x32_bf16 v[116:119], v[72:75], v[88:91], v[116:119]
    ds_read_b128 v[40:43], v8 offset:2048
    v_mfma_f32_16x16x32_bf16 v[124:127], v[76:79], v[88:91], v[124:127]
    ds_read_b128 v[44:47], v8 offset:3072
    v_mfma_f32_16x16x32_bf16 v[132:135], v[80:83], v[88:91], v[132:135]
    ds_read_b128 v[48:51], v8 offset:4096
    v_mfma_f32_16x16x32_bf16 v[140:143], v[84:87], v[88:91], v[140:143]
    ds_read_b128 v[52:55], v8 offset:5120
    s_waitcnt lgkmcnt(5)
    v_mfma_f32_16x16x32_bf16 v[100:103], v[32:35], v[56:59], v[100:103]
    ds_read_b64_tr_b16 v[88:89], v6 offset:4096
    ds_read_b64_tr_b16 v[90:91], v6 offset:6144
    ds_read_b128 v[64:67], v8 offset:6144
    s_waitcnt lgkmcnt(7)
    v_mfma_f32_16x16x32_bf16 v[108:111], v[36:39], v[56:59], v[108:111]
    ds_read_b128 v[68:71], v8 offset:7168
    s_waitcnt lgkmcnt(7)
    v_mfma_f32_16x16x32_bf16 v[116:119], v[40:43], v[56:59], v[116:119]
    ds_read_b128 v[72:75], v8 offset:8192
    s_waitcnt lgkmcnt(7)
    v_mfma_f32_16x16x32_bf16 v[124:127], v[44:47], v[56:59], v[124:127]
    ds_read_b128 v[76:79], v8 offset:9216
    s_waitcnt lgkmcnt(7)
    v_mfma_f32_16x16x32_bf16 v[132:135], v[48:51], v[56:59], v[132:135]
    ds_read_b128 v[80:83], v8 offset:10240
    s_waitcnt lgkmcnt(7)
    v_mfma_f32_16x16x32_bf16 v[140:143], v[52:55], v[56:59], v[140:143]
    ds_read_b128 v[84:87], v8 offset:11264
    s_waitcnt lgkmcnt(5)
    v_mfma_f32_16x16x32_bf16 v[100:103], v[64:67], v[88:91], v[100:103]
    s_waitcnt lgkmcnt(0)
    s_barrier
    v_mfma_f32_16x16x32_bf16 v[108:111], v[68:71], v[88:91], v[108:111]
    ds_read_b64_tr_b16 v[56:57], v6 offset:16384
    ds_read_b64_tr_b16 v[58:59], v6 offset:18432
    ds_read_b128 v[32:35], v8 offset:12288
    ds_read_b128 v[36:39], v8 offset:13312
    v_mfma_f32_16x16x32_bf16 v[116:119], v[72:75], v[88:91], v[116:119]
    ds_read_b128 v[40:43], v8 offset:14336
    v_mfma_f32_16x16x32_bf16 v[124:127], v[76:79], v[88:91], v[124:127]
    ds_read_b128 v[44:47], v8 offset:15360
    v_mfma_f32_16x16x32_bf16 v[132:135], v[80:83], v[88:91], v[132:135]
    ds_read_b128 v[48:51], v8 offset:16384
    v_mfma_f32_16x16x32_bf16 v[140:143], v[84:87], v[88:91], v[140:143]
    ds_read_b128 v[52:55], v8 offset:17408
    s_mov_b64 exec, 3
    buffer_load_dword v16, v12, s[12:15], s34 offen sc1
    s_mov_b64 exec, -1
    s_waitcnt lgkmcnt(5)
    v_mfma_f32_16x16x32_bf16 v[100:103], v[32:35], v[56:59], v[100:103]
    ds_read_b64_tr_b16 v[88:89], v6 offset:20480
    ds_read_b64_tr_b16 v[90:91], v6 offset:22528
    ds_read_b128 v[64:67], v8 offset:18432
    s_waitcnt lgkmcnt(7)
    v_mfma_f32_16x16x32_bf16 v[108:111], v[36:39], v[56:59], v[108:111]
    ds_read_b128 v[68:71], v8 offset:19456
    s_waitcnt lgkmcnt(7)
    v_mfma_f32_16x16x32_bf16 v[116:119], v[40:43], v[56:59], v[116:119]
    ds_read_b128 v[72:75], v8 offset:20480
    s_waitcnt lgkmcnt(7)
    v_mfma_f32_16x16x32_bf16 v[124:127], v[44:47], v[56:59], v[124:127]
    ds_read_b128 v[76:79], v8 offset:21504
    s_waitcnt lgkmcnt(7)
    v_mfma_f32_16x16x32_bf16 v[132:135], v[48:51], v[56:59], v[132:135]
    ds_read_b128 v[80:83], v8 offset:22528
    s_waitcnt lgkmcnt(7)
    v_mfma_f32_16x16x32_bf16 v[140:143], v[52:55], v[56:59], v[140:143]
    ds_read_b128 v[84:87], v8 offset:23552
    s_waitcnt lgkmcnt(5)
    v_mfma_f32_16x16x32_bf16 v[100:103], v[64:67], v[88:91], v[100:103]
    s_waitcnt lgkmcnt(0)
    s_barrier
    v_mfma_f32_16x16x32_bf16 v[108:111], v[68:71], v[88:91], v[108:111]
    ds_read_b64_tr_b16 v[56:57], v6 offset:32768
    ds_read_b64_tr_b16 v[58:59], v6 offset:34816
    ds_read_b128 v[32:35], v9 offset:0
    ds_read_b128 v[36:39], v9 offset:1024
    v_mfma_f32_16x16x32_bf16 v[116:119], v[72:75], v[88:91], v[116:119]
    ds_read_b128 v[40:43], v9 offset:2048
    v_mfma_f32_16x16x32_bf16 v[124:127], v[76:79], v[88:91], v[124:127]
    ds_read_b128 v[44:47], v9 offset:3072
    v_mfma_f32_16x16x32_bf16 v[132:135], v[80:83], v[88:91], v[132:135]
    ds_read_b128 v[48:51], v9 offset:4096
    v_mfma_f32_16x16x32_bf16 v[140:143], v[84:87], v[88:91], v[140:143]
    ds_read_b128 v[52:55], v9 offset:5120
    s_waitcnt lgkmcnt(5)
    v_mfma_f32_16x16x32_bf16 v[100:103], v[32:35], v[56:59], v[100:103]
    ds_read_b64_tr_b16 v[88:89], v6 offset:36864
    ds_read_b64_tr_b16 v[90:91], v6 offset:38912
    ds_read_b128 v[64:67], v9 offset:6144
    s_waitcnt lgkmcnt(7)
    v_mfma_f32_16x16x32_bf16 v[108:111], v[36:39], v[56:59], v[108:111]
    ds_read_b128 v[68:71], v9 offset:7168
    s_waitcnt lgkmcnt(7)
    v_mfma_f32_16x16x32_bf16 v[116:119], v[40:43], v[56:59], v[116:119]
    ds_read_b128 v[72:75], v9 offset:8192
    s_waitcnt lgkmcnt(7)
    v_mfma_f32_16x16x32_bf16 v[124:127], v[44:47], v[56:59], v[124:127]
    ds_read_b128 v[76:79], v9 offset:9216
    s_waitcnt lgkmcnt(7)
    v_mfma_f32_16x16x32_bf16 v[132:135], v[48:51], v[56:59], v[132:135]
    ds_read_b128 v[80:83], v9 offset:10240
    s_waitcnt lgkmcnt(7)
    v_mfma_f32_16x16x32_bf16 v[140:143], v[52:55], v[56:59], v[140:143]
    ds_read_b128 v[84:87], v9 offset:11264
    s_waitcnt lgkmcnt(5)
    v_mfma_f32_16x16x32_bf16 v[100:103], v[64:67], v[88:91], v[100:103]
    s_waitcnt lgkmcnt(0)
    s_barrier
    v_mfma_f32_16x16x32_bf16 v[108:111], v[68:71], v[88:91], v[108:111]
    ds_read_b64_tr_b16 v[56:57], v6 offset:49152
    ds_read_b64_tr_b16 v[58:59], v6 offset:51200
    ds_read_b128 v[32:35], v9 offset:12288
    ds_read_b128 v[36:39], v9 offset:13312
    v_mfma_f32_16x16x32_bf16 v[116:119], v[72:75], v[88:91], v[116:119]
    ds_read_b128 v[40:43], v9 offset:14336
    v_mfma_f32_16x16x32_bf16 v[124:127], v[76:79], v[88:91], v[124:127]
    ds_read_b128 v[44:47], v9 offset:15360
    v_mfma_f32_16x16x32_bf16 v[132:135], v[80:83], v[88:91], v[132:135]
    ds_read_b128 v[48:51], v9 offset:16384
    v_mfma_f32_16x16x32_bf16 v[140:143], v[84:87], v[88:91], v[140:143]
    ds_read_b128 v[52:55], v9 offset:17408
    s_waitcnt vmcnt(0)
    s_mov_b64 exec, 3
    v_cmp_ne_u32 vcc, 0, v16
    s_mov_b64 exec, -1
    s_and_b32 s35, vcc_lo, 1
    s_cmp_eq_u32 s35, 0
    s_cbranch_scc1 K5_NR1
    s_mov_b32 s37, 1
    s_add_u32 s31, s30, 2048
    buffer_load_dwordx4 v[96:99], v10, s[12:15], s31 offen sc1
    s_add_u32 s31, s30, 6144
    buffer_load_dwordx4 v[104:107], v10, s[12:15], s31 offen sc1
    s_add_u32 s31, s30, 10240
    buffer_load_dwordx4 v[112:115], v10, s[12:15], s31 offen sc1
    s_add_u32 s31, s30, 14336
    buffer_load_dwordx4 v[120:123], v10, s[12:15], s31 offen sc1
    s_add_u32 s31, s30, 18432
    buffer_load_dwordx4 v[128:131], v10, s[12:15], s31 offen sc1
    s_add_u32 s31, s30, 22528
    buffer_load_dwordx4 v[136:139], v10, s[12:15], s31 offen sc1
K5_NR1:
    s_waitcnt lgkmcnt(5)
    v_mfma_f32_16x16x32_bf16 v[100:103], v[32:35], v[56:59], v[100:103]
    ds_read_b64_tr_b16 v[88:89], v6 offset:53248
    ds_read_b64_tr_b16 v[90:91], v6 offset:55296
    ds_read_b128 v[64:67], v9 offset:18432
    s_waitcnt lgkmcnt(7)
    v_mfma_f32_16x16x32_bf16 v[108:111], v[36:39], v[56:59], v[108:111]
    ds_read_b128 v[68:71], v9 offset:19456
    s_waitcnt lgkmcnt(7)
    v_mfma_f32_16x16x32_bf16 v[116:119], v[40:43], v[56:59], v[116:119]
    ds_read_b128 v[72:75], v9 offset:20480
    s_waitcnt lgkmcnt(7)
    v_mfma_f32_16x16x32_bf16 v[124:127], v[44:47], v[56:59], v[124:127]
    ds_read_b128 v[76:79], v9 offset:21504
    s_waitcnt lgkmcnt(7)
    v_mfma_f32_16x16x32_bf16 v[132:135], v[48:51], v[56:59], v[132:135]
    ds_read_b128 v[80:83], v9 offset:22528
    s_waitcnt lgkmcnt(7)
    v_mfma_f32_16x16x32_bf16 v[140:143], v[52:55], v[56:59], v[140:143]
    ds_read_b128 v[84:87], v9 offset:23552
    s_waitcnt lgkmcnt(5)
    v_mfma_f32_16x16x32_bf16 v[100:103], v[64:67], v[88:91], v[100:103]
    s_waitcnt lgkmcnt(4)
    v_mfma_f32_16x16x32_bf16 v[108:111], v[68:71], v[88:91], v[108:111]
    s_waitcnt lgkmcnt(3)
    v_mfma_f32_16x16x32_bf16 v[116:119], v[72:75], v[88:91], v[116:119]
    s_waitcnt lgkmcnt(2)
    v_mfma_f32_16x16x32_bf16 v[124:127], v[76:79], v[88:91], v[124:127]
    s_waitcnt lgkmcnt(1)
    v_mfma_f32_16x16x32_bf16 v[132:135], v[80:83], v[88:91], v[132:135]
    s_waitcnt lgkmcnt(0)
    v_mfma_f32_16x16x32_bf16 v[140:143], v[84:87], v[88:91], v[140:143]
    s_cmp_lg_u32 s37, 0
    s_cbranch_scc1 K5_R1
    s_mov_b64 exec, 3
    s_mov_b32 s36, 0x100000
K5_P1:
    s_sub_u32 s36, s36, 1
    s_cmp_eq_u32 s36, 0
    s_cbranch_scc1 K5_G1
    buffer_load_dword v16, v12, s[12:15], s34 offen sc1
    s_waitcnt vmcnt(0)
    v_cmp_ne_u32 vcc, 0, v16
    s_nop 0
    s_and_b32 s35, vcc_lo, 1
    s_cmp_lg_u32 s35, 0
    s_cbranch_scc1 K5_G1
    s_sleep 1
    s_branch K5_P1
K5_G1:
    s_mov_b64 exec, -1
    s_add_u32 s31, s30, 2048
    buffer_load_dwordx4 v[96:99], v10, s[12:15], s31 offen sc1
    s_add_u32 s31, s30, 6144
    buffer_load_dwordx4 v[104:107], v10, s[12:15], s31 offen sc1
    s_add_u32 s31, s30, 10240
    buffer_load_dwordx4 v[112:115], v10, s[12:15], s31 offen sc1
    s_add_u32 s31, s30, 14336
    buffer_load_dwordx4 v[120:123], v10, s[12:15], s31 offen sc1
    s_add_u32 s31, s30, 18432
    buffer_load_dwordx4 v[128:131], v10, s[12:15], s31 offen sc1
    s_add_u32 s31, s30, 22528
    buffer_load_dwordx4 v[136:139], v10, s[12:15], s31 offen sc1
K5_R1:
    s_mov_b32 s16, s20
    s_and_b32 s17, s21, 0xffff
    s_mov_b32 s18, 0x240000
    s_mov_b32 s19, 0x00020000
    s_nop 7
    s_nop 7
    v_pk_add_f32 v[100:101], v[100:101], v[144:145]
    v_pk_add_f32 v[102:103], v[102:103], v[146:147]
    v_pk_add_f32 v[108:109], v[108:109], v[148:149]
    v_pk_add_f32 v[110:111], v[110:111], v[150:151]
    v_pk_add_f32 v[116:117], v[116:117], v[152:153]
    v_pk_add_f32 v[118:119], v[118:119], v[154:155]
    v_pk_add_f32 v[124:125], v[124:125], v[156:157]
    v_pk_add_f32 v[126:127], v[126:127], v[158:159]
    v_pk_add_f32 v[132:133], v[132:133], v[160:161]
    v_pk_add_f32 v[134:135], v[134:135], v[162:163]
    v_pk_add_f32 v[140:141], v[140:141], v[164:165]
    v_pk_add_f32 v[142:143], v[142:143], v[166:167]
    s_waitcnt vmcnt(0)
    v_pk_add_f32 v[100:101], v[100:101], v[96:97]
    v_pk_add_f32 v[102:103], v[102:103], v[98:99]
    v_cvt_pk_bf16_f32 v24, v100, v101
    v_cvt_pk_bf16_f32 v25, v102, v103
    buffer_store_dwordx2 v[24:25], v15, s[16:19], s38 offen offset:0
    v_pk_add_f32 v[108:109], v[108:109], v[104:105]
    v_pk_add_f32 v[110:111], v[110:111], v[106:107]
    v_cvt_pk_bf16_f32 v26, v108, v109
    v_cvt_pk_bf16_f32 v27, v110, v111
    buffer_store_dwordx2 v[26:27], v15, s[16:19], s38 offen offset:32
    v_pk_add_f32 v[116:117], v[116:117], v[112:113]
    v_pk_add_f32 v[118:119], v[118:119], v[114:115]
    v_cvt_pk_bf16_f32 v28, v116, v117
    v_cvt_pk_bf16_f32 v29, v118, v119
    buffer_store_dwordx2 v[28:29], v15, s[16:19], s38 offen offset:64
    v_pk_add_f32 v[124:125], v[124:125], v[120:121]
    v_pk_add_f32 v[126:127], v[126:127], v[122:123]
    v_cvt_pk_bf16_f32 v30, v124, v125
    v_cvt_pk_bf16_f32 v31, v126, v127
    buffer_store_dwordx2 v[30:31], v15, s[16:19], s38 offen offset:96
    v_pk_add_f32 v[132:133], v[132:133], v[128:129]
    v_pk_add_f32 v[134:135], v[134:135], v[130:131]
    v_cvt_pk_bf16_f32 v32, v132, v133
    v_cvt_pk_bf16_f32 v33, v134, v135
    buffer_store_dwordx2 v[32:33], v15, s[16:19], s38 offen offset:128
    v_pk_add_f32 v[140:141], v[140:141], v[136:137]
    v_pk_add_f32 v[142:143], v[142:143], v[138:139]
    v_cvt_pk_bf16_f32 v34, v140, v141
    v_cvt_pk_bf16_f32 v35, v142, v143
    buffer_store_dwordx2 v[34:35], v15, s[16:19], s38 offen offset:160
    s_branch K5_END
K5_PREF:
    s_cmp_ge_u32 s2, 256
    s_cbranch_scc1 K5_END
    s_load_dwordx2 s[16:17], s[0:1], 64
    s_load_dwordx2 s[18:19], s[0:1], 80
    v_and_b32 v1, 63, v0
    v_lshrrev_b32 v2, 6, v0
    s_nop 0
    v_readfirstlane_b32 s27, v2
    s_sub_u32 s3, s2, 192
    s_lshr_b32 s3, s3, 3
    s_mul_i32 s3, s3, 8
    s_add_u32 s3, s3, s27
    s_and_b32 s4, s2, 7
    s_waitcnt lgkmcnt(0)
    s_mov_b32 s8, s18
    s_and_b32 s9, s19, 0xffff
    s_mov_b32 s10, 0x1200000
    s_mov_b32 s11, 0x00020000
    v_lshrrev_b32 v4, 3, v1
    v_and_b32 v5, 7, v1
    s_and_b32 s34, s4, 3
    s_lshr_b32 s35, s4, 2
    v_and_b32 v3, 6, v5
    v_or_b32 v3, s35, v3
    s_lshl_b32 s36, s34, 10
    v_lshlrev_b32 v5, 7, v5
    v_add_u32 v5, s36, v5
    v_lshlrev_b32 v3, 7, v3
    v_add_u32 v3, s36, v3
    s_mul_i32 s34, s34, 9
    s_sub_u32 s36, s34, 4
    s_max_i32 s36, s36, 0
    s_cmp_eq_u32 s35, 0
    s_cselect_b32 s34, s34, s36
    s_cselect_b32 s37, 0, 2560
    s_lshl_b32 s34, s34, 6
    s_mul_i32 s20, s3, 8
    s_add_u32 s20, s20, 400
    s_cmp_ge_u32 s20, 2560
    s_cbranch_scc1 PF_SK5_1
    v_add_u32 v6, s20, v4
    v_min_u32 v6, 2559, v6
    v_add_u32 v7, s34, v6
    v_subrev_u32 v8, 2048, v7
    v_min_u32 v7, v7, v8
    v_add_u32 v7, s37, v7
    v_cmp_le_u32 vcc, 2048, v6
    s_nop 1
    v_cndmask_b32 v7, v7, v6, vcc
    v_cndmask_b32 v9, v5, v3, vcc
    v_lshl_add_u32 v7, v7, 12, v9
    buffer_load_dword v60, v7, s[8:11], 0 offen
PF_SK5_1:
    s_add_u32 s20, s20, 512
    s_cmp_ge_u32 s20, 2560
    s_cbranch_scc1 PF_SK5_2
    v_add_u32 v6, s20, v4
    v_min_u32 v6, 2559, v6
    v_add_u32 v7, s34, v6
    v_subrev_u32 v8, 2048, v7
    v_min_u32 v7, v7, v8
    v_add_u32 v7, s37, v7
    v_cmp_le_u32 vcc, 2048, v6
    s_nop 1
    v_cndmask_b32 v7, v7, v6, vcc
    v_cndmask_b32 v9, v5, v3, vcc
    v_lshl_add_u32 v7, v7, 12, v9
    buffer_load_dword v61, v7, s[8:11], 0 offen
PF_SK5_2:
    s_add_u32 s20, s20, 512
    s_cmp_ge_u32 s20, 2560
    s_cbranch_scc1 PF_SK5_3
    v_add_u32 v6, s20, v4
    v_min_u32 v6, 2559, v6
    v_add_u32 v7, s34, v6
    v_subrev_u32 v8, 2048, v7
    v_min_u32 v7, v7, v8
    v_add_u32 v7, s37, v7
    v_cmp_le_u32 vcc, 2048, v6
    s_nop 1
    v_cndmask_b32 v7, v7, v6, vcc
    v_cndmask_b32 v9, v5, v3, vcc
    v_lshl_add_u32 v7, v7, 12, v9
    buffer_load_dword v62, v7, s[8:11], 0 offen
PF_SK5_3:
    s_add_u32 s20, s20, 512
    s_cmp_ge_u32 s20, 2560
    s_cbranch_scc1 PF_SK5_4
    v_add_u32 v6, s20, v4
    v_min_u32 v6, 2559, v6
    v_add_u32 v7, s34, v6
    v_subrev_u32 v8, 2048, v7
    v_min_u32 v7, v7, v8
    v_add_u32 v7, s37, v7
    v_cmp_le_u32 vcc, 2048, v6
    s_nop 1
    v_cndmask_b32 v7, v7, v6, vcc
    v_cndmask_b32 v9, v5, v3, vcc
    v_lshl_add_u32 v7, v7, 12, v9
    buffer_load_dword v63, v7, s[8:11], 0 offen
PF_SK5_4:
    s_add_u32 s20, s20, 512
    s_cmp_ge_u32 s20, 2560
    s_cbranch_scc1 PF_SK5_5
    v_add_u32 v6, s20, v4
    v_min_u32 v6, 2559, v6
    v_add_u32 v7, s34, v6
    v_subrev_u32 v8, 2048, v7
    v_min_u32 v7, v7, v8
    v_add_u32 v7, s37, v7
    v_cmp_le_u32 vcc, 2048, v6
    s_nop 1
    v_cndmask_b32 v7, v7, v6, vcc
    v_cndmask_b32 v9, v5, v3, vcc
    v_lshl_add_u32 v7, v7, 12, v9
    buffer_load_dword v64, v7, s[8:11], 0 offen
PF_SK5_5:
    s_branch K5_END
K5_END:
    s_endpgm
.section .rodata,"a"
.p2align 6
.p2align 6
.amdhsa_kernel k1_kernel
  .amdhsa_next_free_vgpr 168
  .amdhsa_next_free_sgpr 96
  .amdhsa_accum_offset 168
  .amdhsa_group_segment_fixed_size 0
  .amdhsa_kernarg_size 120
  .amdhsa_user_sgpr_count 2
  .amdhsa_user_sgpr_kernarg_segment_ptr 1
  .amdhsa_system_sgpr_workgroup_id_x 1
.end_amdhsa_kernel
.p2align 6
.amdhsa_kernel k3_kernel
  .amdhsa_next_free_vgpr 104
  .amdhsa_next_free_sgpr 96
  .amdhsa_accum_offset 104
  .amdhsa_group_segment_fixed_size 0
  .amdhsa_kernarg_size 120
  .amdhsa_user_sgpr_count 2
  .amdhsa_user_sgpr_kernarg_segment_ptr 1
  .amdhsa_system_sgpr_workgroup_id_x 1
.end_amdhsa_kernel
.p2align 6
.amdhsa_kernel k4_kernel
  .amdhsa_next_free_vgpr 208
  .amdhsa_next_free_sgpr 96
  .amdhsa_accum_offset 208
  .amdhsa_group_segment_fixed_size 0
  .amdhsa_kernarg_size 120
  .amdhsa_user_sgpr_count 2
  .amdhsa_user_sgpr_kernarg_segment_ptr 1
  .amdhsa_system_sgpr_workgroup_id_x 1
.end_amdhsa_kernel
.p2align 6
.amdhsa_kernel k5_kernel
  .amdhsa_next_free_vgpr 172
  .amdhsa_next_free_sgpr 96
  .amdhsa_accum_offset 172
  .amdhsa_group_segment_fixed_size 0
  .amdhsa_kernarg_size 120
  .amdhsa_user_sgpr_count 2
  .amdhsa_user_sgpr_kernarg_segment_ptr 1
  .amdhsa_system_sgpr_workgroup_id_x 1
.end_amdhsa_kernel
```
